```python
import torch

def _softmax(x, axis=-1):
    return torch.softmax(x, dim=axis)
def _gelu(x):
    return torch.nn.functional.gelu(x, approximate="tanh")
def _silu(x):
    return torch.nn.functional.silu(x)
def _sigmoid(x):
    return torch.sigmoid(x)
def _layernorm(x, axis=-1, eps=1e-5):
    m = x.mean(dim=axis, keepdim=True)
    v = x.var(dim=axis, keepdim=True, unbiased=False)
    return (x - m) / torch.sqrt(v + eps)
def _scatter_add(tgt, idx, src, axis=0):
    return tgt.clone().index_add_(axis, idx, src)
def _segment_sum(src, seg, n):
    out = torch.zeros((n,) + src.shape[1:], dtype=src.dtype)
    return out.index_add_(0, seg, src)
def _pad(x, pw):
    flat = tuple(v for pair in reversed(pw) for v in pair)
    return torch.nn.functional.pad(x, flat)

kernel_name = 'standalone__mha_block_cached__near_ridge'

def setup_inputs():

    _w = (lambda a: (lambda t: t.to(torch.bfloat16) if t.is_floating_point() else t)(torch.as_tensor(a)))
    B, Sq, D = 8, 224, 1024
    H, Sk, Dh = 32, 1024, 128
    return {
        "x": _w((lambda *s: torch.randn(*s, dtype=torch.bfloat16) * 0.8)(B, Sq, D)),
        "k_cache": _w((lambda *s: torch.randn(*s, dtype=torch.bfloat16) * 0.8)(B, H, Sk, Dh)),
        "v_cache": _w((lambda *s: torch.randn(*s, dtype=torch.bfloat16) * 0.05)(B, H, Sk, Dh)),
        "wq": _w((lambda *s: torch.randn(*s, dtype=torch.bfloat16) * 0.8)(D, H * Dh) * (D ** -0.5)),
        "wo": _w((lambda *s: torch.randn(*s, dtype=torch.bfloat16) * 0.05)(H * Dh, D) * ((H * Dh) ** -0.5)),
    }

def reference(x, k_cache, v_cache, wq, wo):
    B, Sq, D = x.shape
    H, Dh = 32, 128
    q = (lambda x, *d: x.permute(*d))((x @ wq).reshape(B, Sq, H, Dh), 0, 2, 1, 3)
    scores = torch.einsum("bhqd,bhkd->bhqk", q, k_cache) * (Dh ** -0.5)
    p = _softmax(scores, axis=-1)
    o = torch.einsum("bhqk,bhkd->bhqd", p, v_cache)
    return (lambda x, *d: x.permute(*d))(o, 0, 2, 1, 3).reshape(B, Sq, H * Dh) @ wo
```

```asm
; @launch grid=(256,1,1) block=(256,1,1) lds=163840
.amdgcn_target "amdgcn-amd-amdhsa--gfx950"
.text
.globl standalone__mha_block_cached__near_ridge_kernel
.p2align 8
.type standalone__mha_block_cached__near_ridge_kernel,@function
standalone__mha_block_cached__near_ridge_kernel:
  s_cmp_ge_u32 s2, 256
  s_cbranch_scc1 L_done
  s_load_dwordx16 s[52:67], s[0:1], 0
  s_getpc_b64 s[4:5]
L_pc:
  s_lshl_b32 s6, s2, 9
  s_and_b32 s6, s6, 0x3000
  v_lshl_add_u32 v14, v0, 4, s6
  global_load_dword v15, v14, s[4:5] offset:512
  v_lshrrev_b32 v14, 6, v0
  v_and_b32 v0, 63, v0
  v_readfirstlane_b32 s28, v14
  s_and_b32 s39, s2, 7
  s_lshr_b32 s40, s2, 3
  s_and_b32 s29, s39, 1
  s_lshl_b32 s29, s29, 2
  s_and_b32 s41, s40, 3
  s_add_u32 s29, s29, s41
  s_lshr_b32 s30, s39, 1
  s_lshl_b32 s30, s30, 3
  s_lshr_b32 s42, s40, 2
  s_add_u32 s30, s30, s42
  s_mul_i32 s95, s41, 1
  s_add_u32 s95, s95, s42
  s_and_b32 s95, s95, 1
  s_mul_i32 s95, s95, 512
  s_mul_i32 s42, s42, 0
  s_mul_i32 s41, s41, 0
  s_add_u32 s33, s41, s42
  s_mul_i32 s39, s39, 128
  s_add_u32 s33, s33, s39
  s_and_b32 s99, s33, 2047
  s_mov_b32 s38, 0
  s_add_u32 s33, s95, s99
  s_and_b32 s33, s33, 2047
  s_lshl_b32 s34, s33, 12
  s_lshr_b32 s31, s28, 1
  s_and_b32 s32, s28, 1
  s_lshl_b32 s48, s28, 12
  s_add_u32 s49, s48, 16384
  s_add_u32 s37, s48, 28672
  s_mul_i32 s39, s31, 14336
  s_lshl_b32 s36, s32, 12
  s_add_u32 s36, s36, s39
  s_mul_i32 s3, s32, 3072
  s_add_u32 s3, s3, s39
  s_add_u32 s3, s3, 8192
  v_and_b32 v244, 15, v0
  v_lshrrev_b32 v245, 4, v0
  v_and_b32 v248, 7, v0
  v_xor_b32 v248, v248, v245
  v_lshrrev_b32 v249, 3, v0
  v_lshlrev_b32 v251, 11, v249
  v_lshl_add_u32 v248, v248, 4, v251
  s_lshl_b32 s39, s32, 16
  v_add_u32 v200, s39, v248
  v_xor_b32 v249, 64, v200
  v_add_u32 v201, 15360, v249
  v_add_u32 v202, 30720, v200
  v_add_u32 v203, 46080, v249
  s_lshl_b32 s39, s32, 6
  v_xor_b32 v248, s39, v248
  s_mul_i32 s39, s32, 49152
  s_add_u32 s39, s39, 131072
  v_add_u32 v204, s39, v248
  v_xor_b32 v249, 64, v204
  v_add_u32 v205, 15360, v249
  v_add_u32 v206, 30720, v204
  v_lshlrev_b32 v248, 2, v245
  v_xor_b32 v248, v248, v244
  v_lshlrev_b32 v249, 13, v245
  v_lshl_add_u32 v207, v248, 4, v249
  v_add_u32 v208, 31744, v207
  v_add_u32 v209, 63488, v207
  v_add_u32 v210, 95232, v207
  s_mul_i32 s39, s29, 458752
  s_mul_i32 s40, s31, 229376
  s_add_u32 s39, s39, s40
  s_lshl_b32 s40, s30, 8
  s_lshl_b32 s41, s28, 17
  s_add_u32 s40, s40, s41
  s_waitcnt lgkmcnt(0)
  s_add_u32 s8, s52, s39
  s_addc_u32 s9, s53, 0
  s_sub_u32 s10, 3670016, s39
  s_mov_b32 s11, 0x20000
  s_add_u32 s20, s58, s40
  s_addc_u32 s21, s59, 0
  s_sub_u32 s22, 8388608, s40
  s_mov_b32 s23, 0x20000
  s_add_u32 m0, 0, s37
  s_nop 0
  buffer_load_dwordx4 v207, s[20:23], s34 offen offset:0 lds
  buffer_load_dwordx4 v208, s[20:23], s34 offen offset:1024 lds
  buffer_load_dwordx4 v209, s[20:23], s34 offen offset:2048 lds
  buffer_load_dwordx4 v210, s[20:23], s34 offen offset:3072 lds
  s_add_u32 m0, 0, s36
  s_nop 0
  buffer_load_dwordx4 v200, s[8:11], s33 offen offset:0 lds
  buffer_load_dwordx4 v201, s[8:11], s33 offen offset:1024 lds
  buffer_load_dwordx4 v202, s[8:11], s33 offen offset:2048 lds
  buffer_load_dwordx4 v203, s[8:11], s33 offen offset:3072 lds
  s_lshl_b32 s39, s29, 5
  s_add_u32 s39, s39, s30
  s_lshl_b32 s39, s39, 18
  s_add_u32 s12, s54, s39
  s_addc_u32 s13, s55, 0
  s_mov_b32 s14, 262144
  s_mov_b32 s15, 0x20000
  s_add_u32 s16, s56, s39
  s_addc_u32 s17, s57, 0
  s_mov_b32 s18, 262144
  s_mov_b32 s19, 0x20000
  s_mov_b32 s24, s66
  s_mov_b32 s25, s67
  s_mov_b32 s26, 24117248
  s_mov_b32 s27, 0x20000
  s_mov_b32 s76, s62
  s_mov_b32 s77, s63
  s_mov_b32 s78, 3670016
  s_mov_b32 s79, 0x20000
  s_lshr_b32 s39, s2, 3
  s_mul_i32 s39, s39, 1
  s_and_b32 s40, s2, 7
  s_mul_i32 s40, s40, 2
  s_add_u32 s39, s39, s40
  s_and_b32 s39, s39, 15
  s_lshl_b32 s39, s39, 14
  s_add_u32 s94, s39, s48
  s_mov_b32 s35, 0x3ffe
  s_mul_i32 s39, s2, 37
  s_and_b32 s39, s39, 255
  s_mul_i32 s39, s39, 7
  s_lshr_b32 s39, s39, 8
  s_add_u32 s40, s39, 0
  s_cmp_ge_u32 s40, 7
  s_cselect_b32 s41, 7, 0
  s_sub_u32 s40, s40, s41
  s_add_u32 s40, s40, 7
  s_bitset0_b32 s35, s40
  s_add_u32 s40, s39, 3
  s_cmp_ge_u32 s40, 7
  s_cselect_b32 s41, 7, 0
  s_sub_u32 s40, s40, s41
  s_add_u32 s40, s40, 7
  s_bitset0_b32 s35, s40
  s_mov_b32 s47, 0
  s_mov_b32 s43, s94
  s_mov_b32 s50, 0x3e0293ee
  s_lshl_b32 s39, s29, 1
  s_add_u32 s39, s39, s31
  s_lshl_b32 s39, s39, 5
  s_add_u32 s39, s39, s30
  s_lshl_b32 s39, s39, 1
  s_add_u32 s39, s39, s32
  s_mul_i32 s51, s39, 14336
  s_lshl_b32 s39, s29, 5
  s_add_u32 s39, s39, s30
  s_lshr_b32 s91, s39, 2
  s_lshl_b32 s91, s91, 7
  s_and_b32 s40, s30, 3
  s_lshl_b32 s40, s40, 2
  s_add_u32 s91, s91, s40
  s_add_u32 s91, s91, 25165824
  s_lshl_b32 s39, s39, 2
  s_add_u32 s39, s39, s28
  s_mul_i32 s100, s39, 7168
  s_add_u32 s100, s100, 16777216
  s_lshl_b32 s101, s39, 7
  s_add_u32 s101, s101, 25231360
  s_bfe_u32 s44, s30, 0x10003
  s_and_b32 s42, s30, 7
  s_lshr_b32 s45, s30, 4
  s_lshl_b32 s45, s45, 3
  s_add_u32 s45, s45, s42
  s_lshr_b32 s40, s2, 3
  s_and_b32 s41, s29, 3
  s_lshl_b32 s93, s40, 14
  s_lshl_b32 s6, s42, 7
  s_sub_u32 s93, s93, s6
  s_mul_i32 s41, s41, 2
  s_mul_i32 s42, s42, 1
  s_add_u32 s46, s41, s42
  s_xor_b32 s40, s44, 1
  s_lshl_b32 s40, s40, 1
  s_add_u32 s40, s40, s32
  s_lshl_b32 s41, s31, 2
  s_add_u32 s40, s40, s41
  s_lshl_b32 s39, s29, 4
  s_add_u32 s39, s39, s40
  s_mul_i32 s39, s39, 114688
  s_add_u32 s72, s66, s39
  s_addc_u32 s73, s67, 0
  s_mov_b32 s74, 1032192
  s_mov_b32 s75, 0x20000
  s_lshl_b32 s92, s29, 3
  s_add_u32 s92, s92, s40
  s_lshl_b32 s92, s92, 7
  s_add_u32 s92, s92, 25165824
  s_lshl_b32 s40, s40, 20
  s_lshl_b32 s41, s45, 7
  s_add_u32 s40, s40, s41
  s_add_u32 s68, s60, s40
  s_addc_u32 s69, s61, 0
  s_sub_u32 s70, 8388608, s40
  s_mov_b32 s71, 0x20000
  s_lshl_b32 s39, s29, 1
  s_add_u32 s39, s39, s44
  s_mul_i32 s90, s39, 229376
  s_add_u32 s90, s90, s41
  s_lshl_b32 s40, s28, 5
  s_add_u32 s90, s90, s40
  s_add_u32 s39, s46, 0
  s_and_b32 s39, s39, 7
  s_lshl_b32 s80, s39, 16
  s_mul_i32 s52, s39, 7168
  s_add_u32 s39, s46, 1
  s_and_b32 s39, s39, 7
  s_lshl_b32 s81, s39, 16
  s_mul_i32 s53, s39, 7168
  s_add_u32 s39, s46, 2
  s_and_b32 s39, s39, 7
  s_lshl_b32 s82, s39, 16
  s_mul_i32 s54, s39, 7168
  s_add_u32 s39, s46, 3
  s_and_b32 s39, s39, 7
  s_lshl_b32 s83, s39, 16
  s_mul_i32 s55, s39, 7168
  s_add_u32 s39, s46, 4
  s_and_b32 s39, s39, 7
  s_lshl_b32 s84, s39, 16
  s_mul_i32 s56, s39, 7168
  s_add_u32 s39, s46, 5
  s_and_b32 s39, s39, 7
  s_lshl_b32 s85, s39, 16
  s_mul_i32 s57, s39, 7168
  s_add_u32 s39, s46, 6
  s_and_b32 s39, s39, 7
  s_lshl_b32 s86, s39, 16
  s_mul_i32 s58, s39, 7168
  s_add_u32 s39, s46, 7
  s_and_b32 s39, s39, 7
  s_lshl_b32 s87, s39, 16
  s_mul_i32 s59, s39, 7168
  s_lshl_b32 s88, s28, 13
  s_add_u32 s88, s88, 98304
  s_xor_b32 s42, s28, 1
  s_mul_i32 s89, s42, 28672
  s_cmp_eq_u32 s42, 3
  s_cselect_b32 s89, 131072, s89
  s_mul_i32 s7, s28, 28672
  s_cmp_eq_u32 s28, 3
  s_cselect_b32 s7, 131072, s7
  s_lshl_b32 s61, s28, 10
  s_add_u32 s61, s61, 86016
  v_lshlrev_b32 v248, 1, v245
  v_and_b32 v250, 7, v0
  v_xor_b32 v250, v248, v250
  v_lshl_add_u32 v3, v250, 4, v251
  v_xor_b32 v248, v248, v244
  v_lshlrev_b32 v249, 8, v245
  v_xor_b32 v250, 0, v248
  v_lshl_add_u32 v4, v250, 4, v249
  v_xor_b32 v250, 8, v248
  v_lshl_add_u32 v5, v250, 4, v249
  v_xor_b32 v250, 1, v248
  v_lshl_add_u32 v6, v250, 4, v249
  v_xor_b32 v250, 9, v248
  v_lshl_add_u32 v7, v250, 4, v249
  v_lshlrev_b32 v1, 4, v0
  v_bfe_u32 v246, v0, 2, 2
  v_and_b32 v247, 3, v0
  v_lshrrev_b32 v248, 1, v244
  v_xor_b32 v248, v248, v245
  s_mul_i32 s39, s31, 14336
  v_lshlrev_b32 v249, 7, v244
  v_add_u32 v249, s39, v249
  v_lshl_add_u32 v8, v248, 4, v249
  v_xor_b32 v9, 64, v8
  v_lshrrev_b32 v248, 1, v247
  v_and_b32 v249, 1, v247
  v_lshl_add_u32 v248, v249, 1, v248
  s_lshl_b32 s39, s32, 1
  v_xor_b32 v249, s39, v246
  v_lshl_add_u32 v248, v249, 2, v248
  v_lshl_add_u32 v249, v245, 3, v246
  v_lshlrev_b32 v249, 8, v249
  v_lshl_add_u32 v10, v248, 4, v249
  v_xor_b32 v11, 64, v10
  v_lshrrev_b32 v248, 1, v245
  v_and_b32 v249, 1, v245
  v_lshl_add_u32 v248, v249, 1, v248
  v_and_b32 v249, 7, v244
  v_lshrrev_b32 v250, 3, v244
  v_lshl_add_u32 v249, v249, 1, v250
  v_xor_b32 v248, v248, v249
  s_lshl_b32 s39, s32, 3
  v_xor_b32 v248, s39, v248
  s_lshl_b32 s40, s32, 13
  s_add_u32 s41, s40, 16384
  v_lshlrev_b32 v249, 8, v244
  v_add_u32 v249, s41, v249
  v_lshl_add_u32 v12, v248, 4, v249
  v_lshl_add_u32 v250, v245, 2, v246
  v_bfe_u32 v248, v250, 1, 2
  v_xor_b32 v248, s28, v248
  v_lshlrev_b32 v249, 7, v250
  v_lshl_add_u32 v249, v248, 5, v249
  v_lshl_add_u32 v231, v247, 3, v249
  v_and_b32 v248, 7, v250
  v_lshrrev_b32 v249, 3, v250
  v_lshl_add_u32 v248, v248, 1, v249
  v_bfe_u32 v249, v0, 1, 1
  v_xor_b32 v248, v248, v249
  v_xor_b32 v248, s39, v248
  v_lshlrev_b32 v250, 8, v250
  v_add_u32 v250, s40, v250
  v_lshl_add_u32 v250, v248, 4, v250
  v_and_b32 v249, 1, v0
  v_lshl_add_u32 v13, v249, 3, v250
  v_mov_b32 v232, v8
  v_mov_b32 v234, v10
  v_mov_b32 v233, v9
  v_mov_b32 v235, v11
  v_accvgpr_write_b32 a80, 0
  v_accvgpr_write_b32 a81, 0
  v_accvgpr_write_b32 a82, 0
  v_accvgpr_write_b32 a83, 0
  v_accvgpr_write_b32 a84, 0
  v_accvgpr_write_b32 a85, 0
  v_accvgpr_write_b32 a86, 0
  v_accvgpr_write_b32 a87, 0
  v_accvgpr_write_b32 a88, 0
  v_accvgpr_write_b32 a89, 0
  v_accvgpr_write_b32 a90, 0
  v_accvgpr_write_b32 a91, 0
  v_accvgpr_write_b32 a92, 0
  v_accvgpr_write_b32 a93, 0
  v_accvgpr_write_b32 a94, 0
  v_accvgpr_write_b32 a95, 0
  v_accvgpr_write_b32 a96, 0
  v_accvgpr_write_b32 a97, 0
  v_accvgpr_write_b32 a98, 0
  v_accvgpr_write_b32 a99, 0
  v_accvgpr_write_b32 a100, 0
  v_accvgpr_write_b32 a101, 0
  v_accvgpr_write_b32 a102, 0
  v_accvgpr_write_b32 a103, 0
  v_accvgpr_write_b32 a104, 0
  v_accvgpr_write_b32 a105, 0
  v_accvgpr_write_b32 a106, 0
  v_accvgpr_write_b32 a107, 0
  v_accvgpr_write_b32 a108, 0
  v_accvgpr_write_b32 a109, 0
  v_accvgpr_write_b32 a110, 0
  v_accvgpr_write_b32 a111, 0
  v_add_u32 v236, 131072, v13
  v_xor_b32 v237, 32, v236
  v_xor_b32 v238, 64, v236
  v_xor_b32 v239, 96, v236
  v_xor_b32 v240, 128, v236
  v_xor_b32 v241, 160, v236
  v_xor_b32 v242, 192, v236
  v_xor_b32 v243, 224, v236
  s_mul_i32 s41, s28, 14336
  v_add_u32 v14, s41, v1
  s_mul_i32 s42, s42, 14336
  v_add_u32 v2, s42, v1
  v_add_u32 v253, s48, v1
  v_add_u32 v211, 0x10000, v253
  v_add_u32 v216, 0x20000, v253
  s_lshl_b32 s6, s28, 12
  s_add_u32 s6, s6, L_trans-L_pc
  v_lshl_add_u32 v215, v0, 6, s6
  s_add_u32 s62, s2, 0
  s_and_b32 s62, s62, 255
  s_mul_i32 s62, s62, 6
  s_lshr_b32 s62, s62, 8
  s_add_u32 s62, s62, 5
  s_lshl_b32 s62, s62, 14
  s_add_u32 s62, s62, s94
  s_and_b32 s62, s62, 0x3ffff
  s_add_u32 s63, s2, 128
  s_and_b32 s63, s63, 255
  s_mul_i32 s63, s63, 6
  s_lshr_b32 s63, s63, 8
  s_add_u32 s63, s63, 5
  s_lshl_b32 s63, s63, 14
  s_add_u32 s63, s63, s94
  s_and_b32 s63, s63, 0x3ffff
  v_and_b32 v254, 15, v0
  v_lshlrev_b32 v254, 7, v254
  s_add_u32 m0, 0, s3
  s_nop 0
  buffer_load_dwordx4 v204, s[8:11], s33 offen offset:0 lds
  buffer_load_dwordx4 v205, s[8:11], s33 offen offset:1024 lds
  buffer_load_dwordx4 v206, s[8:11], s33 offen offset:2048 lds
  s_add_u32 s38, s38, 128
  s_xor_b32 s33, s38, s95
  s_add_u32 s33, s33, s99
  s_and_b32 s33, s33, 2047
  s_lshl_b32 s34, s33, 12
  s_add_u32 m0, 90112, s37
  s_nop 0
  buffer_load_dwordx4 v207, s[20:23], s34 offen offset:0 lds
  buffer_load_dwordx4 v208, s[20:23], s34 offen offset:1024 lds
  buffer_load_dwordx4 v209, s[20:23], s34 offen offset:2048 lds
  buffer_load_dwordx4 v210, s[20:23], s34 offen offset:3072 lds
  s_add_u32 m0, 90112, s36
  s_nop 0
  buffer_load_dwordx4 v200, s[8:11], s33 offen offset:0 lds
  buffer_load_dwordx4 v201, s[8:11], s33 offen offset:1024 lds
  buffer_load_dwordx4 v202, s[8:11], s33 offen offset:2048 lds
  buffer_load_dwordx4 v203, s[8:11], s33 offen offset:3072 lds
  s_add_u32 m0, 90112, s3
  s_nop 0
  buffer_load_dwordx4 v204, s[8:11], s33 offen offset:0 lds
  buffer_load_dwordx4 v205, s[8:11], s33 offen offset:1024 lds
  buffer_load_dwordx4 v206, s[8:11], s33 offen offset:2048 lds
  s_add_u32 s38, s38, 128
  s_xor_b32 s33, s38, s95
  s_add_u32 s33, s33, s99
  s_and_b32 s33, s33, 2047
  s_lshl_b32 s34, s33, 12
  s_waitcnt vmcnt(14)
  s_barrier
  ds_read_b64_tr_b16 a[112:113], v234 offset:28672
  ds_read_b64_tr_b16 a[114:115], v234 offset:29696
  ds_read_b128 a[176:179], v232 offset:0
  ds_read_b64_tr_b16 a[116:117], v234 offset:28680
  ds_read_b64_tr_b16 a[118:119], v234 offset:29704
  ds_read_b64_tr_b16 a[120:121], v235 offset:28672
  ds_read_b64_tr_b16 a[122:123], v235 offset:29696
  ds_read_b64_tr_b16 a[124:125], v235 offset:28680
  ds_read_b64_tr_b16 a[126:127], v235 offset:29704
  ds_read_b64_tr_b16 a[128:129], v234 offset:36864
  ds_read_b64_tr_b16 a[130:131], v234 offset:37888
  ds_read_b64_tr_b16 a[132:133], v234 offset:36872
  ds_read_b64_tr_b16 a[134:135], v234 offset:37896
  ds_read_b64_tr_b16 a[136:137], v235 offset:36864
  ds_read_b64_tr_b16 a[138:139], v235 offset:37888
  ds_read_b64_tr_b16 a[140:141], v235 offset:36872
  ds_read_b64_tr_b16 a[142:143], v235 offset:37896
  ds_read_b128 a[180:183], v233 offset:0
  ds_read_b128 a[184:187], v232 offset:2048
  ds_read_b128 a[188:191], v233 offset:2048
  ds_read_b128 a[192:195], v232 offset:4096
  ds_read_b128 a[196:199], v233 offset:4096
  ds_read_b128 a[200:203], v232 offset:6144
  ds_read_b128 a[204:207], v233 offset:6144
  v_add_u32 v234, 90112, v10
  v_add_u32 v235, 90112, v11
  s_waitcnt lgkmcnt(0) vmcnt(7)
  s_barrier
  v_mfma_f32_16x16x32_bf16 v[16:19], a[112:115], a[176:179], 0
  s_add_u32 m0, 45056, s37
  ds_read_b128 a[208:211], v232 offset:8192
  v_mfma_f32_16x16x32_bf16 v[16:19], a[128:131], a[180:183], v[16:19]
  ds_read_b128 a[212:215], v233 offset:8192
  buffer_load_dwordx4 v207, s[20:23], s34 offen offset:0 lds
  v_mfma_f32_16x16x32_bf16 v[20:23], a[116:119], a[176:179], 0
  ds_read_b128 a[216:219], v232 offset:10240
  v_mfma_f32_16x16x32_bf16 v[20:23], a[132:135], a[180:183], v[20:23]
  ds_read_b128 a[220:223], v233 offset:10240
  v_mfma_f32_16x16x32_bf16 v[24:27], a[120:123], a[176:179], 0
  buffer_load_dwordx4 v208, s[20:23], s34 offen offset:1024 lds
  v_mfma_f32_16x16x32_bf16 v[24:27], a[136:139], a[180:183], v[24:27]
  ds_read_b128 a[224:227], v232 offset:12288
  v_mfma_f32_16x16x32_bf16 v[28:31], a[124:127], a[176:179], 0
  ds_read_b128 a[228:231], v233 offset:12288
  v_mfma_f32_16x16x32_bf16 v[28:31], a[140:143], a[180:183], v[28:31]
  buffer_load_dwordx4 v209, s[20:23], s34 offen offset:2048 lds
  v_mfma_f32_16x16x32_bf16 v[32:35], a[112:115], a[184:187], 0
  ds_read_b64_tr_b16 a[144:145], v234 offset:28672
  v_add_u32 v232, 90112, v8
  v_mfma_f32_16x16x32_bf16 v[32:35], a[128:131], a[188:191], v[32:35]
  ds_read_b64_tr_b16 a[146:147], v234 offset:29696
  v_add_u32 v233, 90112, v9
  v_mfma_f32_16x16x32_bf16 v[36:39], a[116:119], a[184:187], 0
  buffer_load_dwordx4 v210, s[20:23], s34 offen offset:3072 lds
  v_mfma_f32_16x16x32_bf16 v[36:39], a[132:135], a[188:191], v[36:39]
  ds_read_b64_tr_b16 a[148:149], v234 offset:28680
  v_mfma_f32_16x16x32_bf16 v[40:43], a[120:123], a[184:187], 0
  s_add_u32 m0, 45056, s36
  ds_read_b64_tr_b16 a[150:151], v234 offset:29704
  v_mfma_f32_16x16x32_bf16 v[40:43], a[136:139], a[188:191], v[40:43]
  buffer_load_dwordx4 v200, s[8:11], s33 offen offset:0 lds
  v_mfma_f32_16x16x32_bf16 v[44:47], a[124:127], a[184:187], 0
  ds_read_b64_tr_b16 a[152:153], v235 offset:28672
  v_mfma_f32_16x16x32_bf16 v[44:47], a[140:143], a[188:191], v[44:47]
  ds_read_b64_tr_b16 a[154:155], v235 offset:29696
  v_mfma_f32_16x16x32_bf16 v[48:51], a[112:115], a[192:195], 0
  ds_read_b64_tr_b16 a[156:157], v235 offset:28680
  v_mfma_f32_16x16x32_bf16 v[48:51], a[128:131], a[196:199], v[48:51]
  buffer_load_dwordx4 v201, s[8:11], s33 offen offset:1024 lds
  v_mfma_f32_16x16x32_bf16 v[52:55], a[116:119], a[192:195], 0
  ds_read_b64_tr_b16 a[158:159], v235 offset:29704
  v_mfma_f32_16x16x32_bf16 v[52:55], a[132:135], a[196:199], v[52:55]
  ds_read_b64_tr_b16 a[160:161], v234 offset:36864
  v_mfma_f32_16x16x32_bf16 v[56:59], a[120:123], a[192:195], 0
  buffer_load_dwordx4 v202, s[8:11], s33 offen offset:2048 lds
  v_mfma_f32_16x16x32_bf16 v[56:59], a[136:139], a[196:199], v[56:59]
  ds_read_b64_tr_b16 a[162:163], v234 offset:37888
  v_mfma_f32_16x16x32_bf16 v[60:63], a[124:127], a[192:195], 0
  ds_read_b64_tr_b16 a[164:165], v234 offset:36872
  v_mfma_f32_16x16x32_bf16 v[60:63], a[140:143], a[196:199], v[60:63]
  buffer_load_dwordx4 v203, s[8:11], s33 offen offset:3072 lds
  v_mfma_f32_16x16x32_bf16 v[64:67], a[112:115], a[200:203], 0
  ds_read_b64_tr_b16 a[166:167], v234 offset:37896
  v_mfma_f32_16x16x32_bf16 v[64:67], a[128:131], a[204:207], v[64:67]
  s_add_u32 m0, 45056, s3
  ds_read_b64_tr_b16 a[168:169], v235 offset:36864
  v_mfma_f32_16x16x32_bf16 v[68:71], a[116:119], a[200:203], 0
  buffer_load_dwordx4 v204, s[8:11], s33 offen offset:0 lds
  v_mfma_f32_16x16x32_bf16 v[68:71], a[132:135], a[204:207], v[68:71]
  ds_read_b64_tr_b16 a[170:171], v235 offset:37888
  v_mfma_f32_16x16x32_bf16 v[72:75], a[120:123], a[200:203], 0
  ds_read_b64_tr_b16 a[172:173], v235 offset:36872
  v_mfma_f32_16x16x32_bf16 v[72:75], a[136:139], a[204:207], v[72:75]
  ds_read_b64_tr_b16 a[174:175], v235 offset:37896
  v_mfma_f32_16x16x32_bf16 v[76:79], a[124:127], a[200:203], 0
  v_mfma_f32_16x16x32_bf16 v[76:79], a[140:143], a[204:207], v[76:79]
  s_waitcnt lgkmcnt(0) vmcnt(12)
  s_barrier
  v_mfma_f32_16x16x32_bf16 v[80:83], a[112:115], a[208:211], 0
  ds_read_b128 a[176:179], v232 offset:0
  v_add_u32 v234, 45056, v10
  v_mfma_f32_16x16x32_bf16 v[80:83], a[128:131], a[212:215], v[80:83]
  buffer_load_dwordx4 v205, s[8:11], s33 offen offset:1024 lds
  v_mfma_f32_16x16x32_bf16 v[84:87], a[116:119], a[208:211], 0
  ds_read_b128 a[180:183], v233 offset:0
  v_add_u32 v235, 45056, v11
  v_mfma_f32_16x16x32_bf16 v[84:87], a[132:135], a[212:215], v[84:87]
  buffer_load_dwordx4 v206, s[8:11], s33 offen offset:2048 lds
  v_mfma_f32_16x16x32_bf16 v[88:91], a[120:123], a[208:211], 0
  s_add_u32 s38, s38, 128
  s_xor_b32 s33, s38, s95
  ds_read_b128 a[184:187], v232 offset:2048
  v_mfma_f32_16x16x32_bf16 v[88:91], a[136:139], a[212:215], v[88:91]
  s_add_u32 s33, s33, s99
  s_and_b32 s33, s33, 2047
  s_add_u32 m0, 0, s37
  ds_read_b128 a[188:191], v233 offset:2048
  v_mfma_f32_16x16x32_bf16 v[92:95], a[124:127], a[208:211], 0
  s_lshl_b32 s34, s33, 12
  buffer_load_dwordx4 v207, s[20:23], s34 offen offset:0 lds
  v_mfma_f32_16x16x32_bf16 v[92:95], a[140:143], a[212:215], v[92:95]
  ds_read_b128 a[192:195], v232 offset:4096
  v_mfma_f32_16x16x32_bf16 v[128:131], a[112:115], a[216:219], 0
  buffer_load_dwordx4 v208, s[20:23], s34 offen offset:1024 lds
  v_mfma_f32_16x16x32_bf16 v[128:131], a[128:131], a[220:223], v[128:131]
  ds_read_b128 a[196:199], v233 offset:4096
  v_mfma_f32_16x16x32_bf16 v[132:135], a[116:119], a[216:219], 0
  ds_read_b128 a[200:203], v232 offset:6144
  v_mfma_f32_16x16x32_bf16 v[132:135], a[132:135], a[220:223], v[132:135]
  buffer_load_dwordx4 v209, s[20:23], s34 offen offset:2048 lds
  v_mfma_f32_16x16x32_bf16 v[136:139], a[120:123], a[216:219], 0
  ds_read_b128 a[204:207], v233 offset:6144
  v_mfma_f32_16x16x32_bf16 v[136:139], a[136:139], a[220:223], v[136:139]
  v_mfma_f32_16x16x32_bf16 v[140:143], a[124:127], a[216:219], 0
  buffer_load_dwordx4 v210, s[20:23], s34 offen offset:3072 lds
  v_mfma_f32_16x16x32_bf16 v[140:143], a[140:143], a[220:223], v[140:143]
  s_add_u32 m0, 0, s36
  v_mfma_f32_16x16x32_bf16 v[144:147], a[112:115], a[224:227], 0
  buffer_load_dwordx4 v200, s[8:11], s33 offen offset:0 lds
  v_mfma_f32_16x16x32_bf16 v[144:147], a[128:131], a[228:231], v[144:147]
  v_mfma_f32_16x16x32_bf16 v[148:151], a[116:119], a[224:227], 0
  v_mfma_f32_16x16x32_bf16 v[148:151], a[132:135], a[228:231], v[148:151]
  buffer_load_dwordx4 v201, s[8:11], s33 offen offset:1024 lds
  v_mfma_f32_16x16x32_bf16 v[152:155], a[120:123], a[224:227], 0
  v_mfma_f32_16x16x32_bf16 v[152:155], a[136:139], a[228:231], v[152:155]
  v_mfma_f32_16x16x32_bf16 v[156:159], a[124:127], a[224:227], 0
  v_mfma_f32_16x16x32_bf16 v[156:159], a[140:143], a[228:231], v[156:159]
  s_waitcnt lgkmcnt(0) vmcnt(13)
  s_barrier
  v_mfma_f32_16x16x32_bf16 v[16:19], a[144:147], a[176:179], v[16:19]
  ds_read_b128 a[208:211], v232 offset:8192
  v_mfma_f32_16x16x32_bf16 v[16:19], a[160:163], a[180:183], v[16:19]
  ds_read_b128 a[212:215], v233 offset:8192
  buffer_load_dwordx4 v202, s[8:11], s33 offen offset:2048 lds
  v_mfma_f32_16x16x32_bf16 v[20:23], a[148:151], a[176:179], v[20:23]
  ds_read_b128 a[216:219], v232 offset:10240
  v_mfma_f32_16x16x32_bf16 v[20:23], a[164:167], a[180:183], v[20:23]
  ds_read_b128 a[220:223], v233 offset:10240
  v_mfma_f32_16x16x32_bf16 v[24:27], a[152:155], a[176:179], v[24:27]
  buffer_load_dwordx4 v203, s[8:11], s33 offen offset:3072 lds
  v_mfma_f32_16x16x32_bf16 v[24:27], a[168:171], a[180:183], v[24:27]
  ds_read_b128 a[224:227], v232 offset:12288
  v_mfma_f32_16x16x32_bf16 v[28:31], a[156:159], a[176:179], v[28:31]
  s_add_u32 m0, 0, s3
  ds_read_b128 a[228:231], v233 offset:12288
  v_mfma_f32_16x16x32_bf16 v[28:31], a[172:175], a[180:183], v[28:31]
  buffer_load_dwordx4 v204, s[8:11], s33 offen offset:0 lds
  v_mfma_f32_16x16x32_bf16 v[32:35], a[144:147], a[184:187], v[32:35]
  ds_read_b64_tr_b16 a[112:113], v234 offset:28672
  v_add_u32 v232, 45056, v8
  v_mfma_f32_16x16x32_bf16 v[32:35], a[160:163], a[188:191], v[32:35]
  ds_read_b64_tr_b16 a[114:115], v234 offset:29696
  v_add_u32 v233, 45056, v9
  v_mfma_f32_16x16x32_bf16 v[36:39], a[148:151], a[184:187], v[36:39]
  buffer_load_dwordx4 v205, s[8:11], s33 offen offset:1024 lds
  v_mfma_f32_16x16x32_bf16 v[36:39], a[164:167], a[188:191], v[36:39]
  ds_read_b64_tr_b16 a[116:117], v234 offset:28680
  v_mfma_f32_16x16x32_bf16 v[40:43], a[152:155], a[184:187], v[40:43]
  ds_read_b64_tr_b16 a[118:119], v234 offset:29704
  v_mfma_f32_16x16x32_bf16 v[40:43], a[168:171], a[188:191], v[40:43]
  buffer_load_dwordx4 v206, s[8:11], s33 offen offset:2048 lds
  v_mfma_f32_16x16x32_bf16 v[44:47], a[156:159], a[184:187], v[44:47]
  s_add_u32 s38, s38, 128
  s_xor_b32 s33, s38, s95
  ds_read_b64_tr_b16 a[120:121], v235 offset:28672
  v_mfma_f32_16x16x32_bf16 v[44:47], a[172:175], a[188:191], v[44:47]
  s_add_u32 s33, s33, s99
  s_and_b32 s33, s33, 2047
  ds_read_b64_tr_b16 a[122:123], v235 offset:29696
  v_mfma_f32_16x16x32_bf16 v[48:51], a[144:147], a[192:195], v[48:51]
  s_lshl_b32 s34, s33, 12
  s_add_u32 m0, 90112, s37
  ds_read_b64_tr_b16 a[124:125], v235 offset:28680
  v_mfma_f32_16x16x32_bf16 v[48:51], a[160:163], a[196:199], v[48:51]
  buffer_load_dwordx4 v207, s[20:23], s34 offen offset:0 lds
  v_mfma_f32_16x16x32_bf16 v[52:55], a[148:151], a[192:195], v[52:55]
  ds_read_b64_tr_b16 a[126:127], v235 offset:29704
  v_mfma_f32_16x16x32_bf16 v[52:55], a[164:167], a[196:199], v[52:55]
  ds_read_b64_tr_b16 a[128:129], v234 offset:36864
  v_mfma_f32_16x16x32_bf16 v[56:59], a[152:155], a[192:195], v[56:59]
  buffer_load_dwordx4 v208, s[20:23], s34 offen offset:1024 lds
  v_mfma_f32_16x16x32_bf16 v[56:59], a[168:171], a[196:199], v[56:59]
  ds_read_b64_tr_b16 a[130:131], v234 offset:37888
  v_mfma_f32_16x16x32_bf16 v[60:63], a[156:159], a[192:195], v[60:63]
  ds_read_b64_tr_b16 a[132:133], v234 offset:36872
  v_mfma_f32_16x16x32_bf16 v[60:63], a[172:175], a[196:199], v[60:63]
  buffer_load_dwordx4 v209, s[20:23], s34 offen offset:2048 lds
  v_mfma_f32_16x16x32_bf16 v[64:67], a[144:147], a[200:203], v[64:67]
  ds_read_b64_tr_b16 a[134:135], v234 offset:37896
  v_mfma_f32_16x16x32_bf16 v[64:67], a[160:163], a[204:207], v[64:67]
  ds_read_b64_tr_b16 a[136:137], v235 offset:36864
  v_mfma_f32_16x16x32_bf16 v[68:71], a[148:151], a[200:203], v[68:71]
  buffer_load_dwordx4 v210, s[20:23], s34 offen offset:3072 lds
  v_mfma_f32_16x16x32_bf16 v[68:71], a[164:167], a[204:207], v[68:71]
  ds_read_b64_tr_b16 a[138:139], v235 offset:37888
  v_mfma_f32_16x16x32_bf16 v[72:75], a[152:155], a[200:203], v[72:75]
  ds_read_b64_tr_b16 a[140:141], v235 offset:36872
  v_mfma_f32_16x16x32_bf16 v[72:75], a[168:171], a[204:207], v[72:75]
  ds_read_b64_tr_b16 a[142:143], v235 offset:37896
  v_mfma_f32_16x16x32_bf16 v[76:79], a[156:159], a[200:203], v[76:79]
  v_mfma_f32_16x16x32_bf16 v[76:79], a[172:175], a[204:207], v[76:79]
  s_waitcnt lgkmcnt(0) vmcnt(18)
  s_barrier
  v_mfma_f32_16x16x32_bf16 v[80:83], a[144:147], a[208:211], v[80:83]
  s_add_u32 m0, 131072, s49
  ds_read_b128 a[176:179], v232 offset:0
  v_mfma_f32_16x16x32_bf16 v[80:83], a[160:163], a[212:215], v[80:83]
  buffer_load_dwordx4 v4, s[12:15], s94 offen offset:0 nt lds
  v_mfma_f32_16x16x32_bf16 v[84:87], a[148:151], a[208:211], v[84:87]
  buffer_load_dwordx4 v5, s[12:15], s94 offen offset:1024 nt lds
  v_mfma_f32_16x16x32_bf16 v[84:87], a[164:167], a[212:215], v[84:87]
  ds_read_b128 a[180:183], v233 offset:0
  v_add_u32 v234, 0, v10
  v_mfma_f32_16x16x32_bf16 v[88:91], a[152:155], a[208:211], v[88:91]
  buffer_load_dwordx4 v6, s[12:15], s94 offen offset:2048 nt lds
  v_mfma_f32_16x16x32_bf16 v[88:91], a[168:171], a[212:215], v[88:91]
  ds_read_b128 a[184:187], v232 offset:2048
  v_add_u32 v235, 0, v11
  v_mfma_f32_16x16x32_bf16 v[92:95], a[156:159], a[208:211], v[92:95]
  buffer_load_dwordx4 v7, s[12:15], s94 offen offset:3072 nt lds
  v_mfma_f32_16x16x32_bf16 v[92:95], a[172:175], a[212:215], v[92:95]
  s_add_u32 m0, 90112, s36
  ds_read_b128 a[188:191], v233 offset:2048
  v_mfma_f32_16x16x32_bf16 v[128:131], a[144:147], a[216:219], v[128:131]
  buffer_load_dwordx4 v200, s[8:11], s33 offen offset:0 lds
  v_mfma_f32_16x16x32_bf16 v[128:131], a[160:163], a[220:223], v[128:131]
  buffer_load_dwordx4 v201, s[8:11], s33 offen offset:1024 lds
  v_mfma_f32_16x16x32_bf16 v[132:135], a[148:151], a[216:219], v[132:135]
  ds_read_b128 a[192:195], v232 offset:4096
  v_mfma_f32_16x16x32_bf16 v[132:135], a[164:167], a[220:223], v[132:135]
  buffer_load_dwordx4 v202, s[8:11], s33 offen offset:2048 lds
  v_mfma_f32_16x16x32_bf16 v[136:139], a[152:155], a[216:219], v[136:139]
  ds_read_b128 a[196:199], v233 offset:4096
  v_mfma_f32_16x16x32_bf16 v[136:139], a[168:171], a[220:223], v[136:139]
  buffer_load_dwordx4 v203, s[8:11], s33 offen offset:3072 lds
  v_mfma_f32_16x16x32_bf16 v[140:143], a[156:159], a[216:219], v[140:143]
  s_add_u32 m0, 90112, s3
  ds_read_b128 a[200:203], v232 offset:6144
  v_mfma_f32_16x16x32_bf16 v[140:143], a[172:175], a[220:223], v[140:143]
  buffer_load_dwordx4 v204, s[8:11], s33 offen offset:0 lds
  v_mfma_f32_16x16x32_bf16 v[144:147], a[144:147], a[224:227], v[144:147]
  buffer_load_dwordx4 v205, s[8:11], s33 offen offset:1024 lds
  v_mfma_f32_16x16x32_bf16 v[144:147], a[160:163], a[228:231], v[144:147]
  ds_read_b128 a[204:207], v233 offset:6144
  v_mfma_f32_16x16x32_bf16 v[148:151], a[148:151], a[224:227], v[148:151]
  buffer_load_dwordx4 v206, s[8:11], s33 offen offset:2048 lds
  v_mfma_f32_16x16x32_bf16 v[148:151], a[164:167], a[228:231], v[148:151]
  s_add_u32 s38, s38, 128
  s_xor_b32 s33, s38, s95
  s_add_u32 m0, 45056, s37
  v_mfma_f32_16x16x32_bf16 v[152:155], a[152:155], a[224:227], v[152:155]
  s_add_u32 s33, s33, s99
  s_and_b32 s33, s33, 2047
  s_lshl_b32 s34, s33, 12
  buffer_load_dwordx4 v207, s[20:23], s34 offen offset:0 lds
  v_mfma_f32_16x16x32_bf16 v[152:155], a[168:171], a[228:231], v[152:155]
  v_mfma_f32_16x16x32_bf16 v[156:159], a[156:159], a[224:227], v[156:159]
  v_mfma_f32_16x16x32_bf16 v[156:159], a[172:175], a[228:231], v[156:159]
  s_waitcnt lgkmcnt(0) vmcnt(23)
  s_barrier
  v_mfma_f32_16x16x32_bf16 v[16:19], a[112:115], a[176:179], v[16:19]
  ds_read_b128 a[208:211], v232 offset:8192
  v_mfma_f32_16x16x32_bf16 v[16:19], a[128:131], a[180:183], v[16:19]
  buffer_load_dwordx4 v208, s[20:23], s34 offen offset:1024 lds
  v_mfma_f32_16x16x32_bf16 v[20:23], a[116:119], a[176:179], v[20:23]
  ds_read_b128 a[212:215], v233 offset:8192
  v_mfma_f32_16x16x32_bf16 v[20:23], a[132:135], a[180:183], v[20:23]
  ds_read_b128 a[216:219], v232 offset:10240
  v_mfma_f32_16x16x32_bf16 v[24:27], a[120:123], a[176:179], v[24:27]
  ds_read_b128 a[220:223], v233 offset:10240
  v_mfma_f32_16x16x32_bf16 v[24:27], a[136:139], a[180:183], v[24:27]
  buffer_load_dwordx4 v209, s[20:23], s34 offen offset:2048 lds
  v_mfma_f32_16x16x32_bf16 v[28:31], a[124:127], a[176:179], v[28:31]
  ds_read_b128 a[224:227], v232 offset:12288
  v_mfma_f32_16x16x32_bf16 v[28:31], a[140:143], a[180:183], v[28:31]
  ds_read_b128 a[228:231], v233 offset:12288
  v_mfma_f32_16x16x32_bf16 v[32:35], a[112:115], a[184:187], v[32:35]
  ds_read_b64_tr_b16 a[144:145], v234 offset:28672
  v_add_u32 v232, 0, v8
  v_mfma_f32_16x16x32_bf16 v[32:35], a[128:131], a[188:191], v[32:35]
  buffer_load_dwordx4 v210, s[20:23], s34 offen offset:3072 lds
  v_mfma_f32_16x16x32_bf16 v[36:39], a[116:119], a[184:187], v[36:39]
  ds_read_b64_tr_b16 a[146:147], v234 offset:29696
  v_add_u32 v233, 0, v9
  v_mfma_f32_16x16x32_bf16 v[36:39], a[132:135], a[188:191], v[36:39]
  ds_read_b64_tr_b16 a[148:149], v234 offset:28680
  v_mfma_f32_16x16x32_bf16 v[40:43], a[120:123], a[184:187], v[40:43]
  s_add_u32 m0, 45056, s36
  ds_read_b64_tr_b16 a[150:151], v234 offset:29704
  v_mfma_f32_16x16x32_bf16 v[40:43], a[136:139], a[188:191], v[40:43]
  buffer_load_dwordx4 v200, s[8:11], s33 offen offset:0 lds
  v_mfma_f32_16x16x32_bf16 v[44:47], a[124:127], a[184:187], v[44:47]
  ds_read_b64_tr_b16 a[152:153], v235 offset:28672
  v_mfma_f32_16x16x32_bf16 v[44:47], a[140:143], a[188:191], v[44:47]
  ds_read_b64_tr_b16 a[154:155], v235 offset:29696
  v_mfma_f32_16x16x32_bf16 v[48:51], a[112:115], a[192:195], v[48:51]
  ds_read_b64_tr_b16 a[156:157], v235 offset:28680
  v_mfma_f32_16x16x32_bf16 v[48:51], a[128:131], a[196:199], v[48:51]
  buffer_load_dwordx4 v201, s[8:11], s33 offen offset:1024 lds
  v_mfma_f32_16x16x32_bf16 v[52:55], a[116:119], a[192:195], v[52:55]
  ds_read_b64_tr_b16 a[158:159], v235 offset:29704
  v_mfma_f32_16x16x32_bf16 v[52:55], a[132:135], a[196:199], v[52:55]
  ds_read_b64_tr_b16 a[160:161], v234 offset:36864
  v_mfma_f32_16x16x32_bf16 v[56:59], a[120:123], a[192:195], v[56:59]
  ds_read_b64_tr_b16 a[162:163], v234 offset:37888
  v_mfma_f32_16x16x32_bf16 v[56:59], a[136:139], a[196:199], v[56:59]
  buffer_load_dwordx4 v202, s[8:11], s33 offen offset:2048 lds
  v_mfma_f32_16x16x32_bf16 v[60:63], a[124:127], a[192:195], v[60:63]
  ds_read_b64_tr_b16 a[164:165], v234 offset:36872
  v_mfma_f32_16x16x32_bf16 v[60:63], a[140:143], a[196:199], v[60:63]
  ds_read_b64_tr_b16 a[166:167], v234 offset:37896
  v_mfma_f32_16x16x32_bf16 v[64:67], a[112:115], a[200:203], v[64:67]
  ds_read_b64_tr_b16 a[168:169], v235 offset:36864
  v_mfma_f32_16x16x32_bf16 v[64:67], a[128:131], a[204:207], v[64:67]
  buffer_load_dwordx4 v203, s[8:11], s33 offen offset:3072 lds
  v_mfma_f32_16x16x32_bf16 v[68:71], a[116:119], a[200:203], v[68:71]
  ds_read_b64_tr_b16 a[170:171], v235 offset:37888
  v_mfma_f32_16x16x32_bf16 v[68:71], a[132:135], a[204:207], v[68:71]
  ds_read_b64_tr_b16 a[172:173], v235 offset:36872
  v_mfma_f32_16x16x32_bf16 v[72:75], a[120:123], a[200:203], v[72:75]
  ds_read_b64_tr_b16 a[174:175], v235 offset:37896
  v_mfma_f32_16x16x32_bf16 v[72:75], a[136:139], a[204:207], v[72:75]
  v_mfma_f32_16x16x32_bf16 v[76:79], a[124:127], a[200:203], v[76:79]
  v_mfma_f32_16x16x32_bf16 v[76:79], a[140:143], a[204:207], v[76:79]
  s_waitcnt lgkmcnt(0) vmcnt(26)
  s_barrier
  v_mfma_f32_16x16x32_bf16 v[80:83], a[112:115], a[208:211], v[80:83]
  s_add_u32 m0, 45056, s3
  ds_read_b128 a[176:179], v232 offset:0
  v_mfma_f32_16x16x32_bf16 v[80:83], a[128:131], a[212:215], v[80:83]
  buffer_load_dwordx4 v204, s[8:11], s33 offen offset:0 lds
  v_mfma_f32_16x16x32_bf16 v[84:87], a[116:119], a[208:211], v[84:87]
  ds_read_b128 a[180:183], v233 offset:0
  v_add_u32 v234, 90112, v10
  v_mfma_f32_16x16x32_bf16 v[84:87], a[132:135], a[212:215], v[84:87]
  ds_read_b128 a[184:187], v232 offset:2048
  v_add_u32 v235, 90112, v11
  v_mfma_f32_16x16x32_bf16 v[88:91], a[120:123], a[208:211], v[88:91]
  ds_read_b128 a[188:191], v233 offset:2048
  v_mfma_f32_16x16x32_bf16 v[88:91], a[136:139], a[212:215], v[88:91]
  buffer_load_dwordx4 v205, s[8:11], s33 offen offset:1024 lds
  v_mfma_f32_16x16x32_bf16 v[92:95], a[124:127], a[208:211], v[92:95]
  ds_read_b128 a[192:195], v232 offset:4096
  v_mfma_f32_16x16x32_bf16 v[92:95], a[140:143], a[212:215], v[92:95]
  ds_read_b128 a[196:199], v233 offset:4096
  v_mfma_f32_16x16x32_bf16 v[128:131], a[112:115], a[216:219], v[128:131]
  ds_read_b128 a[200:203], v232 offset:6144
  v_mfma_f32_16x16x32_bf16 v[128:131], a[128:131], a[220:223], v[128:131]
  buffer_load_dwordx4 v206, s[8:11], s33 offen offset:2048 lds
  v_mfma_f32_16x16x32_bf16 v[132:135], a[116:119], a[216:219], v[132:135]
  s_add_u32 s38, s38, 128
  s_xor_b32 s33, s38, s95
  ds_read_b128 a[204:207], v233 offset:6144
  v_mfma_f32_16x16x32_bf16 v[132:135], a[132:135], a[220:223], v[132:135]
  s_add_u32 s33, s33, s99
  s_and_b32 s33, s33, 2047
  v_mfma_f32_16x16x32_bf16 v[136:139], a[120:123], a[216:219], v[136:139]
  s_lshl_b32 s34, s33, 12
  s_add_u32 m0, 0, s37
  v_mfma_f32_16x16x32_bf16 v[136:139], a[136:139], a[220:223], v[136:139]
  buffer_load_dwordx4 v207, s[20:23], s34 offen offset:0 lds
  v_mfma_f32_16x16x32_bf16 v[140:143], a[124:127], a[216:219], v[140:143]
  v_mfma_f32_16x16x32_bf16 v[140:143], a[140:143], a[220:223], v[140:143]
  v_mfma_f32_16x16x32_bf16 v[144:147], a[112:115], a[224:227], v[144:147]
  v_mfma_f32_16x16x32_bf16 v[144:147], a[128:131], a[228:231], v[144:147]
  buffer_load_dwordx4 v208, s[20:23], s34 offen offset:1024 lds
  v_mfma_f32_16x16x32_bf16 v[148:151], a[116:119], a[224:227], v[148:151]
  v_mfma_f32_16x16x32_bf16 v[148:151], a[132:135], a[228:231], v[148:151]
  v_mfma_f32_16x16x32_bf16 v[152:155], a[120:123], a[224:227], v[152:155]
  v_mfma_f32_16x16x32_bf16 v[152:155], a[136:139], a[228:231], v[152:155]
  v_mfma_f32_16x16x32_bf16 v[156:159], a[124:127], a[224:227], v[156:159]
  v_mfma_f32_16x16x32_bf16 v[156:159], a[140:143], a[228:231], v[156:159]
  s_waitcnt lgkmcnt(0) vmcnt(24)
  s_barrier
  v_mfma_f32_16x16x32_bf16 v[16:19], a[144:147], a[176:179], v[16:19]
  ds_read_b128 a[208:211], v232 offset:8192
  v_mfma_f32_16x16x32_bf16 v[16:19], a[160:163], a[180:183], v[16:19]
  buffer_load_dwordx4 v209, s[20:23], s34 offen offset:2048 lds
  v_mfma_f32_16x16x32_bf16 v[20:23], a[148:151], a[176:179], v[20:23]
  ds_read_b128 a[212:215], v233 offset:8192
  v_mfma_f32_16x16x32_bf16 v[20:23], a[164:167], a[180:183], v[20:23]
  ds_read_b128 a[216:219], v232 offset:10240
  v_mfma_f32_16x16x32_bf16 v[24:27], a[152:155], a[176:179], v[24:27]
  ds_read_b128 a[220:223], v233 offset:10240
  v_mfma_f32_16x16x32_bf16 v[24:27], a[168:171], a[180:183], v[24:27]
  buffer_load_dwordx4 v210, s[20:23], s34 offen offset:3072 lds
  v_mfma_f32_16x16x32_bf16 v[28:31], a[156:159], a[176:179], v[28:31]
  ds_read_b128 a[224:227], v232 offset:12288
  v_mfma_f32_16x16x32_bf16 v[28:31], a[172:175], a[180:183], v[28:31]
  ds_read_b128 a[228:231], v233 offset:12288
  v_mfma_f32_16x16x32_bf16 v[32:35], a[144:147], a[184:187], v[32:35]
  ds_read_b64_tr_b16 a[112:113], v234 offset:28672
  v_add_u32 v232, 90112, v8
  v_mfma_f32_16x16x32_bf16 v[32:35], a[160:163], a[188:191], v[32:35]
  s_add_u32 m0, 0, s36
  ds_read_b64_tr_b16 a[114:115], v234 offset:29696
  v_mfma_f32_16x16x32_bf16 v[36:39], a[148:151], a[184:187], v[36:39]
  buffer_load_dwordx4 v200, s[8:11], s33 offen offset:0 lds
  v_mfma_f32_16x16x32_bf16 v[36:39], a[164:167], a[188:191], v[36:39]
  ds_read_b64_tr_b16 a[116:117], v234 offset:28680
  v_add_u32 v233, 90112, v9
  v_mfma_f32_16x16x32_bf16 v[40:43], a[152:155], a[184:187], v[40:43]
  ds_read_b64_tr_b16 a[118:119], v234 offset:29704
  v_mfma_f32_16x16x32_bf16 v[40:43], a[168:171], a[188:191], v[40:43]
  ds_read_b64_tr_b16 a[120:121], v235 offset:28672
  v_mfma_f32_16x16x32_bf16 v[44:47], a[156:159], a[184:187], v[44:47]
  ds_read_b64_tr_b16 a[122:123], v235 offset:29696
  v_mfma_f32_16x16x32_bf16 v[44:47], a[172:175], a[188:191], v[44:47]
  buffer_load_dwordx4 v201, s[8:11], s33 offen offset:1024 lds
  v_mfma_f32_16x16x32_bf16 v[48:51], a[144:147], a[192:195], v[48:51]
  ds_read_b64_tr_b16 a[124:125], v235 offset:28680
  v_mfma_f32_16x16x32_bf16 v[48:51], a[160:163], a[196:199], v[48:51]
  ds_read_b64_tr_b16 a[126:127], v235 offset:29704
  v_mfma_f32_16x16x32_bf16 v[52:55], a[148:151], a[192:195], v[52:55]
  ds_read_b64_tr_b16 a[128:129], v234 offset:36864
  v_mfma_f32_16x16x32_bf16 v[52:55], a[164:167], a[196:199], v[52:55]
  ds_read_b64_tr_b16 a[130:131], v234 offset:37888
  v_mfma_f32_16x16x32_bf16 v[56:59], a[152:155], a[192:195], v[56:59]
  buffer_load_dwordx4 v202, s[8:11], s33 offen offset:2048 lds
  v_mfma_f32_16x16x32_bf16 v[56:59], a[168:171], a[196:199], v[56:59]
  ds_read_b64_tr_b16 a[132:133], v234 offset:36872
  v_mfma_f32_16x16x32_bf16 v[60:63], a[156:159], a[192:195], v[60:63]
  ds_read_b64_tr_b16 a[134:135], v234 offset:37896
  v_mfma_f32_16x16x32_bf16 v[60:63], a[172:175], a[196:199], v[60:63]
  ds_read_b64_tr_b16 a[136:137], v235 offset:36864
  v_mfma_f32_16x16x32_bf16 v[64:67], a[144:147], a[200:203], v[64:67]
  ds_read_b64_tr_b16 a[138:139], v235 offset:37888
  v_mfma_f32_16x16x32_bf16 v[64:67], a[160:163], a[204:207], v[64:67]
  buffer_load_dwordx4 v203, s[8:11], s33 offen offset:3072 lds
  v_mfma_f32_16x16x32_bf16 v[68:71], a[148:151], a[200:203], v[68:71]
  ds_read_b64_tr_b16 a[140:141], v235 offset:36872
  v_mfma_f32_16x16x32_bf16 v[68:71], a[164:167], a[204:207], v[68:71]
  ds_read_b64_tr_b16 a[142:143], v235 offset:37896
  v_mfma_f32_16x16x32_bf16 v[72:75], a[152:155], a[200:203], v[72:75]
  v_mfma_f32_16x16x32_bf16 v[72:75], a[168:171], a[204:207], v[72:75]
  v_mfma_f32_16x16x32_bf16 v[76:79], a[156:159], a[200:203], v[76:79]
  v_mfma_f32_16x16x32_bf16 v[76:79], a[172:175], a[204:207], v[76:79]
  s_waitcnt lgkmcnt(0) vmcnt(22)
  s_barrier
  v_mfma_f32_16x16x32_bf16 v[80:83], a[144:147], a[208:211], v[80:83]
  s_add_u32 m0, 0, s3
  ds_read_b128 a[176:179], v232 offset:0
  v_mfma_f32_16x16x32_bf16 v[80:83], a[160:163], a[212:215], v[80:83]
  buffer_load_dwordx4 v204, s[8:11], s33 offen offset:0 lds
  v_mfma_f32_16x16x32_bf16 v[84:87], a[148:151], a[208:211], v[84:87]
  ds_read_b128 a[180:183], v233 offset:0
  v_add_u32 v234, 45056, v10
  v_mfma_f32_16x16x32_bf16 v[84:87], a[164:167], a[212:215], v[84:87]
  ds_read_b128 a[184:187], v232 offset:2048
  v_add_u32 v235, 45056, v11
  v_mfma_f32_16x16x32_bf16 v[88:91], a[152:155], a[208:211], v[88:91]
  ds_read_b128 a[188:191], v233 offset:2048
  v_mfma_f32_16x16x32_bf16 v[88:91], a[168:171], a[212:215], v[88:91]
  buffer_load_dwordx4 v205, s[8:11], s33 offen offset:1024 lds
  v_mfma_f32_16x16x32_bf16 v[92:95], a[156:159], a[208:211], v[92:95]
  ds_read_b128 a[192:195], v232 offset:4096
  v_mfma_f32_16x16x32_bf16 v[92:95], a[172:175], a[212:215], v[92:95]
  ds_read_b128 a[196:199], v233 offset:4096
  v_mfma_f32_16x16x32_bf16 v[128:131], a[144:147], a[216:219], v[128:131]
  ds_read_b128 a[200:203], v232 offset:6144
  v_mfma_f32_16x16x32_bf16 v[128:131], a[160:163], a[220:223], v[128:131]
  buffer_load_dwordx4 v206, s[8:11], s33 offen offset:2048 lds
  v_mfma_f32_16x16x32_bf16 v[132:135], a[148:151], a[216:219], v[132:135]
  s_add_u32 s38, s38, 128
  s_xor_b32 s33, s38, s95
  ds_read_b128 a[204:207], v233 offset:6144
  v_mfma_f32_16x16x32_bf16 v[132:135], a[164:167], a[220:223], v[132:135]
  s_add_u32 s33, s33, s99
  s_and_b32 s33, s33, 2047
  v_mfma_f32_16x16x32_bf16 v[136:139], a[152:155], a[216:219], v[136:139]
  s_lshl_b32 s34, s33, 12
  s_add_u32 m0, 90112, s37
  v_mfma_f32_16x16x32_bf16 v[136:139], a[168:171], a[220:223], v[136:139]
  buffer_load_dwordx4 v207, s[20:23], s34 offen offset:0 lds
  v_mfma_f32_16x16x32_bf16 v[140:143], a[156:159], a[216:219], v[140:143]
  v_mfma_f32_16x16x32_bf16 v[140:143], a[172:175], a[220:223], v[140:143]
  v_mfma_f32_16x16x32_bf16 v[144:147], a[144:147], a[224:227], v[144:147]
  v_mfma_f32_16x16x32_bf16 v[144:147], a[160:163], a[228:231], v[144:147]
  buffer_load_dwordx4 v208, s[20:23], s34 offen offset:1024 lds
  v_mfma_f32_16x16x32_bf16 v[148:151], a[148:151], a[224:227], v[148:151]
  v_mfma_f32_16x16x32_bf16 v[148:151], a[164:167], a[228:231], v[148:151]
  v_mfma_f32_16x16x32_bf16 v[152:155], a[152:155], a[224:227], v[152:155]
  v_mfma_f32_16x16x32_bf16 v[152:155], a[168:171], a[228:231], v[152:155]
  v_mfma_f32_16x16x32_bf16 v[156:159], a[156:159], a[224:227], v[156:159]
  v_mfma_f32_16x16x32_bf16 v[156:159], a[172:175], a[228:231], v[156:159]
  s_waitcnt lgkmcnt(0) vmcnt(20)
  s_barrier
  v_mfma_f32_16x16x32_bf16 v[16:19], a[112:115], a[176:179], v[16:19]
  ds_read_b128 a[208:211], v232 offset:8192
  v_mfma_f32_16x16x32_bf16 v[16:19], a[128:131], a[180:183], v[16:19]
  buffer_load_dwordx4 v209, s[20:23], s34 offen offset:2048 lds
  v_mfma_f32_16x16x32_bf16 v[20:23], a[116:119], a[176:179], v[20:23]
  ds_read_b128 a[212:215], v233 offset:8192
  v_mfma_f32_16x16x32_bf16 v[20:23], a[132:135], a[180:183], v[20:23]
  ds_read_b128 a[216:219], v232 offset:10240
  v_mfma_f32_16x16x32_bf16 v[24:27], a[120:123], a[176:179], v[24:27]
  ds_read_b128 a[220:223], v233 offset:10240
  v_mfma_f32_16x16x32_bf16 v[24:27], a[136:139], a[180:183], v[24:27]
  buffer_load_dwordx4 v210, s[20:23], s34 offen offset:3072 lds
  v_mfma_f32_16x16x32_bf16 v[28:31], a[124:127], a[176:179], v[28:31]
  ds_read_b128 a[224:227], v232 offset:12288
  v_mfma_f32_16x16x32_bf16 v[28:31], a[140:143], a[180:183], v[28:31]
  ds_read_b128 a[228:231], v233 offset:12288
  v_mfma_f32_16x16x32_bf16 v[32:35], a[112:115], a[184:187], v[32:35]
  ds_read_b64_tr_b16 a[144:145], v234 offset:28672
  v_add_u32 v232, 45056, v8
  v_mfma_f32_16x16x32_bf16 v[32:35], a[128:131], a[188:191], v[32:35]
  s_add_u32 m0, 90112, s36
  ds_read_b64_tr_b16 a[146:147], v234 offset:29696
  v_mfma_f32_16x16x32_bf16 v[36:39], a[116:119], a[184:187], v[36:39]
  buffer_load_dwordx4 v200, s[8:11], s33 offen offset:0 lds
  v_mfma_f32_16x16x32_bf16 v[36:39], a[132:135], a[188:191], v[36:39]
  ds_read_b64_tr_b16 a[148:149], v234 offset:28680
  v_add_u32 v233, 45056, v9
  v_mfma_f32_16x16x32_bf16 v[40:43], a[120:123], a[184:187], v[40:43]
  ds_read_b64_tr_b16 a[150:151], v234 offset:29704
  v_mfma_f32_16x16x32_bf16 v[40:43], a[136:139], a[188:191], v[40:43]
  ds_read_b64_tr_b16 a[152:153], v235 offset:28672
  v_mfma_f32_16x16x32_bf16 v[44:47], a[124:127], a[184:187], v[44:47]
  ds_read_b64_tr_b16 a[154:155], v235 offset:29696
  v_mfma_f32_16x16x32_bf16 v[44:47], a[140:143], a[188:191], v[44:47]
  buffer_load_dwordx4 v201, s[8:11], s33 offen offset:1024 lds
  v_mfma_f32_16x16x32_bf16 v[48:51], a[112:115], a[192:195], v[48:51]
  ds_read_b64_tr_b16 a[156:157], v235 offset:28680
  v_mfma_f32_16x16x32_bf16 v[48:51], a[128:131], a[196:199], v[48:51]
  ds_read_b64_tr_b16 a[158:159], v235 offset:29704
  v_mfma_f32_16x16x32_bf16 v[52:55], a[116:119], a[192:195], v[52:55]
  ds_read_b64_tr_b16 a[160:161], v234 offset:36864
  v_mfma_f32_16x16x32_bf16 v[52:55], a[132:135], a[196:199], v[52:55]
  ds_read_b64_tr_b16 a[162:163], v234 offset:37888
  v_mfma_f32_16x16x32_bf16 v[56:59], a[120:123], a[192:195], v[56:59]
  buffer_load_dwordx4 v202, s[8:11], s33 offen offset:2048 lds
  v_mfma_f32_16x16x32_bf16 v[56:59], a[136:139], a[196:199], v[56:59]
  ds_read_b64_tr_b16 a[164:165], v234 offset:36872
  v_mfma_f32_16x16x32_bf16 v[60:63], a[124:127], a[192:195], v[60:63]
  ds_read_b64_tr_b16 a[166:167], v234 offset:37896
  v_mfma_f32_16x16x32_bf16 v[60:63], a[140:143], a[196:199], v[60:63]
  ds_read_b64_tr_b16 a[168:169], v235 offset:36864
  v_mfma_f32_16x16x32_bf16 v[64:67], a[112:115], a[200:203], v[64:67]
  ds_read_b64_tr_b16 a[170:171], v235 offset:37888
  v_mfma_f32_16x16x32_bf16 v[64:67], a[128:131], a[204:207], v[64:67]
  buffer_load_dwordx4 v203, s[8:11], s33 offen offset:3072 lds
  v_mfma_f32_16x16x32_bf16 v[68:71], a[116:119], a[200:203], v[68:71]
  ds_read_b64_tr_b16 a[172:173], v235 offset:36872
  v_mfma_f32_16x16x32_bf16 v[68:71], a[132:135], a[204:207], v[68:71]
  ds_read_b64_tr_b16 a[174:175], v235 offset:37896
  v_mfma_f32_16x16x32_bf16 v[72:75], a[120:123], a[200:203], v[72:75]
  v_mfma_f32_16x16x32_bf16 v[72:75], a[136:139], a[204:207], v[72:75]
  v_mfma_f32_16x16x32_bf16 v[76:79], a[124:127], a[200:203], v[76:79]
  v_mfma_f32_16x16x32_bf16 v[76:79], a[140:143], a[204:207], v[76:79]
  s_waitcnt lgkmcnt(0) vmcnt(22)
  s_barrier
  v_mfma_f32_16x16x32_bf16 v[80:83], a[112:115], a[208:211], v[80:83]
  s_add_u32 m0, 90112, s3
  ds_read_b128 a[176:179], v232 offset:0
  v_mfma_f32_16x16x32_bf16 v[80:83], a[128:131], a[212:215], v[80:83]
  buffer_load_dwordx4 v204, s[8:11], s33 offen offset:0 lds
  v_mfma_f32_16x16x32_bf16 v[84:87], a[116:119], a[208:211], v[84:87]
  ds_read_b128 a[180:183], v233 offset:0
  v_add_u32 v234, 0, v10
  v_mfma_f32_16x16x32_bf16 v[84:87], a[132:135], a[212:215], v[84:87]
  ds_read_b128 a[184:187], v232 offset:2048
  v_add_u32 v235, 0, v11
  v_mfma_f32_16x16x32_bf16 v[88:91], a[120:123], a[208:211], v[88:91]
  ds_read_b128 a[188:191], v233 offset:2048
  v_mfma_f32_16x16x32_bf16 v[88:91], a[136:139], a[212:215], v[88:91]
  buffer_load_dwordx4 v205, s[8:11], s33 offen offset:1024 lds
  v_mfma_f32_16x16x32_bf16 v[92:95], a[124:127], a[208:211], v[92:95]
  ds_read_b128 a[192:195], v232 offset:4096
  v_mfma_f32_16x16x32_bf16 v[92:95], a[140:143], a[212:215], v[92:95]
  ds_read_b128 a[196:199], v233 offset:4096
  v_mfma_f32_16x16x32_bf16 v[128:131], a[112:115], a[216:219], v[128:131]
  ds_read_b128 a[200:203], v232 offset:6144
  v_mfma_f32_16x16x32_bf16 v[128:131], a[128:131], a[220:223], v[128:131]
  buffer_load_dwordx4 v206, s[8:11], s33 offen offset:2048 lds
  v_mfma_f32_16x16x32_bf16 v[132:135], a[116:119], a[216:219], v[132:135]
  s_add_u32 s38, s38, 128
  s_xor_b32 s33, s38, s95
  ds_read_b128 a[204:207], v233 offset:6144
  v_mfma_f32_16x16x32_bf16 v[132:135], a[132:135], a[220:223], v[132:135]
  s_add_u32 s33, s33, s99
  s_and_b32 s33, s33, 2047
  v_mfma_f32_16x16x32_bf16 v[136:139], a[120:123], a[216:219], v[136:139]
  s_lshl_b32 s34, s33, 12
  s_add_u32 m0, 45056, s37
  v_mfma_f32_16x16x32_bf16 v[136:139], a[136:139], a[220:223], v[136:139]
  buffer_load_dwordx4 v207, s[20:23], s34 offen offset:0 lds
  v_mfma_f32_16x16x32_bf16 v[140:143], a[124:127], a[216:219], v[140:143]
  v_mfma_f32_16x16x32_bf16 v[140:143], a[140:143], a[220:223], v[140:143]
  v_mfma_f32_16x16x32_bf16 v[144:147], a[112:115], a[224:227], v[144:147]
  v_mfma_f32_16x16x32_bf16 v[144:147], a[128:131], a[228:231], v[144:147]
  buffer_load_dwordx4 v208, s[20:23], s34 offen offset:1024 lds
  v_mfma_f32_16x16x32_bf16 v[148:151], a[116:119], a[224:227], v[148:151]
  v_mfma_f32_16x16x32_bf16 v[148:151], a[132:135], a[228:231], v[148:151]
  v_mfma_f32_16x16x32_bf16 v[152:155], a[120:123], a[224:227], v[152:155]
  v_mfma_f32_16x16x32_bf16 v[152:155], a[136:139], a[228:231], v[152:155]
  v_mfma_f32_16x16x32_bf16 v[156:159], a[124:127], a[224:227], v[156:159]
  v_mfma_f32_16x16x32_bf16 v[156:159], a[140:143], a[228:231], v[156:159]
  s_waitcnt lgkmcnt(0) vmcnt(20)
  s_barrier
  v_mfma_f32_16x16x32_bf16 v[16:19], a[144:147], a[176:179], v[16:19]
  ds_read_b128 a[208:211], v232 offset:8192
  v_mfma_f32_16x16x32_bf16 v[16:19], a[160:163], a[180:183], v[16:19]
  buffer_load_dwordx4 v209, s[20:23], s34 offen offset:2048 lds
  v_mfma_f32_16x16x32_bf16 v[20:23], a[148:151], a[176:179], v[20:23]
  ds_read_b128 a[212:215], v233 offset:8192
  v_mfma_f32_16x16x32_bf16 v[20:23], a[164:167], a[180:183], v[20:23]
  ds_read_b128 a[216:219], v232 offset:10240
  v_mfma_f32_16x16x32_bf16 v[24:27], a[152:155], a[176:179], v[24:27]
  ds_read_b128 a[220:223], v233 offset:10240
  v_mfma_f32_16x16x32_bf16 v[24:27], a[168:171], a[180:183], v[24:27]
  buffer_load_dwordx4 v210, s[20:23], s34 offen offset:3072 lds
  v_mfma_f32_16x16x32_bf16 v[28:31], a[156:159], a[176:179], v[28:31]
  ds_read_b128 a[224:227], v232 offset:12288
  v_mfma_f32_16x16x32_bf16 v[28:31], a[172:175], a[180:183], v[28:31]
  ds_read_b128 a[228:231], v233 offset:12288
  v_mfma_f32_16x16x32_bf16 v[32:35], a[144:147], a[184:187], v[32:35]
  ds_read_b64_tr_b16 a[112:113], v234 offset:28672
  v_add_u32 v232, 0, v8
  v_mfma_f32_16x16x32_bf16 v[32:35], a[160:163], a[188:191], v[32:35]
  s_add_u32 m0, 45056, s36
  ds_read_b64_tr_b16 a[114:115], v234 offset:29696
  v_mfma_f32_16x16x32_bf16 v[36:39], a[148:151], a[184:187], v[36:39]
  buffer_load_dwordx4 v200, s[8:11], s33 offen offset:0 lds
  v_mfma_f32_16x16x32_bf16 v[36:39], a[164:167], a[188:191], v[36:39]
  ds_read_b64_tr_b16 a[116:117], v234 offset:28680
  v_add_u32 v233, 0, v9
  v_mfma_f32_16x16x32_bf16 v[40:43], a[152:155], a[184:187], v[40:43]
  ds_read_b64_tr_b16 a[118:119], v234 offset:29704
  v_mfma_f32_16x16x32_bf16 v[40:43], a[168:171], a[188:191], v[40:43]
  ds_read_b64_tr_b16 a[120:121], v235 offset:28672
  v_mfma_f32_16x16x32_bf16 v[44:47], a[156:159], a[184:187], v[44:47]
  ds_read_b64_tr_b16 a[122:123], v235 offset:29696
  v_mfma_f32_16x16x32_bf16 v[44:47], a[172:175], a[188:191], v[44:47]
  buffer_load_dwordx4 v201, s[8:11], s33 offen offset:1024 lds
  v_mfma_f32_16x16x32_bf16 v[48:51], a[144:147], a[192:195], v[48:51]
  ds_read_b64_tr_b16 a[124:125], v235 offset:28680
  v_mfma_f32_16x16x32_bf16 v[48:51], a[160:163], a[196:199], v[48:51]
  ds_read_b64_tr_b16 a[126:127], v235 offset:29704
  v_mfma_f32_16x16x32_bf16 v[52:55], a[148:151], a[192:195], v[52:55]
  ds_read_b64_tr_b16 a[128:129], v234 offset:36864
  v_mfma_f32_16x16x32_bf16 v[52:55], a[164:167], a[196:199], v[52:55]
  ds_read_b64_tr_b16 a[130:131], v234 offset:37888
  v_mfma_f32_16x16x32_bf16 v[56:59], a[152:155], a[192:195], v[56:59]
  buffer_load_dwordx4 v202, s[8:11], s33 offen offset:2048 lds
  v_mfma_f32_16x16x32_bf16 v[56:59], a[168:171], a[196:199], v[56:59]
  ds_read_b64_tr_b16 a[132:133], v234 offset:36872
  v_mfma_f32_16x16x32_bf16 v[60:63], a[156:159], a[192:195], v[60:63]
  ds_read_b64_tr_b16 a[134:135], v234 offset:37896
  v_mfma_f32_16x16x32_bf16 v[60:63], a[172:175], a[196:199], v[60:63]
  ds_read_b64_tr_b16 a[136:137], v235 offset:36864
  v_mfma_f32_16x16x32_bf16 v[64:67], a[144:147], a[200:203], v[64:67]
  ds_read_b64_tr_b16 a[138:139], v235 offset:37888
  v_mfma_f32_16x16x32_bf16 v[64:67], a[160:163], a[204:207], v[64:67]
  buffer_load_dwordx4 v203, s[8:11], s33 offen offset:3072 lds
  v_mfma_f32_16x16x32_bf16 v[68:71], a[148:151], a[200:203], v[68:71]
  ds_read_b64_tr_b16 a[140:141], v235 offset:36872
  v_mfma_f32_16x16x32_bf16 v[68:71], a[164:167], a[204:207], v[68:71]
  ds_read_b64_tr_b16 a[142:143], v235 offset:37896
  v_mfma_f32_16x16x32_bf16 v[72:75], a[152:155], a[200:203], v[72:75]
  v_mfma_f32_16x16x32_bf16 v[72:75], a[168:171], a[204:207], v[72:75]
  v_mfma_f32_16x16x32_bf16 v[76:79], a[156:159], a[200:203], v[76:79]
  v_mfma_f32_16x16x32_bf16 v[76:79], a[172:175], a[204:207], v[76:79]
  s_waitcnt lgkmcnt(0) vmcnt(22)
  s_barrier
  v_mfma_f32_16x16x32_bf16 v[80:83], a[144:147], a[208:211], v[80:83]
  s_add_u32 m0, 45056, s3
  ds_read_b128 a[176:179], v232 offset:0
  v_mfma_f32_16x16x32_bf16 v[80:83], a[160:163], a[212:215], v[80:83]
  buffer_load_dwordx4 v204, s[8:11], s33 offen offset:0 lds
  v_mfma_f32_16x16x32_bf16 v[84:87], a[148:151], a[208:211], v[84:87]
  ds_read_b128 a[180:183], v233 offset:0
  v_add_u32 v234, 90112, v10
  v_mfma_f32_16x16x32_bf16 v[84:87], a[164:167], a[212:215], v[84:87]
  ds_read_b128 a[184:187], v232 offset:2048
  v_add_u32 v235, 90112, v11
  v_mfma_f32_16x16x32_bf16 v[88:91], a[152:155], a[208:211], v[88:91]
  ds_read_b128 a[188:191], v233 offset:2048
  v_mfma_f32_16x16x32_bf16 v[88:91], a[168:171], a[212:215], v[88:91]
  buffer_load_dwordx4 v205, s[8:11], s33 offen offset:1024 lds
  v_mfma_f32_16x16x32_bf16 v[92:95], a[156:159], a[208:211], v[92:95]
  ds_read_b128 a[192:195], v232 offset:4096
  v_mfma_f32_16x16x32_bf16 v[92:95], a[172:175], a[212:215], v[92:95]
  ds_read_b128 a[196:199], v233 offset:4096
  v_mfma_f32_16x16x32_bf16 v[128:131], a[144:147], a[216:219], v[128:131]
  ds_read_b128 a[200:203], v232 offset:6144
  v_mfma_f32_16x16x32_bf16 v[128:131], a[160:163], a[220:223], v[128:131]
  buffer_load_dwordx4 v206, s[8:11], s33 offen offset:2048 lds
  v_mfma_f32_16x16x32_bf16 v[132:135], a[148:151], a[216:219], v[132:135]
  s_add_u32 s38, s38, 128
  s_xor_b32 s33, s38, s95
  ds_read_b128 a[204:207], v233 offset:6144
  v_mfma_f32_16x16x32_bf16 v[132:135], a[164:167], a[220:223], v[132:135]
  s_add_u32 s33, s33, s99
  s_and_b32 s33, s33, 2047
  v_mfma_f32_16x16x32_bf16 v[136:139], a[152:155], a[216:219], v[136:139]
  s_lshl_b32 s34, s33, 12
  s_add_u32 m0, 0, s37
  v_mfma_f32_16x16x32_bf16 v[136:139], a[168:171], a[220:223], v[136:139]
  buffer_load_dwordx4 v207, s[20:23], s34 offen offset:0 lds
  v_mfma_f32_16x16x32_bf16 v[140:143], a[156:159], a[216:219], v[140:143]
  v_mfma_f32_16x16x32_bf16 v[140:143], a[172:175], a[220:223], v[140:143]
  v_mfma_f32_16x16x32_bf16 v[144:147], a[144:147], a[224:227], v[144:147]
  v_mfma_f32_16x16x32_bf16 v[144:147], a[160:163], a[228:231], v[144:147]
  buffer_load_dwordx4 v208, s[20:23], s34 offen offset:1024 lds
  v_mfma_f32_16x16x32_bf16 v[148:151], a[148:151], a[224:227], v[148:151]
  v_mfma_f32_16x16x32_bf16 v[148:151], a[164:167], a[228:231], v[148:151]
  v_mfma_f32_16x16x32_bf16 v[152:155], a[152:155], a[224:227], v[152:155]
  v_mfma_f32_16x16x32_bf16 v[152:155], a[168:171], a[228:231], v[152:155]
  v_mfma_f32_16x16x32_bf16 v[156:159], a[156:159], a[224:227], v[156:159]
  v_mfma_f32_16x16x32_bf16 v[156:159], a[172:175], a[228:231], v[156:159]
  s_waitcnt lgkmcnt(0) vmcnt(20)
  s_barrier
  v_mfma_f32_16x16x32_bf16 v[16:19], a[112:115], a[176:179], v[16:19]
  ds_read_b128 a[208:211], v232 offset:8192
  v_mfma_f32_16x16x32_bf16 v[16:19], a[128:131], a[180:183], v[16:19]
  buffer_load_dwordx4 v209, s[20:23], s34 offen offset:2048 lds
  v_mfma_f32_16x16x32_bf16 v[20:23], a[116:119], a[176:179], v[20:23]
  ds_read_b128 a[212:215], v233 offset:8192
  v_mfma_f32_16x16x32_bf16 v[20:23], a[132:135], a[180:183], v[20:23]
  ds_read_b128 a[216:219], v232 offset:10240
  v_mfma_f32_16x16x32_bf16 v[24:27], a[120:123], a[176:179], v[24:27]
  ds_read_b128 a[220:223], v233 offset:10240
  v_mfma_f32_16x16x32_bf16 v[24:27], a[136:139], a[180:183], v[24:27]
  buffer_load_dwordx4 v210, s[20:23], s34 offen offset:3072 lds
  v_mfma_f32_16x16x32_bf16 v[28:31], a[124:127], a[176:179], v[28:31]
  ds_read_b128 a[224:227], v232 offset:12288
  v_mfma_f32_16x16x32_bf16 v[28:31], a[140:143], a[180:183], v[28:31]
  ds_read_b128 a[228:231], v233 offset:12288
  v_mfma_f32_16x16x32_bf16 v[32:35], a[112:115], a[184:187], v[32:35]
  ds_read_b64_tr_b16 a[144:145], v234 offset:28672
  v_add_u32 v232, 90112, v8
  v_mfma_f32_16x16x32_bf16 v[32:35], a[128:131], a[188:191], v[32:35]
  s_add_u32 m0, 0, s36
  ds_read_b64_tr_b16 a[146:147], v234 offset:29696
  v_mfma_f32_16x16x32_bf16 v[36:39], a[116:119], a[184:187], v[36:39]
  buffer_load_dwordx4 v200, s[8:11], s33 offen offset:0 lds
  v_mfma_f32_16x16x32_bf16 v[36:39], a[132:135], a[188:191], v[36:39]
  ds_read_b64_tr_b16 a[148:149], v234 offset:28680
  v_add_u32 v233, 90112, v9
  v_mfma_f32_16x16x32_bf16 v[40:43], a[120:123], a[184:187], v[40:43]
  ds_read_b64_tr_b16 a[150:151], v234 offset:29704
  v_mfma_f32_16x16x32_bf16 v[40:43], a[136:139], a[188:191], v[40:43]
  ds_read_b64_tr_b16 a[152:153], v235 offset:28672
  v_mfma_f32_16x16x32_bf16 v[44:47], a[124:127], a[184:187], v[44:47]
  ds_read_b64_tr_b16 a[154:155], v235 offset:29696
  v_mfma_f32_16x16x32_bf16 v[44:47], a[140:143], a[188:191], v[44:47]
  buffer_load_dwordx4 v201, s[8:11], s33 offen offset:1024 lds
  v_mfma_f32_16x16x32_bf16 v[48:51], a[112:115], a[192:195], v[48:51]
  ds_read_b64_tr_b16 a[156:157], v235 offset:28680
  v_mfma_f32_16x16x32_bf16 v[48:51], a[128:131], a[196:199], v[48:51]
  ds_read_b64_tr_b16 a[158:159], v235 offset:29704
  v_mfma_f32_16x16x32_bf16 v[52:55], a[116:119], a[192:195], v[52:55]
  ds_read_b64_tr_b16 a[160:161], v234 offset:36864
  v_mfma_f32_16x16x32_bf16 v[52:55], a[132:135], a[196:199], v[52:55]
  ds_read_b64_tr_b16 a[162:163], v234 offset:37888
  v_mfma_f32_16x16x32_bf16 v[56:59], a[120:123], a[192:195], v[56:59]
  buffer_load_dwordx4 v202, s[8:11], s33 offen offset:2048 lds
  v_mfma_f32_16x16x32_bf16 v[56:59], a[136:139], a[196:199], v[56:59]
  ds_read_b64_tr_b16 a[164:165], v234 offset:36872
  v_mfma_f32_16x16x32_bf16 v[60:63], a[124:127], a[192:195], v[60:63]
  ds_read_b64_tr_b16 a[166:167], v234 offset:37896
  v_mfma_f32_16x16x32_bf16 v[60:63], a[140:143], a[196:199], v[60:63]
  ds_read_b64_tr_b16 a[168:169], v235 offset:36864
  v_mfma_f32_16x16x32_bf16 v[64:67], a[112:115], a[200:203], v[64:67]
  ds_read_b64_tr_b16 a[170:171], v235 offset:37888
  v_mfma_f32_16x16x32_bf16 v[64:67], a[128:131], a[204:207], v[64:67]
  buffer_load_dwordx4 v203, s[8:11], s33 offen offset:3072 lds
  v_mfma_f32_16x16x32_bf16 v[68:71], a[116:119], a[200:203], v[68:71]
  ds_read_b64_tr_b16 a[172:173], v235 offset:36872
  v_mfma_f32_16x16x32_bf16 v[68:71], a[132:135], a[204:207], v[68:71]
  ds_read_b64_tr_b16 a[174:175], v235 offset:37896
  v_mfma_f32_16x16x32_bf16 v[72:75], a[120:123], a[200:203], v[72:75]
  v_mfma_f32_16x16x32_bf16 v[72:75], a[136:139], a[204:207], v[72:75]
  v_mfma_f32_16x16x32_bf16 v[76:79], a[124:127], a[200:203], v[76:79]
  v_mfma_f32_16x16x32_bf16 v[76:79], a[140:143], a[204:207], v[76:79]
  s_waitcnt lgkmcnt(0) vmcnt(22)
  s_barrier
  v_mfma_f32_16x16x32_bf16 v[80:83], a[112:115], a[208:211], v[80:83]
  ds_read_b128 a[176:179], v232 offset:0
  v_add_u32 v234, 45056, v10
  v_mfma_f32_16x16x32_bf16 v[80:83], a[128:131], a[212:215], v[80:83]
  buffer_load_dwordx4 v[160:163], v4, s[16:19], s43 offen offset:0 nt
  v_mfma_f32_16x16x32_bf16 v[84:87], a[116:119], a[208:211], v[84:87]
  ds_read_b128 a[180:183], v233 offset:0
  v_add_u32 v235, 45056, v11
  v_mfma_f32_16x16x32_bf16 v[84:87], a[132:135], a[212:215], v[84:87]
  buffer_load_dwordx4 v[164:167], v5, s[16:19], s43 offen offset:1024 nt
  v_mfma_f32_16x16x32_bf16 v[88:91], a[120:123], a[208:211], v[88:91]
  ds_read_b128 a[184:187], v232 offset:2048
  v_mfma_f32_16x16x32_bf16 v[88:91], a[136:139], a[212:215], v[88:91]
  buffer_load_dwordx4 v[168:171], v6, s[16:19], s43 offen offset:2048 nt
  v_mfma_f32_16x16x32_bf16 v[92:95], a[124:127], a[208:211], v[92:95]
  ds_read_b128 a[188:191], v233 offset:2048
  v_mfma_f32_16x16x32_bf16 v[92:95], a[140:143], a[212:215], v[92:95]
  ds_read_b128 a[192:195], v232 offset:4096
  v_mfma_f32_16x16x32_bf16 v[128:131], a[112:115], a[216:219], v[128:131]
  buffer_load_dwordx4 v[172:175], v7, s[16:19], s43 offen offset:3072 nt
  v_mfma_f32_16x16x32_bf16 v[128:131], a[128:131], a[220:223], v[128:131]
  s_add_u32 s43, s43, 16384
  s_and_b32 s43, s43, 0x3ffff
  s_add_u32 m0, 0, s3
  ds_read_b128 a[196:199], v233 offset:4096
  v_mfma_f32_16x16x32_bf16 v[132:135], a[116:119], a[216:219], v[132:135]
  buffer_load_dwordx4 v204, s[8:11], s33 offen offset:0 lds
  v_mfma_f32_16x16x32_bf16 v[132:135], a[132:135], a[220:223], v[132:135]
  ds_read_b128 a[200:203], v232 offset:6144
  v_mfma_f32_16x16x32_bf16 v[136:139], a[120:123], a[216:219], v[136:139]
  buffer_load_dwordx4 v205, s[8:11], s33 offen offset:1024 lds
  v_mfma_f32_16x16x32_bf16 v[136:139], a[136:139], a[220:223], v[136:139]
  ds_read_b128 a[204:207], v233 offset:6144
  v_mfma_f32_16x16x32_bf16 v[140:143], a[124:127], a[216:219], v[140:143]
  v_mfma_f32_16x16x32_bf16 v[140:143], a[140:143], a[220:223], v[140:143]
  buffer_load_dwordx4 v206, s[8:11], s33 offen offset:2048 lds
  v_mfma_f32_16x16x32_bf16 v[144:147], a[112:115], a[224:227], v[144:147]
  s_add_u32 s38, s38, 128
  s_xor_b32 s33, s38, s95
  s_add_u32 m0, 90112, s37
  v_mfma_f32_16x16x32_bf16 v[144:147], a[128:131], a[228:231], v[144:147]
  s_add_u32 s33, s33, s99
  s_and_b32 s33, s33, 2047
  s_lshl_b32 s34, s33, 12
  buffer_load_dwordx4 v207, s[20:23], s34 offen offset:0 lds
  v_mfma_f32_16x16x32_bf16 v[148:151], a[116:119], a[224:227], v[148:151]
  v_mfma_f32_16x16x32_bf16 v[148:151], a[132:135], a[228:231], v[148:151]
  buffer_load_dwordx4 v208, s[20:23], s34 offen offset:1024 lds
  v_mfma_f32_16x16x32_bf16 v[152:155], a[120:123], a[224:227], v[152:155]
  v_mfma_f32_16x16x32_bf16 v[152:155], a[136:139], a[228:231], v[152:155]
  v_mfma_f32_16x16x32_bf16 v[156:159], a[124:127], a[224:227], v[156:159]
  v_mfma_f32_16x16x32_bf16 v[156:159], a[140:143], a[228:231], v[156:159]
  s_waitcnt lgkmcnt(0) vmcnt(24)
  s_barrier
  v_mfma_f32_16x16x32_bf16 v[16:19], a[144:147], a[176:179], v[16:19]
  ds_read_b128 a[208:211], v232 offset:8192
  v_mfma_f32_16x16x32_bf16 v[16:19], a[160:163], a[180:183], v[16:19]
  buffer_load_dwordx4 v209, s[20:23], s34 offen offset:2048 lds
  v_mfma_f32_16x16x32_bf16 v[20:23], a[148:151], a[176:179], v[20:23]
  ds_read_b128 a[212:215], v233 offset:8192
  v_mfma_f32_16x16x32_bf16 v[20:23], a[164:167], a[180:183], v[20:23]
  ds_read_b128 a[216:219], v232 offset:10240
  v_mfma_f32_16x16x32_bf16 v[24:27], a[152:155], a[176:179], v[24:27]
  ds_read_b128 a[220:223], v233 offset:10240
  v_mfma_f32_16x16x32_bf16 v[24:27], a[168:171], a[180:183], v[24:27]
  buffer_load_dwordx4 v210, s[20:23], s34 offen offset:3072 lds
  v_mfma_f32_16x16x32_bf16 v[28:31], a[156:159], a[176:179], v[28:31]
  ds_read_b128 a[224:227], v232 offset:12288
  v_mfma_f32_16x16x32_bf16 v[28:31], a[172:175], a[180:183], v[28:31]
  ds_read_b128 a[228:231], v233 offset:12288
  v_mfma_f32_16x16x32_bf16 v[32:35], a[144:147], a[184:187], v[32:35]
  ds_read_b64_tr_b16 a[112:113], v234 offset:28672
  v_add_u32 v232, 45056, v8
  v_mfma_f32_16x16x32_bf16 v[32:35], a[160:163], a[188:191], v[32:35]
  s_add_u32 m0, 90112, s36
  ds_read_b64_tr_b16 a[114:115], v234 offset:29696
  v_mfma_f32_16x16x32_bf16 v[36:39], a[148:151], a[184:187], v[36:39]
  buffer_load_dwordx4 v200, s[8:11], s33 offen offset:0 lds
  v_mfma_f32_16x16x32_bf16 v[36:39], a[164:167], a[188:191], v[36:39]
  ds_read_b64_tr_b16 a[116:117], v234 offset:28680
  v_add_u32 v233, 45056, v9
  v_mfma_f32_16x16x32_bf16 v[40:43], a[152:155], a[184:187], v[40:43]
  ds_read_b64_tr_b16 a[118:119], v234 offset:29704
  v_mfma_f32_16x16x32_bf16 v[40:43], a[168:171], a[188:191], v[40:43]
  ds_read_b64_tr_b16 a[120:121], v235 offset:28672
  v_mfma_f32_16x16x32_bf16 v[44:47], a[156:159], a[184:187], v[44:47]
  ds_read_b64_tr_b16 a[122:123], v235 offset:29696
  v_mfma_f32_16x16x32_bf16 v[44:47], a[172:175], a[188:191], v[44:47]
  buffer_load_dwordx4 v201, s[8:11], s33 offen offset:1024 lds
  v_mfma_f32_16x16x32_bf16 v[48:51], a[144:147], a[192:195], v[48:51]
  ds_read_b64_tr_b16 a[124:125], v235 offset:28680
  v_mfma_f32_16x16x32_bf16 v[48:51], a[160:163], a[196:199], v[48:51]
  ds_read_b64_tr_b16 a[126:127], v235 offset:29704
  v_mfma_f32_16x16x32_bf16 v[52:55], a[148:151], a[192:195], v[52:55]
  ds_read_b64_tr_b16 a[128:129], v234 offset:36864
  v_mfma_f32_16x16x32_bf16 v[52:55], a[164:167], a[196:199], v[52:55]
  ds_read_b64_tr_b16 a[130:131], v234 offset:37888
  v_mfma_f32_16x16x32_bf16 v[56:59], a[152:155], a[192:195], v[56:59]
  buffer_load_dwordx4 v202, s[8:11], s33 offen offset:2048 lds
  v_mfma_f32_16x16x32_bf16 v[56:59], a[168:171], a[196:199], v[56:59]
  ds_read_b64_tr_b16 a[132:133], v234 offset:36872
  v_mfma_f32_16x16x32_bf16 v[60:63], a[156:159], a[192:195], v[60:63]
  ds_read_b64_tr_b16 a[134:135], v234 offset:37896
  v_mfma_f32_16x16x32_bf16 v[60:63], a[172:175], a[196:199], v[60:63]
  ds_read_b64_tr_b16 a[136:137], v235 offset:36864
  v_mfma_f32_16x16x32_bf16 v[64:67], a[144:147], a[200:203], v[64:67]
  ds_read_b64_tr_b16 a[138:139], v235 offset:37888
  v_mfma_f32_16x16x32_bf16 v[64:67], a[160:163], a[204:207], v[64:67]
  buffer_load_dwordx4 v203, s[8:11], s33 offen offset:3072 lds
  v_mfma_f32_16x16x32_bf16 v[68:71], a[148:151], a[200:203], v[68:71]
  ds_read_b64_tr_b16 a[140:141], v235 offset:36872
  v_mfma_f32_16x16x32_bf16 v[68:71], a[164:167], a[204:207], v[68:71]
  ds_read_b64_tr_b16 a[142:143], v235 offset:37896
  v_mfma_f32_16x16x32_bf16 v[72:75], a[152:155], a[200:203], v[72:75]
  v_mfma_f32_16x16x32_bf16 v[72:75], a[168:171], a[204:207], v[72:75]
  v_mfma_f32_16x16x32_bf16 v[76:79], a[156:159], a[200:203], v[76:79]
  v_mfma_f32_16x16x32_bf16 v[76:79], a[172:175], a[204:207], v[76:79]
  s_waitcnt lgkmcnt(0) vmcnt(26)
  s_barrier
  v_mfma_f32_16x16x32_bf16 v[80:83], a[144:147], a[208:211], v[80:83]
  ds_read_b128 a[176:179], v232 offset:0
  v_add_u32 v234, 0, v10
  v_mfma_f32_16x16x32_bf16 v[80:83], a[160:163], a[212:215], v[80:83]
  buffer_load_dwordx4 v[176:179], v4, s[12:15], s43 offen offset:0 nt
  v_mfma_f32_16x16x32_bf16 v[84:87], a[148:151], a[208:211], v[84:87]
  ds_read_b128 a[180:183], v233 offset:0
  v_add_u32 v235, 0, v11
  v_mfma_f32_16x16x32_bf16 v[84:87], a[164:167], a[212:215], v[84:87]
  buffer_load_dwordx4 v[180:183], v5, s[12:15], s43 offen offset:1024 nt
  v_mfma_f32_16x16x32_bf16 v[88:91], a[152:155], a[208:211], v[88:91]
  ds_read_b128 a[184:187], v232 offset:2048
  v_mfma_f32_16x16x32_bf16 v[88:91], a[168:171], a[212:215], v[88:91]
  buffer_load_dwordx4 v[184:187], v6, s[12:15], s43 offen offset:2048 nt
  v_mfma_f32_16x16x32_bf16 v[92:95], a[156:159], a[208:211], v[92:95]
  ds_read_b128 a[188:191], v233 offset:2048
  v_mfma_f32_16x16x32_bf16 v[92:95], a[172:175], a[212:215], v[92:95]
  ds_read_b128 a[192:195], v232 offset:4096
  v_mfma_f32_16x16x32_bf16 v[128:131], a[144:147], a[216:219], v[128:131]
  buffer_load_dwordx4 v[188:191], v7, s[12:15], s43 offen offset:3072 nt
  v_mfma_f32_16x16x32_bf16 v[128:131], a[160:163], a[220:223], v[128:131]
  s_add_u32 m0, 90112, s3
  ds_read_b128 a[196:199], v233 offset:4096
  v_mfma_f32_16x16x32_bf16 v[132:135], a[148:151], a[216:219], v[132:135]
  buffer_load_dwordx4 v204, s[8:11], s33 offen offset:0 lds
  v_mfma_f32_16x16x32_bf16 v[132:135], a[164:167], a[220:223], v[132:135]
  ds_read_b128 a[200:203], v232 offset:6144
  v_mfma_f32_16x16x32_bf16 v[136:139], a[152:155], a[216:219], v[136:139]
  buffer_load_dwordx4 v205, s[8:11], s33 offen offset:1024 lds
  v_mfma_f32_16x16x32_bf16 v[136:139], a[168:171], a[220:223], v[136:139]
  ds_read_b128 a[204:207], v233 offset:6144
  v_mfma_f32_16x16x32_bf16 v[140:143], a[156:159], a[216:219], v[140:143]
  v_mfma_f32_16x16x32_bf16 v[140:143], a[172:175], a[220:223], v[140:143]
  buffer_load_dwordx4 v206, s[8:11], s33 offen offset:2048 lds
  v_mfma_f32_16x16x32_bf16 v[144:147], a[144:147], a[224:227], v[144:147]
  s_add_u32 s38, s38, 128
  s_xor_b32 s33, s38, s95
  s_add_u32 m0, 45056, s37
  v_mfma_f32_16x16x32_bf16 v[144:147], a[160:163], a[228:231], v[144:147]
  s_add_u32 s33, s33, s99
  s_and_b32 s33, s33, 2047
  s_lshl_b32 s34, s33, 12
  buffer_load_dwordx4 v207, s[20:23], s34 offen offset:0 lds
  v_mfma_f32_16x16x32_bf16 v[148:151], a[148:151], a[224:227], v[148:151]
  v_mfma_f32_16x16x32_bf16 v[148:151], a[164:167], a[228:231], v[148:151]
  buffer_load_dwordx4 v208, s[20:23], s34 offen offset:1024 lds
  v_mfma_f32_16x16x32_bf16 v[152:155], a[152:155], a[224:227], v[152:155]
  v_mfma_f32_16x16x32_bf16 v[152:155], a[168:171], a[228:231], v[152:155]
  v_mfma_f32_16x16x32_bf16 v[156:159], a[156:159], a[224:227], v[156:159]
  v_mfma_f32_16x16x32_bf16 v[156:159], a[172:175], a[228:231], v[156:159]
  s_waitcnt lgkmcnt(0) vmcnt(28)
  s_barrier
  v_mfma_f32_16x16x32_bf16 v[16:19], a[112:115], a[176:179], v[16:19]
  ds_read_b128 a[208:211], v232 offset:8192
  v_mfma_f32_16x16x32_bf16 v[16:19], a[128:131], a[180:183], v[16:19]
  buffer_load_dwordx4 v209, s[20:23], s34 offen offset:2048 lds
  v_mfma_f32_16x16x32_bf16 v[20:23], a[116:119], a[176:179], v[20:23]
  ds_read_b128 a[212:215], v233 offset:8192
  v_mfma_f32_16x16x32_bf16 v[20:23], a[132:135], a[180:183], v[20:23]
  ds_read_b128 a[216:219], v232 offset:10240
  v_mfma_f32_16x16x32_bf16 v[24:27], a[120:123], a[176:179], v[24:27]
  ds_read_b128 a[220:223], v233 offset:10240
  v_mfma_f32_16x16x32_bf16 v[24:27], a[136:139], a[180:183], v[24:27]
  buffer_load_dwordx4 v210, s[20:23], s34 offen offset:3072 lds
  v_mfma_f32_16x16x32_bf16 v[28:31], a[124:127], a[176:179], v[28:31]
  ds_read_b128 a[224:227], v232 offset:12288
  v_mfma_f32_16x16x32_bf16 v[28:31], a[140:143], a[180:183], v[28:31]
  ds_read_b128 a[228:231], v233 offset:12288
  v_mfma_f32_16x16x32_bf16 v[32:35], a[112:115], a[184:187], v[32:35]
  ds_read_b64_tr_b16 a[144:145], v234 offset:28672
  v_add_u32 v232, 0, v8
  v_mfma_f32_16x16x32_bf16 v[32:35], a[128:131], a[188:191], v[32:35]
  s_add_u32 m0, 45056, s36
  ds_read_b64_tr_b16 a[146:147], v234 offset:29696
  v_mfma_f32_16x16x32_bf16 v[36:39], a[116:119], a[184:187], v[36:39]
  buffer_load_dwordx4 v200, s[8:11], s33 offen offset:0 lds
  v_mfma_f32_16x16x32_bf16 v[36:39], a[132:135], a[188:191], v[36:39]
  ds_read_b64_tr_b16 a[148:149], v234 offset:28680
  v_add_u32 v233, 0, v9
  v_mfma_f32_16x16x32_bf16 v[40:43], a[120:123], a[184:187], v[40:43]
  ds_read_b64_tr_b16 a[150:151], v234 offset:29704
  v_mfma_f32_16x16x32_bf16 v[40:43], a[136:139], a[188:191], v[40:43]
  ds_read_b64_tr_b16 a[152:153], v235 offset:28672
  v_mfma_f32_16x16x32_bf16 v[44:47], a[124:127], a[184:187], v[44:47]
  ds_read_b64_tr_b16 a[154:155], v235 offset:29696
  v_mfma_f32_16x16x32_bf16 v[44:47], a[140:143], a[188:191], v[44:47]
  buffer_load_dwordx4 v201, s[8:11], s33 offen offset:1024 lds
  v_mfma_f32_16x16x32_bf16 v[48:51], a[112:115], a[192:195], v[48:51]
  ds_read_b64_tr_b16 a[156:157], v235 offset:28680
  v_mfma_f32_16x16x32_bf16 v[48:51], a[128:131], a[196:199], v[48:51]
  ds_read_b64_tr_b16 a[158:159], v235 offset:29704
  v_mfma_f32_16x16x32_bf16 v[52:55], a[116:119], a[192:195], v[52:55]
  ds_read_b64_tr_b16 a[160:161], v234 offset:36864
  v_mfma_f32_16x16x32_bf16 v[52:55], a[132:135], a[196:199], v[52:55]
  ds_read_b64_tr_b16 a[162:163], v234 offset:37888
  v_mfma_f32_16x16x32_bf16 v[56:59], a[120:123], a[192:195], v[56:59]
  buffer_load_dwordx4 v202, s[8:11], s33 offen offset:2048 lds
  v_mfma_f32_16x16x32_bf16 v[56:59], a[136:139], a[196:199], v[56:59]
  ds_read_b64_tr_b16 a[164:165], v234 offset:36872
  v_mfma_f32_16x16x32_bf16 v[60:63], a[124:127], a[192:195], v[60:63]
  ds_read_b64_tr_b16 a[166:167], v234 offset:37896
  v_mfma_f32_16x16x32_bf16 v[60:63], a[140:143], a[196:199], v[60:63]
  ds_read_b64_tr_b16 a[168:169], v235 offset:36864
  v_mfma_f32_16x16x32_bf16 v[64:67], a[112:115], a[200:203], v[64:67]
  ds_read_b64_tr_b16 a[170:171], v235 offset:37888
  v_mfma_f32_16x16x32_bf16 v[64:67], a[128:131], a[204:207], v[64:67]
  buffer_load_dwordx4 v203, s[8:11], s33 offen offset:3072 lds
  v_mfma_f32_16x16x32_bf16 v[68:71], a[116:119], a[200:203], v[68:71]
  ds_read_b64_tr_b16 a[172:173], v235 offset:36872
  v_mfma_f32_16x16x32_bf16 v[68:71], a[132:135], a[204:207], v[68:71]
  ds_read_b64_tr_b16 a[174:175], v235 offset:37896
  v_mfma_f32_16x16x32_bf16 v[72:75], a[120:123], a[200:203], v[72:75]
  v_mfma_f32_16x16x32_bf16 v[72:75], a[136:139], a[204:207], v[72:75]
  v_mfma_f32_16x16x32_bf16 v[76:79], a[124:127], a[200:203], v[76:79]
  v_mfma_f32_16x16x32_bf16 v[76:79], a[140:143], a[204:207], v[76:79]
  s_waitcnt lgkmcnt(0) vmcnt(30)
  s_barrier
  v_mfma_f32_16x16x32_bf16 v[80:83], a[112:115], a[208:211], v[80:83]
  ds_read_b128 a[176:179], v232 offset:0
  v_add_u32 v234, 90112, v10
  v_mfma_f32_16x16x32_bf16 v[80:83], a[128:131], a[212:215], v[80:83]
  buffer_load_dwordx4 a[0:3], v4, s[16:19], s43 offen offset:0 nt
  v_mfma_f32_16x16x32_bf16 v[84:87], a[116:119], a[208:211], v[84:87]
  ds_read_b128 a[180:183], v233 offset:0
  v_add_u32 v235, 90112, v11
  v_mfma_f32_16x16x32_bf16 v[84:87], a[132:135], a[212:215], v[84:87]
  buffer_load_dwordx4 a[4:7], v5, s[16:19], s43 offen offset:1024 nt
  v_mfma_f32_16x16x32_bf16 v[88:91], a[120:123], a[208:211], v[88:91]
  ds_read_b128 a[184:187], v232 offset:2048
  v_mfma_f32_16x16x32_bf16 v[88:91], a[136:139], a[212:215], v[88:91]
  buffer_load_dwordx4 a[8:11], v6, s[16:19], s43 offen offset:2048 nt
  v_mfma_f32_16x16x32_bf16 v[92:95], a[124:127], a[208:211], v[92:95]
  ds_read_b128 a[188:191], v233 offset:2048
  v_mfma_f32_16x16x32_bf16 v[92:95], a[140:143], a[212:215], v[92:95]
  ds_read_b128 a[192:195], v232 offset:4096
  v_mfma_f32_16x16x32_bf16 v[128:131], a[112:115], a[216:219], v[128:131]
  buffer_load_dwordx4 a[12:15], v7, s[16:19], s43 offen offset:3072 nt
  v_mfma_f32_16x16x32_bf16 v[128:131], a[128:131], a[220:223], v[128:131]
  s_add_u32 s43, s43, 16384
  s_and_b32 s43, s43, 0x3ffff
  s_add_u32 m0, 45056, s3
  ds_read_b128 a[196:199], v233 offset:4096
  v_mfma_f32_16x16x32_bf16 v[132:135], a[116:119], a[216:219], v[132:135]
  buffer_load_dwordx4 v204, s[8:11], s33 offen offset:0 lds
  v_mfma_f32_16x16x32_bf16 v[132:135], a[132:135], a[220:223], v[132:135]
  ds_read_b128 a[200:203], v232 offset:6144
  v_mfma_f32_16x16x32_bf16 v[136:139], a[120:123], a[216:219], v[136:139]
  buffer_load_dwordx4 v205, s[8:11], s33 offen offset:1024 lds
  v_mfma_f32_16x16x32_bf16 v[136:139], a[136:139], a[220:223], v[136:139]
  ds_read_b128 a[204:207], v233 offset:6144
  v_mfma_f32_16x16x32_bf16 v[140:143], a[124:127], a[216:219], v[140:143]
  v_mfma_f32_16x16x32_bf16 v[140:143], a[140:143], a[220:223], v[140:143]
  buffer_load_dwordx4 v206, s[8:11], s33 offen offset:2048 lds
  v_mfma_f32_16x16x32_bf16 v[144:147], a[112:115], a[224:227], v[144:147]
  s_add_u32 s38, s38, 128
  s_xor_b32 s33, s38, s95
  s_add_u32 m0, 0, s37
  v_mfma_f32_16x16x32_bf16 v[144:147], a[128:131], a[228:231], v[144:147]
  s_add_u32 s33, s33, s99
  s_and_b32 s33, s33, 2047
  s_lshl_b32 s34, s33, 12
  buffer_load_dwordx4 v207, s[20:23], s34 offen offset:0 lds
  v_mfma_f32_16x16x32_bf16 v[148:151], a[116:119], a[224:227], v[148:151]
  v_mfma_f32_16x16x32_bf16 v[148:151], a[132:135], a[228:231], v[148:151]
  buffer_load_dwordx4 v208, s[20:23], s34 offen offset:1024 lds
  v_mfma_f32_16x16x32_bf16 v[152:155], a[120:123], a[224:227], v[152:155]
  v_mfma_f32_16x16x32_bf16 v[152:155], a[136:139], a[228:231], v[152:155]
  v_mfma_f32_16x16x32_bf16 v[156:159], a[124:127], a[224:227], v[156:159]
  v_mfma_f32_16x16x32_bf16 v[156:159], a[140:143], a[228:231], v[156:159]
  s_waitcnt lgkmcnt(0) vmcnt(28)
  s_barrier
  v_mfma_f32_16x16x32_bf16 v[16:19], a[144:147], a[176:179], v[16:19]
  ds_read_b128 a[208:211], v232 offset:8192
  v_mfma_f32_16x16x32_bf16 v[16:19], a[160:163], a[180:183], v[16:19]
  buffer_load_dwordx4 v209, s[20:23], s34 offen offset:2048 lds
  v_mfma_f32_16x16x32_bf16 v[20:23], a[148:151], a[176:179], v[20:23]
  ds_read_b128 a[212:215], v233 offset:8192
  v_mfma_f32_16x16x32_bf16 v[20:23], a[164:167], a[180:183], v[20:23]
  ds_read_b128 a[216:219], v232 offset:10240
  v_mfma_f32_16x16x32_bf16 v[24:27], a[152:155], a[176:179], v[24:27]
  ds_read_b128 a[220:223], v233 offset:10240
  v_mfma_f32_16x16x32_bf16 v[24:27], a[168:171], a[180:183], v[24:27]
  buffer_load_dwordx4 v210, s[20:23], s34 offen offset:3072 lds
  v_mfma_f32_16x16x32_bf16 v[28:31], a[156:159], a[176:179], v[28:31]
  ds_read_b128 a[224:227], v232 offset:12288
  v_mfma_f32_16x16x32_bf16 v[28:31], a[172:175], a[180:183], v[28:31]
  ds_read_b128 a[228:231], v233 offset:12288
  v_mfma_f32_16x16x32_bf16 v[32:35], a[144:147], a[184:187], v[32:35]
  ds_read_b64_tr_b16 a[112:113], v234 offset:28672
  v_add_u32 v232, 90112, v8
  v_mfma_f32_16x16x32_bf16 v[32:35], a[160:163], a[188:191], v[32:35]
  s_add_u32 m0, 0, s36
  ds_read_b64_tr_b16 a[114:115], v234 offset:29696
  v_mfma_f32_16x16x32_bf16 v[36:39], a[148:151], a[184:187], v[36:39]
  buffer_load_dwordx4 v200, s[8:11], s33 offen offset:0 lds
  v_mfma_f32_16x16x32_bf16 v[36:39], a[164:167], a[188:191], v[36:39]
  ds_read_b64_tr_b16 a[116:117], v234 offset:28680
  v_add_u32 v233, 90112, v9
  v_mfma_f32_16x16x32_bf16 v[40:43], a[152:155], a[184:187], v[40:43]
  ds_read_b64_tr_b16 a[118:119], v234 offset:29704
  v_mfma_f32_16x16x32_bf16 v[40:43], a[168:171], a[188:191], v[40:43]
  ds_read_b64_tr_b16 a[120:121], v235 offset:28672
  v_mfma_f32_16x16x32_bf16 v[44:47], a[156:159], a[184:187], v[44:47]
  ds_read_b64_tr_b16 a[122:123], v235 offset:29696
  v_mfma_f32_16x16x32_bf16 v[44:47], a[172:175], a[188:191], v[44:47]
  buffer_load_dwordx4 v201, s[8:11], s33 offen offset:1024 lds
  v_mfma_f32_16x16x32_bf16 v[48:51], a[144:147], a[192:195], v[48:51]
  ds_read_b64_tr_b16 a[124:125], v235 offset:28680
  v_mfma_f32_16x16x32_bf16 v[48:51], a[160:163], a[196:199], v[48:51]
  ds_read_b64_tr_b16 a[126:127], v235 offset:29704
  v_mfma_f32_16x16x32_bf16 v[52:55], a[148:151], a[192:195], v[52:55]
  ds_read_b64_tr_b16 a[128:129], v234 offset:36864
  v_mfma_f32_16x16x32_bf16 v[52:55], a[164:167], a[196:199], v[52:55]
  ds_read_b64_tr_b16 a[130:131], v234 offset:37888
  v_mfma_f32_16x16x32_bf16 v[56:59], a[152:155], a[192:195], v[56:59]
  buffer_load_dwordx4 v202, s[8:11], s33 offen offset:2048 lds
  v_mfma_f32_16x16x32_bf16 v[56:59], a[168:171], a[196:199], v[56:59]
  ds_read_b64_tr_b16 a[132:133], v234 offset:36872
  v_mfma_f32_16x16x32_bf16 v[60:63], a[156:159], a[192:195], v[60:63]
  ds_read_b64_tr_b16 a[134:135], v234 offset:37896
  v_mfma_f32_16x16x32_bf16 v[60:63], a[172:175], a[196:199], v[60:63]
  ds_read_b64_tr_b16 a[136:137], v235 offset:36864
  v_mfma_f32_16x16x32_bf16 v[64:67], a[144:147], a[200:203], v[64:67]
  ds_read_b64_tr_b16 a[138:139], v235 offset:37888
  v_mfma_f32_16x16x32_bf16 v[64:67], a[160:163], a[204:207], v[64:67]
  buffer_load_dwordx4 v203, s[8:11], s33 offen offset:3072 lds
  v_mfma_f32_16x16x32_bf16 v[68:71], a[148:151], a[200:203], v[68:71]
  ds_read_b64_tr_b16 a[140:141], v235 offset:36872
  v_mfma_f32_16x16x32_bf16 v[68:71], a[164:167], a[204:207], v[68:71]
  ds_read_b64_tr_b16 a[142:143], v235 offset:37896
  v_mfma_f32_16x16x32_bf16 v[72:75], a[152:155], a[200:203], v[72:75]
  v_mfma_f32_16x16x32_bf16 v[72:75], a[168:171], a[204:207], v[72:75]
  v_mfma_f32_16x16x32_bf16 v[76:79], a[156:159], a[200:203], v[76:79]
  v_mfma_f32_16x16x32_bf16 v[76:79], a[172:175], a[204:207], v[76:79]
  s_waitcnt lgkmcnt(0) vmcnt(30)
  s_barrier
  v_mfma_f32_16x16x32_bf16 v[80:83], a[144:147], a[208:211], v[80:83]
  ds_read_b128 a[176:179], v232 offset:0
  v_add_u32 v234, 45056, v10
  v_mfma_f32_16x16x32_bf16 v[80:83], a[160:163], a[212:215], v[80:83]
  buffer_load_dwordx4 a[16:19], v4, s[12:15], s43 offen offset:0 nt
  v_mfma_f32_16x16x32_bf16 v[84:87], a[148:151], a[208:211], v[84:87]
  ds_read_b128 a[180:183], v233 offset:0
  v_add_u32 v235, 45056, v11
  v_mfma_f32_16x16x32_bf16 v[84:87], a[164:167], a[212:215], v[84:87]
  buffer_load_dwordx4 a[20:23], v5, s[12:15], s43 offen offset:1024 nt
  v_mfma_f32_16x16x32_bf16 v[88:91], a[152:155], a[208:211], v[88:91]
  ds_read_b128 a[184:187], v232 offset:2048
  v_mfma_f32_16x16x32_bf16 v[88:91], a[168:171], a[212:215], v[88:91]
  buffer_load_dwordx4 a[24:27], v6, s[12:15], s43 offen offset:2048 nt
  v_mfma_f32_16x16x32_bf16 v[92:95], a[156:159], a[208:211], v[92:95]
  ds_read_b128 a[188:191], v233 offset:2048
  v_mfma_f32_16x16x32_bf16 v[92:95], a[172:175], a[212:215], v[92:95]
  ds_read_b128 a[192:195], v232 offset:4096
  v_mfma_f32_16x16x32_bf16 v[128:131], a[144:147], a[216:219], v[128:131]
  buffer_load_dwordx4 a[28:31], v7, s[12:15], s43 offen offset:3072 nt
  v_mfma_f32_16x16x32_bf16 v[128:131], a[160:163], a[220:223], v[128:131]
  s_add_u32 m0, 0, s3
  ds_read_b128 a[196:199], v233 offset:4096
  v_mfma_f32_16x16x32_bf16 v[132:135], a[148:151], a[216:219], v[132:135]
  buffer_load_dwordx4 v204, s[8:11], s33 offen offset:0 lds
  v_mfma_f32_16x16x32_bf16 v[132:135], a[164:167], a[220:223], v[132:135]
  ds_read_b128 a[200:203], v232 offset:6144
  v_mfma_f32_16x16x32_bf16 v[136:139], a[152:155], a[216:219], v[136:139]
  buffer_load_dwordx4 v205, s[8:11], s33 offen offset:1024 lds
  v_mfma_f32_16x16x32_bf16 v[136:139], a[168:171], a[220:223], v[136:139]
  ds_read_b128 a[204:207], v233 offset:6144
  v_mfma_f32_16x16x32_bf16 v[140:143], a[156:159], a[216:219], v[140:143]
  v_mfma_f32_16x16x32_bf16 v[140:143], a[172:175], a[220:223], v[140:143]
  buffer_load_dwordx4 v206, s[8:11], s33 offen offset:2048 lds
  v_mfma_f32_16x16x32_bf16 v[144:147], a[144:147], a[224:227], v[144:147]
  s_add_u32 s38, s38, 128
  s_xor_b32 s33, s38, s95
  s_add_u32 m0, 90112, s37
  v_mfma_f32_16x16x32_bf16 v[144:147], a[160:163], a[228:231], v[144:147]
  s_add_u32 s33, s33, s99
  s_and_b32 s33, s33, 2047
  s_lshl_b32 s34, s33, 12
  buffer_load_dwordx4 v207, s[20:23], s34 offen offset:0 lds
  v_mfma_f32_16x16x32_bf16 v[148:151], a[148:151], a[224:227], v[148:151]
  v_mfma_f32_16x16x32_bf16 v[148:151], a[164:167], a[228:231], v[148:151]
  buffer_load_dwordx4 v208, s[20:23], s34 offen offset:1024 lds
  v_mfma_f32_16x16x32_bf16 v[152:155], a[152:155], a[224:227], v[152:155]
  v_mfma_f32_16x16x32_bf16 v[152:155], a[168:171], a[228:231], v[152:155]
  v_mfma_f32_16x16x32_bf16 v[156:159], a[156:159], a[224:227], v[156:159]
  v_mfma_f32_16x16x32_bf16 v[156:159], a[172:175], a[228:231], v[156:159]
  s_waitcnt lgkmcnt(0) vmcnt(28)
  s_barrier
  v_mfma_f32_16x16x32_bf16 v[16:19], a[112:115], a[176:179], v[16:19]
  ds_read_b128 a[208:211], v232 offset:8192
  v_mfma_f32_16x16x32_bf16 v[16:19], a[128:131], a[180:183], v[16:19]
  buffer_load_dwordx4 v209, s[20:23], s34 offen offset:2048 lds
  v_mfma_f32_16x16x32_bf16 v[20:23], a[116:119], a[176:179], v[20:23]
  ds_read_b128 a[212:215], v233 offset:8192
  v_mfma_f32_16x16x32_bf16 v[20:23], a[132:135], a[180:183], v[20:23]
  ds_read_b128 a[216:219], v232 offset:10240
  v_mfma_f32_16x16x32_bf16 v[24:27], a[120:123], a[176:179], v[24:27]
  ds_read_b128 a[220:223], v233 offset:10240
  v_mfma_f32_16x16x32_bf16 v[24:27], a[136:139], a[180:183], v[24:27]
  buffer_load_dwordx4 v210, s[20:23], s34 offen offset:3072 lds
  v_mfma_f32_16x16x32_bf16 v[28:31], a[124:127], a[176:179], v[28:31]
  ds_read_b128 a[224:227], v232 offset:12288
  v_mfma_f32_16x16x32_bf16 v[28:31], a[140:143], a[180:183], v[28:31]
  ds_read_b128 a[228:231], v233 offset:12288
  v_mfma_f32_16x16x32_bf16 v[32:35], a[112:115], a[184:187], v[32:35]
  ds_read_b64_tr_b16 a[144:145], v234 offset:28672
  v_add_u32 v232, 45056, v8
  v_mfma_f32_16x16x32_bf16 v[32:35], a[128:131], a[188:191], v[32:35]
  s_add_u32 m0, 90112, s36
  ds_read_b64_tr_b16 a[146:147], v234 offset:29696
  v_mfma_f32_16x16x32_bf16 v[36:39], a[116:119], a[184:187], v[36:39]
  buffer_load_dwordx4 v200, s[8:11], s33 offen offset:0 lds
  v_mfma_f32_16x16x32_bf16 v[36:39], a[132:135], a[188:191], v[36:39]
  ds_read_b64_tr_b16 a[148:149], v234 offset:28680
  v_add_u32 v233, 45056, v9
  v_mfma_f32_16x16x32_bf16 v[40:43], a[120:123], a[184:187], v[40:43]
  ds_read_b64_tr_b16 a[150:151], v234 offset:29704
  v_mfma_f32_16x16x32_bf16 v[40:43], a[136:139], a[188:191], v[40:43]
  ds_read_b64_tr_b16 a[152:153], v235 offset:28672
  v_mfma_f32_16x16x32_bf16 v[44:47], a[124:127], a[184:187], v[44:47]
  ds_read_b64_tr_b16 a[154:155], v235 offset:29696
  v_mfma_f32_16x16x32_bf16 v[44:47], a[140:143], a[188:191], v[44:47]
  buffer_load_dwordx4 v201, s[8:11], s33 offen offset:1024 lds
  v_mfma_f32_16x16x32_bf16 v[48:51], a[112:115], a[192:195], v[48:51]
  ds_read_b64_tr_b16 a[156:157], v235 offset:28680
  v_mfma_f32_16x16x32_bf16 v[48:51], a[128:131], a[196:199], v[48:51]
  ds_read_b64_tr_b16 a[158:159], v235 offset:29704
  v_mfma_f32_16x16x32_bf16 v[52:55], a[116:119], a[192:195], v[52:55]
  ds_read_b64_tr_b16 a[160:161], v234 offset:36864
  v_mfma_f32_16x16x32_bf16 v[52:55], a[132:135], a[196:199], v[52:55]
  ds_read_b64_tr_b16 a[162:163], v234 offset:37888
  v_mfma_f32_16x16x32_bf16 v[56:59], a[120:123], a[192:195], v[56:59]
  buffer_load_dwordx4 v202, s[8:11], s33 offen offset:2048 lds
  v_mfma_f32_16x16x32_bf16 v[56:59], a[136:139], a[196:199], v[56:59]
  ds_read_b64_tr_b16 a[164:165], v234 offset:36872
  v_mfma_f32_16x16x32_bf16 v[60:63], a[124:127], a[192:195], v[60:63]
  ds_read_b64_tr_b16 a[166:167], v234 offset:37896
  v_mfma_f32_16x16x32_bf16 v[60:63], a[140:143], a[196:199], v[60:63]
  ds_read_b64_tr_b16 a[168:169], v235 offset:36864
  v_mfma_f32_16x16x32_bf16 v[64:67], a[112:115], a[200:203], v[64:67]
  ds_read_b64_tr_b16 a[170:171], v235 offset:37888
  v_mfma_f32_16x16x32_bf16 v[64:67], a[128:131], a[204:207], v[64:67]
  buffer_load_dwordx4 v203, s[8:11], s33 offen offset:3072 lds
  v_mfma_f32_16x16x32_bf16 v[68:71], a[116:119], a[200:203], v[68:71]
  ds_read_b64_tr_b16 a[172:173], v235 offset:36872
  v_mfma_f32_16x16x32_bf16 v[68:71], a[132:135], a[204:207], v[68:71]
  ds_read_b64_tr_b16 a[174:175], v235 offset:37896
  v_mfma_f32_16x16x32_bf16 v[72:75], a[120:123], a[200:203], v[72:75]
  v_mfma_f32_16x16x32_bf16 v[72:75], a[136:139], a[204:207], v[72:75]
  v_mfma_f32_16x16x32_bf16 v[76:79], a[124:127], a[200:203], v[76:79]
  v_mfma_f32_16x16x32_bf16 v[76:79], a[140:143], a[204:207], v[76:79]
  s_waitcnt lgkmcnt(0) vmcnt(30)
  s_barrier
  v_mfma_f32_16x16x32_bf16 v[80:83], a[112:115], a[208:211], v[80:83]
  ds_read_b128 a[176:179], v232 offset:0
  v_add_u32 v234, 0, v10
  v_mfma_f32_16x16x32_bf16 v[80:83], a[128:131], a[212:215], v[80:83]
  buffer_load_dwordx4 a[32:35], v4, s[16:19], s43 offen offset:0 nt
  v_mfma_f32_16x16x32_bf16 v[84:87], a[116:119], a[208:211], v[84:87]
  ds_read_b128 a[180:183], v233 offset:0
  v_add_u32 v235, 0, v11
  v_mfma_f32_16x16x32_bf16 v[84:87], a[132:135], a[212:215], v[84:87]
  buffer_load_dwordx4 a[36:39], v5, s[16:19], s43 offen offset:1024 nt
  v_mfma_f32_16x16x32_bf16 v[88:91], a[120:123], a[208:211], v[88:91]
  ds_read_b128 a[184:187], v232 offset:2048
  v_mfma_f32_16x16x32_bf16 v[88:91], a[136:139], a[212:215], v[88:91]
  buffer_load_dwordx4 a[40:43], v6, s[16:19], s43 offen offset:2048 nt
  v_mfma_f32_16x16x32_bf16 v[92:95], a[124:127], a[208:211], v[92:95]
  ds_read_b128 a[188:191], v233 offset:2048
  v_mfma_f32_16x16x32_bf16 v[92:95], a[140:143], a[212:215], v[92:95]
  ds_read_b128 a[192:195], v232 offset:4096
  v_mfma_f32_16x16x32_bf16 v[128:131], a[112:115], a[216:219], v[128:131]
  buffer_load_dwordx4 a[44:47], v7, s[16:19], s43 offen offset:3072 nt
  v_mfma_f32_16x16x32_bf16 v[128:131], a[128:131], a[220:223], v[128:131]
  s_add_u32 s43, s43, 16384
  s_and_b32 s43, s43, 0x3ffff
  s_add_u32 m0, 90112, s3
  ds_read_b128 a[196:199], v233 offset:4096
  v_mfma_f32_16x16x32_bf16 v[132:135], a[116:119], a[216:219], v[132:135]
  buffer_load_dwordx4 v204, s[8:11], s33 offen offset:0 lds
  v_mfma_f32_16x16x32_bf16 v[132:135], a[132:135], a[220:223], v[132:135]
  ds_read_b128 a[200:203], v232 offset:6144
  v_mfma_f32_16x16x32_bf16 v[136:139], a[120:123], a[216:219], v[136:139]
  buffer_load_dwordx4 v205, s[8:11], s33 offen offset:1024 lds
  v_mfma_f32_16x16x32_bf16 v[136:139], a[136:139], a[220:223], v[136:139]
  ds_read_b128 a[204:207], v233 offset:6144
  v_mfma_f32_16x16x32_bf16 v[140:143], a[124:127], a[216:219], v[140:143]
  v_mfma_f32_16x16x32_bf16 v[140:143], a[140:143], a[220:223], v[140:143]
  buffer_load_dwordx4 v206, s[8:11], s33 offen offset:2048 lds
  v_mfma_f32_16x16x32_bf16 v[144:147], a[112:115], a[224:227], v[144:147]
  s_add_u32 s38, s38, 128
  s_xor_b32 s33, s38, s95
  s_add_u32 m0, 45056, s37
  v_mfma_f32_16x16x32_bf16 v[144:147], a[128:131], a[228:231], v[144:147]
  s_add_u32 s33, s33, s99
  s_and_b32 s33, s33, 2047
  s_lshl_b32 s34, s33, 12
  buffer_load_dwordx4 v207, s[20:23], s34 offen offset:0 lds
  v_mfma_f32_16x16x32_bf16 v[148:151], a[116:119], a[224:227], v[148:151]
  v_mfma_f32_16x16x32_bf16 v[148:151], a[132:135], a[228:231], v[148:151]
  buffer_load_dwordx4 v208, s[20:23], s34 offen offset:1024 lds
  v_mfma_f32_16x16x32_bf16 v[152:155], a[120:123], a[224:227], v[152:155]
  v_mfma_f32_16x16x32_bf16 v[152:155], a[136:139], a[228:231], v[152:155]
  v_mfma_f32_16x16x32_bf16 v[156:159], a[124:127], a[224:227], v[156:159]
  v_mfma_f32_16x16x32_bf16 v[156:159], a[140:143], a[228:231], v[156:159]
  s_waitcnt lgkmcnt(0) vmcnt(28)
  s_barrier
  v_mfma_f32_16x16x32_bf16 v[16:19], a[144:147], a[176:179], v[16:19]
  ds_read_b128 a[208:211], v232 offset:8192
  v_mfma_f32_16x16x32_bf16 v[16:19], a[160:163], a[180:183], v[16:19]
  buffer_load_dwordx4 v209, s[20:23], s34 offen offset:2048 lds
  v_mfma_f32_16x16x32_bf16 v[20:23], a[148:151], a[176:179], v[20:23]
  ds_read_b128 a[212:215], v233 offset:8192
  v_mfma_f32_16x16x32_bf16 v[20:23], a[164:167], a[180:183], v[20:23]
  ds_read_b128 a[216:219], v232 offset:10240
  v_mfma_f32_16x16x32_bf16 v[24:27], a[152:155], a[176:179], v[24:27]
  ds_read_b128 a[220:223], v233 offset:10240
  v_mfma_f32_16x16x32_bf16 v[24:27], a[168:171], a[180:183], v[24:27]
  buffer_load_dwordx4 v210, s[20:23], s34 offen offset:3072 lds
  v_mfma_f32_16x16x32_bf16 v[28:31], a[156:159], a[176:179], v[28:31]
  ds_read_b128 a[224:227], v232 offset:12288
  v_mfma_f32_16x16x32_bf16 v[28:31], a[172:175], a[180:183], v[28:31]
  ds_read_b128 a[228:231], v233 offset:12288
  v_mfma_f32_16x16x32_bf16 v[32:35], a[144:147], a[184:187], v[32:35]
  ds_read_b64_tr_b16 a[112:113], v234 offset:28672
  v_add_u32 v232, 0, v8
  v_mfma_f32_16x16x32_bf16 v[32:35], a[160:163], a[188:191], v[32:35]
  s_add_u32 m0, 45056, s36
  ds_read_b64_tr_b16 a[114:115], v234 offset:29696
  v_mfma_f32_16x16x32_bf16 v[36:39], a[148:151], a[184:187], v[36:39]
  buffer_load_dwordx4 v200, s[8:11], s33 offen offset:0 lds
  v_mfma_f32_16x16x32_bf16 v[36:39], a[164:167], a[188:191], v[36:39]
  ds_read_b64_tr_b16 a[116:117], v234 offset:28680
  v_add_u32 v233, 0, v9
  v_mfma_f32_16x16x32_bf16 v[40:43], a[152:155], a[184:187], v[40:43]
  ds_read_b64_tr_b16 a[118:119], v234 offset:29704
  v_mfma_f32_16x16x32_bf16 v[40:43], a[168:171], a[188:191], v[40:43]
  ds_read_b64_tr_b16 a[120:121], v235 offset:28672
  v_mfma_f32_16x16x32_bf16 v[44:47], a[156:159], a[184:187], v[44:47]
  ds_read_b64_tr_b16 a[122:123], v235 offset:29696
  v_mfma_f32_16x16x32_bf16 v[44:47], a[172:175], a[188:191], v[44:47]
  buffer_load_dwordx4 v201, s[8:11], s33 offen offset:1024 lds
  v_mfma_f32_16x16x32_bf16 v[48:51], a[144:147], a[192:195], v[48:51]
  ds_read_b64_tr_b16 a[124:125], v235 offset:28680
  v_mfma_f32_16x16x32_bf16 v[48:51], a[160:163], a[196:199], v[48:51]
  ds_read_b64_tr_b16 a[126:127], v235 offset:29704
  v_mfma_f32_16x16x32_bf16 v[52:55], a[148:151], a[192:195], v[52:55]
  ds_read_b64_tr_b16 a[128:129], v234 offset:36864
  v_mfma_f32_16x16x32_bf16 v[52:55], a[164:167], a[196:199], v[52:55]
  ds_read_b64_tr_b16 a[130:131], v234 offset:37888
  v_mfma_f32_16x16x32_bf16 v[56:59], a[152:155], a[192:195], v[56:59]
  buffer_load_dwordx4 v202, s[8:11], s33 offen offset:2048 lds
  v_mfma_f32_16x16x32_bf16 v[56:59], a[168:171], a[196:199], v[56:59]
  ds_read_b64_tr_b16 a[132:133], v234 offset:36872
  v_mfma_f32_16x16x32_bf16 v[60:63], a[156:159], a[192:195], v[60:63]
  ds_read_b64_tr_b16 a[134:135], v234 offset:37896
  v_mfma_f32_16x16x32_bf16 v[60:63], a[172:175], a[196:199], v[60:63]
  ds_read_b64_tr_b16 a[136:137], v235 offset:36864
  v_mfma_f32_16x16x32_bf16 v[64:67], a[144:147], a[200:203], v[64:67]
  ds_read_b64_tr_b16 a[138:139], v235 offset:37888
  v_mfma_f32_16x16x32_bf16 v[64:67], a[160:163], a[204:207], v[64:67]
  buffer_load_dwordx4 v203, s[8:11], s33 offen offset:3072 lds
  v_mfma_f32_16x16x32_bf16 v[68:71], a[148:151], a[200:203], v[68:71]
  ds_read_b64_tr_b16 a[140:141], v235 offset:36872
  v_mfma_f32_16x16x32_bf16 v[68:71], a[164:167], a[204:207], v[68:71]
  ds_read_b64_tr_b16 a[142:143], v235 offset:37896
  v_mfma_f32_16x16x32_bf16 v[72:75], a[152:155], a[200:203], v[72:75]
  v_mfma_f32_16x16x32_bf16 v[72:75], a[168:171], a[204:207], v[72:75]
  v_mfma_f32_16x16x32_bf16 v[76:79], a[156:159], a[200:203], v[76:79]
  v_mfma_f32_16x16x32_bf16 v[76:79], a[172:175], a[204:207], v[76:79]
  s_waitcnt lgkmcnt(0) vmcnt(30)
  s_barrier
  v_mfma_f32_16x16x32_bf16 v[80:83], a[144:147], a[208:211], v[80:83]
  ds_read_b128 a[176:179], v232 offset:0
  v_add_u32 v234, 90112, v10
  v_mfma_f32_16x16x32_bf16 v[80:83], a[160:163], a[212:215], v[80:83]
  buffer_load_dwordx4 a[48:51], v4, s[12:15], s43 offen offset:0 nt
  v_mfma_f32_16x16x32_bf16 v[84:87], a[148:151], a[208:211], v[84:87]
  ds_read_b128 a[180:183], v233 offset:0
  v_add_u32 v235, 90112, v11
  v_mfma_f32_16x16x32_bf16 v[84:87], a[164:167], a[212:215], v[84:87]
  buffer_load_dwordx4 a[52:55], v5, s[12:15], s43 offen offset:1024 nt
  v_mfma_f32_16x16x32_bf16 v[88:91], a[152:155], a[208:211], v[88:91]
  ds_read_b128 a[184:187], v232 offset:2048
  v_mfma_f32_16x16x32_bf16 v[88:91], a[168:171], a[212:215], v[88:91]
  buffer_load_dwordx4 a[56:59], v6, s[12:15], s43 offen offset:2048 nt
  v_mfma_f32_16x16x32_bf16 v[92:95], a[156:159], a[208:211], v[92:95]
  ds_read_b128 a[188:191], v233 offset:2048
  v_mfma_f32_16x16x32_bf16 v[92:95], a[172:175], a[212:215], v[92:95]
  ds_read_b128 a[192:195], v232 offset:4096
  v_mfma_f32_16x16x32_bf16 v[128:131], a[144:147], a[216:219], v[128:131]
  buffer_load_dwordx4 a[60:63], v7, s[12:15], s43 offen offset:3072 nt
  v_mfma_f32_16x16x32_bf16 v[128:131], a[160:163], a[220:223], v[128:131]
  s_add_u32 m0, 45056, s3
  ds_read_b128 a[196:199], v233 offset:4096
  v_mfma_f32_16x16x32_bf16 v[132:135], a[148:151], a[216:219], v[132:135]
  buffer_load_dwordx4 v204, s[8:11], s33 offen offset:0 lds
  v_mfma_f32_16x16x32_bf16 v[132:135], a[164:167], a[220:223], v[132:135]
  ds_read_b128 a[200:203], v232 offset:6144
  v_mfma_f32_16x16x32_bf16 v[136:139], a[152:155], a[216:219], v[136:139]
  buffer_load_dwordx4 v205, s[8:11], s33 offen offset:1024 lds
  v_mfma_f32_16x16x32_bf16 v[136:139], a[168:171], a[220:223], v[136:139]
  ds_read_b128 a[204:207], v233 offset:6144
  v_mfma_f32_16x16x32_bf16 v[140:143], a[156:159], a[216:219], v[140:143]
  v_mfma_f32_16x16x32_bf16 v[140:143], a[172:175], a[220:223], v[140:143]
  buffer_load_dwordx4 v206, s[8:11], s33 offen offset:2048 lds
  v_mfma_f32_16x16x32_bf16 v[144:147], a[144:147], a[224:227], v[144:147]
  s_add_u32 s38, s38, 128
  s_xor_b32 s33, s38, s95
  s_add_u32 m0, 0, s37
  v_mfma_f32_16x16x32_bf16 v[144:147], a[160:163], a[228:231], v[144:147]
  s_add_u32 s33, s33, s99
  s_and_b32 s33, s33, 2047
  s_lshl_b32 s34, s33, 12
  buffer_load_dwordx4 v207, s[20:23], s34 offen offset:0 lds
  v_mfma_f32_16x16x32_bf16 v[148:151], a[148:151], a[224:227], v[148:151]
  v_mfma_f32_16x16x32_bf16 v[148:151], a[164:167], a[228:231], v[148:151]
  buffer_load_dwordx4 v208, s[20:23], s34 offen offset:1024 lds
  v_mfma_f32_16x16x32_bf16 v[152:155], a[152:155], a[224:227], v[152:155]
  v_mfma_f32_16x16x32_bf16 v[152:155], a[168:171], a[228:231], v[152:155]
  v_mfma_f32_16x16x32_bf16 v[156:159], a[156:159], a[224:227], v[156:159]
  v_mfma_f32_16x16x32_bf16 v[156:159], a[172:175], a[228:231], v[156:159]
  s_waitcnt lgkmcnt(0) vmcnt(28)
  s_barrier
  v_mfma_f32_16x16x32_bf16 v[16:19], a[112:115], a[176:179], v[16:19]
  ds_read_b128 a[208:211], v232 offset:8192
  v_mfma_f32_16x16x32_bf16 v[16:19], a[128:131], a[180:183], v[16:19]
  buffer_load_dwordx4 v209, s[20:23], s34 offen offset:2048 lds
  v_mfma_f32_16x16x32_bf16 v[20:23], a[116:119], a[176:179], v[20:23]
  ds_read_b128 a[212:215], v233 offset:8192
  v_mfma_f32_16x16x32_bf16 v[20:23], a[132:135], a[180:183], v[20:23]
  ds_read_b128 a[216:219], v232 offset:10240
  v_mfma_f32_16x16x32_bf16 v[24:27], a[120:123], a[176:179], v[24:27]
  ds_read_b128 a[220:223], v233 offset:10240
  v_mfma_f32_16x16x32_bf16 v[24:27], a[136:139], a[180:183], v[24:27]
  buffer_load_dwordx4 v210, s[20:23], s34 offen offset:3072 lds
  v_mfma_f32_16x16x32_bf16 v[28:31], a[124:127], a[176:179], v[28:31]
  ds_read_b128 a[224:227], v232 offset:12288
  v_mfma_f32_16x16x32_bf16 v[28:31], a[140:143], a[180:183], v[28:31]
  ds_read_b128 a[228:231], v233 offset:12288
  v_mfma_f32_16x16x32_bf16 v[32:35], a[112:115], a[184:187], v[32:35]
  ds_read_b64_tr_b16 a[144:145], v234 offset:28672
  v_add_u32 v232, 90112, v8
  v_mfma_f32_16x16x32_bf16 v[32:35], a[128:131], a[188:191], v[32:35]
  s_add_u32 m0, 0, s36
  ds_read_b64_tr_b16 a[146:147], v234 offset:29696
  v_mfma_f32_16x16x32_bf16 v[36:39], a[116:119], a[184:187], v[36:39]
  buffer_load_dwordx4 v200, s[8:11], s33 offen offset:0 lds
  v_mfma_f32_16x16x32_bf16 v[36:39], a[132:135], a[188:191], v[36:39]
  ds_read_b64_tr_b16 a[148:149], v234 offset:28680
  v_add_u32 v233, 90112, v9
  v_mfma_f32_16x16x32_bf16 v[40:43], a[120:123], a[184:187], v[40:43]
  ds_read_b64_tr_b16 a[150:151], v234 offset:29704
  v_mfma_f32_16x16x32_bf16 v[40:43], a[136:139], a[188:191], v[40:43]
  ds_read_b64_tr_b16 a[152:153], v235 offset:28672
  v_mfma_f32_16x16x32_bf16 v[44:47], a[124:127], a[184:187], v[44:47]
  ds_read_b64_tr_b16 a[154:155], v235 offset:29696
  v_mfma_f32_16x16x32_bf16 v[44:47], a[140:143], a[188:191], v[44:47]
  buffer_load_dwordx4 v201, s[8:11], s33 offen offset:1024 lds
  v_mfma_f32_16x16x32_bf16 v[48:51], a[112:115], a[192:195], v[48:51]
  ds_read_b64_tr_b16 a[156:157], v235 offset:28680
  v_mfma_f32_16x16x32_bf16 v[48:51], a[128:131], a[196:199], v[48:51]
  ds_read_b64_tr_b16 a[158:159], v235 offset:29704
  v_mfma_f32_16x16x32_bf16 v[52:55], a[116:119], a[192:195], v[52:55]
  ds_read_b64_tr_b16 a[160:161], v234 offset:36864
  v_mfma_f32_16x16x32_bf16 v[52:55], a[132:135], a[196:199], v[52:55]
  ds_read_b64_tr_b16 a[162:163], v234 offset:37888
  v_mfma_f32_16x16x32_bf16 v[56:59], a[120:123], a[192:195], v[56:59]
  buffer_load_dwordx4 v202, s[8:11], s33 offen offset:2048 lds
  v_mfma_f32_16x16x32_bf16 v[56:59], a[136:139], a[196:199], v[56:59]
  ds_read_b64_tr_b16 a[164:165], v234 offset:36872
  v_mfma_f32_16x16x32_bf16 v[60:63], a[124:127], a[192:195], v[60:63]
  ds_read_b64_tr_b16 a[166:167], v234 offset:37896
  v_mfma_f32_16x16x32_bf16 v[60:63], a[140:143], a[196:199], v[60:63]
  ds_read_b64_tr_b16 a[168:169], v235 offset:36864
  v_mfma_f32_16x16x32_bf16 v[64:67], a[112:115], a[200:203], v[64:67]
  ds_read_b64_tr_b16 a[170:171], v235 offset:37888
  v_mfma_f32_16x16x32_bf16 v[64:67], a[128:131], a[204:207], v[64:67]
  buffer_load_dwordx4 v203, s[8:11], s33 offen offset:3072 lds
  v_mfma_f32_16x16x32_bf16 v[68:71], a[116:119], a[200:203], v[68:71]
  ds_read_b64_tr_b16 a[172:173], v235 offset:36872
  v_mfma_f32_16x16x32_bf16 v[68:71], a[132:135], a[204:207], v[68:71]
  ds_read_b64_tr_b16 a[174:175], v235 offset:37896
  v_mfma_f32_16x16x32_bf16 v[72:75], a[120:123], a[200:203], v[72:75]
  v_mfma_f32_16x16x32_bf16 v[72:75], a[136:139], a[204:207], v[72:75]
  v_mfma_f32_16x16x32_bf16 v[76:79], a[124:127], a[200:203], v[76:79]
  v_mfma_f32_16x16x32_bf16 v[76:79], a[140:143], a[204:207], v[76:79]
  s_waitcnt lgkmcnt(0) vmcnt(30)
  s_barrier
  v_mfma_f32_16x16x32_bf16 v[80:83], a[112:115], a[208:211], v[80:83]
  ds_read_b128 a[176:179], v232 offset:0
  v_add_u32 v234, 45056, v10
  v_mfma_f32_16x16x32_bf16 v[80:83], a[128:131], a[212:215], v[80:83]
  buffer_load_dwordx4 a[64:67], v4, s[16:19], s43 offen offset:0 nt
  v_mfma_f32_16x16x32_bf16 v[84:87], a[116:119], a[208:211], v[84:87]
  ds_read_b128 a[180:183], v233 offset:0
  v_add_u32 v235, 45056, v11
  v_mfma_f32_16x16x32_bf16 v[84:87], a[132:135], a[212:215], v[84:87]
  buffer_load_dwordx4 a[68:71], v5, s[16:19], s43 offen offset:1024 nt
  v_mfma_f32_16x16x32_bf16 v[88:91], a[120:123], a[208:211], v[88:91]
  ds_read_b128 a[184:187], v232 offset:2048
  v_mfma_f32_16x16x32_bf16 v[88:91], a[136:139], a[212:215], v[88:91]
  ds_read_b128 a[188:191], v233 offset:2048
  v_mfma_f32_16x16x32_bf16 v[92:95], a[124:127], a[208:211], v[92:95]
  buffer_load_dwordx4 a[72:75], v6, s[16:19], s43 offen offset:2048 nt
  v_mfma_f32_16x16x32_bf16 v[92:95], a[140:143], a[212:215], v[92:95]
  ds_read_b128 a[192:195], v232 offset:4096
  v_mfma_f32_16x16x32_bf16 v[128:131], a[112:115], a[216:219], v[128:131]
  buffer_load_dwordx4 a[76:79], v7, s[16:19], s43 offen offset:3072 nt
  v_mfma_f32_16x16x32_bf16 v[128:131], a[128:131], a[220:223], v[128:131]
  s_add_u32 s43, s43, 16384
  s_and_b32 s43, s43, 0x3ffff
  ds_read_b128 a[196:199], v233 offset:4096
  v_mfma_f32_16x16x32_bf16 v[132:135], a[116:119], a[216:219], v[132:135]
  s_add_u32 m0, 0, s3
  ds_read_b128 a[200:203], v232 offset:6144
  v_mfma_f32_16x16x32_bf16 v[132:135], a[132:135], a[220:223], v[132:135]
  buffer_load_dwordx4 v204, s[8:11], s33 offen offset:0 lds
  v_mfma_f32_16x16x32_bf16 v[136:139], a[120:123], a[216:219], v[136:139]
  ds_read_b128 a[204:207], v233 offset:6144
  v_mfma_f32_16x16x32_bf16 v[136:139], a[136:139], a[220:223], v[136:139]
  v_mfma_f32_16x16x32_bf16 v[140:143], a[124:127], a[216:219], v[140:143]
  buffer_load_dwordx4 v205, s[8:11], s33 offen offset:1024 lds
  v_mfma_f32_16x16x32_bf16 v[140:143], a[140:143], a[220:223], v[140:143]
  v_mfma_f32_16x16x32_bf16 v[144:147], a[112:115], a[224:227], v[144:147]
  buffer_load_dwordx4 v206, s[8:11], s33 offen offset:2048 lds
  v_mfma_f32_16x16x32_bf16 v[144:147], a[128:131], a[228:231], v[144:147]
  s_add_u32 s38, s38, 128
  s_xor_b32 s33, s38, s95
  v_mfma_f32_16x16x32_bf16 v[148:151], a[116:119], a[224:227], v[148:151]
  s_add_u32 s33, s33, s99
  s_and_b32 s33, s33, 2047
  v_mfma_f32_16x16x32_bf16 v[148:151], a[132:135], a[228:231], v[148:151]
  s_lshl_b32 s34, s33, 12
  global_load_dword v250, v215, s[4:5]
  v_mfma_f32_16x16x32_bf16 v[152:155], a[120:123], a[224:227], v[152:155]
  v_mfma_f32_16x16x32_bf16 v[152:155], a[136:139], a[228:231], v[152:155]
  v_mfma_f32_16x16x32_bf16 v[156:159], a[124:127], a[224:227], v[156:159]
  v_mfma_f32_16x16x32_bf16 v[156:159], a[140:143], a[228:231], v[156:159]
  s_waitcnt lgkmcnt(0) vmcnt(27)
  s_barrier
  v_mfma_f32_16x16x32_bf16 v[16:19], a[144:147], a[176:179], v[16:19]
  ds_read_b128 a[208:211], v232 offset:8192
  v_mfma_f32_16x16x32_bf16 v[16:19], a[160:163], a[180:183], v[16:19]
  buffer_load_dwordx4 v[96:99], v4, s[12:15], s43 offen offset:0 nt
  v_mfma_f32_16x16x32_bf16 v[20:23], a[148:151], a[176:179], v[20:23]
  ds_read_b128 a[212:215], v233 offset:8192
  v_mfma_f32_16x16x32_bf16 v[20:23], a[164:167], a[180:183], v[20:23]
  ds_read_b128 a[216:219], v232 offset:10240
  v_mfma_f32_16x16x32_bf16 v[24:27], a[152:155], a[176:179], v[24:27]
  ds_read_b128 a[220:223], v233 offset:10240
  v_mfma_f32_16x16x32_bf16 v[24:27], a[168:171], a[180:183], v[24:27]
  ds_read_b128 a[224:227], v232 offset:12288
  v_mfma_f32_16x16x32_bf16 v[28:31], a[156:159], a[176:179], v[28:31]
  ds_read_b128 a[228:231], v233 offset:12288
  v_mfma_f32_16x16x32_bf16 v[28:31], a[172:175], a[180:183], v[28:31]
  ds_read_b64_tr_b16 a[112:113], v234 offset:28672
  v_add_u32 v232, 45056, v8
  v_mfma_f32_16x16x32_bf16 v[32:35], a[144:147], a[184:187], v[32:35]
  ds_read_b64_tr_b16 a[114:115], v234 offset:29696
  v_add_u32 v233, 45056, v9
  v_mfma_f32_16x16x32_bf16 v[32:35], a[160:163], a[188:191], v[32:35]
  ds_read_b64_tr_b16 a[116:117], v234 offset:28680
  v_mfma_f32_16x16x32_bf16 v[36:39], a[148:151], a[184:187], v[36:39]
  ds_read_b64_tr_b16 a[118:119], v234 offset:29704
  v_mfma_f32_16x16x32_bf16 v[36:39], a[164:167], a[188:191], v[36:39]
  ds_read_b64_tr_b16 a[120:121], v235 offset:28672
  v_mfma_f32_16x16x32_bf16 v[40:43], a[152:155], a[184:187], v[40:43]
  ds_read_b64_tr_b16 a[122:123], v235 offset:29696
  v_mfma_f32_16x16x32_bf16 v[40:43], a[168:171], a[188:191], v[40:43]
  ds_read_b64_tr_b16 a[124:125], v235 offset:28680
  v_mfma_f32_16x16x32_bf16 v[44:47], a[156:159], a[184:187], v[44:47]
  ds_read_b64_tr_b16 a[126:127], v235 offset:29704
  v_mfma_f32_16x16x32_bf16 v[44:47], a[172:175], a[188:191], v[44:47]
  buffer_load_dwordx4 v[100:103], v5, s[12:15], s43 offen offset:1024 nt
  v_mfma_f32_16x16x32_bf16 v[48:51], a[144:147], a[192:195], v[48:51]
  ds_read_b64_tr_b16 a[128:129], v234 offset:36864
  v_mfma_f32_16x16x32_bf16 v[48:51], a[160:163], a[196:199], v[48:51]
  ds_read_b64_tr_b16 a[130:131], v234 offset:37888
  v_mfma_f32_16x16x32_bf16 v[52:55], a[148:151], a[192:195], v[52:55]
  ds_read_b64_tr_b16 a[132:133], v234 offset:36872
  v_mfma_f32_16x16x32_bf16 v[52:55], a[164:167], a[196:199], v[52:55]
  ds_read_b64_tr_b16 a[134:135], v234 offset:37896
  v_mfma_f32_16x16x32_bf16 v[56:59], a[152:155], a[192:195], v[56:59]
  ds_read_b64_tr_b16 a[136:137], v235 offset:36864
  v_mfma_f32_16x16x32_bf16 v[56:59], a[168:171], a[196:199], v[56:59]
  ds_read_b64_tr_b16 a[138:139], v235 offset:37888
  v_mfma_f32_16x16x32_bf16 v[60:63], a[156:159], a[192:195], v[60:63]
  ds_read_b64_tr_b16 a[140:141], v235 offset:36872
  v_mfma_f32_16x16x32_bf16 v[60:63], a[172:175], a[196:199], v[60:63]
  ds_read_b64_tr_b16 a[142:143], v235 offset:37896
  v_mfma_f32_16x16x32_bf16 v[64:67], a[144:147], a[200:203], v[64:67]
  v_mfma_f32_16x16x32_bf16 v[64:67], a[160:163], a[204:207], v[64:67]
  v_mfma_f32_16x16x32_bf16 v[68:71], a[148:151], a[200:203], v[68:71]
  v_mfma_f32_16x16x32_bf16 v[68:71], a[164:167], a[204:207], v[68:71]
  v_mfma_f32_16x16x32_bf16 v[72:75], a[152:155], a[200:203], v[72:75]
  v_mfma_f32_16x16x32_bf16 v[72:75], a[168:171], a[204:207], v[72:75]
  v_mfma_f32_16x16x32_bf16 v[76:79], a[156:159], a[200:203], v[76:79]
  v_mfma_f32_16x16x32_bf16 v[76:79], a[172:175], a[204:207], v[76:79]
  s_waitcnt lgkmcnt(0) vmcnt(25)
  s_barrier
  v_mfma_f32_16x16x32_bf16 v[80:83], a[144:147], a[208:211], v[80:83]
  ds_read_b128 a[176:179], v232 offset:0
  v_add_u32 v234, 0, v10
  v_mfma_f32_16x16x32_bf16 v[80:83], a[160:163], a[212:215], v[80:83]
  buffer_load_dwordx4 v[104:107], v6, s[12:15], s43 offen offset:2048 nt
  v_mfma_f32_16x16x32_bf16 v[84:87], a[148:151], a[208:211], v[84:87]
  ds_read_b128 a[180:183], v233 offset:0
  v_add_u32 v235, 0, v11
  v_mfma_f32_16x16x32_bf16 v[84:87], a[164:167], a[212:215], v[84:87]
  buffer_load_dwordx4 v[108:111], v7, s[12:15], s43 offen offset:3072 nt
  v_mfma_f32_16x16x32_bf16 v[88:91], a[152:155], a[208:211], v[88:91]
  ds_read_b128 a[184:187], v232 offset:2048
  v_mfma_f32_16x16x32_bf16 v[88:91], a[168:171], a[212:215], v[88:91]
  s_waitcnt vmcnt(62)
  ds_read_b128 a[188:191], v233 offset:2048
  v_mfma_f32_16x16x32_bf16 v[92:95], a[156:159], a[208:211], v[92:95]
  ds_write_b128 v216, v[160:163] offset:0
  v_mfma_f32_16x16x32_bf16 v[92:95], a[172:175], a[212:215], v[92:95]
  ds_read_b128 a[192:195], v232 offset:4096
  v_mfma_f32_16x16x32_bf16 v[128:131], a[144:147], a[216:219], v[128:131]
  ds_write_b128 v216, v[164:167] offset:1024
  v_mfma_f32_16x16x32_bf16 v[128:131], a[160:163], a[220:223], v[128:131]
  ds_read_b128 a[196:199], v233 offset:4096
  v_mfma_f32_16x16x32_bf16 v[132:135], a[148:151], a[216:219], v[132:135]
  ds_read_b128 a[200:203], v232 offset:6144
  v_mfma_f32_16x16x32_bf16 v[132:135], a[164:167], a[220:223], v[132:135]
  ds_write_b128 v216, v[168:171] offset:2048
  v_mfma_f32_16x16x32_bf16 v[136:139], a[152:155], a[216:219], v[136:139]
  ds_read_b128 a[204:207], v233 offset:6144
  v_mfma_f32_16x16x32_bf16 v[136:139], a[168:171], a[220:223], v[136:139]
  v_mfma_f32_16x16x32_bf16 v[140:143], a[156:159], a[216:219], v[140:143]
  ds_write_b128 v216, v[172:175] offset:3072
  v_mfma_f32_16x16x32_bf16 v[140:143], a[172:175], a[220:223], v[140:143]
  s_waitcnt vmcnt(62)
  v_mfma_f32_16x16x32_bf16 v[144:147], a[144:147], a[224:227], v[144:147]
  ds_write_b128 v211, v[176:179] offset:49152
  v_mfma_f32_16x16x32_bf16 v[144:147], a[160:163], a[228:231], v[144:147]
  v_mfma_f32_16x16x32_bf16 v[148:151], a[148:151], a[224:227], v[148:151]
  v_mfma_f32_16x16x32_bf16 v[148:151], a[164:167], a[228:231], v[148:151]
  ds_write_b128 v211, v[180:183] offset:50176
  v_mfma_f32_16x16x32_bf16 v[152:155], a[152:155], a[224:227], v[152:155]
  v_mfma_f32_16x16x32_bf16 v[152:155], a[168:171], a[228:231], v[152:155]
  v_mfma_f32_16x16x32_bf16 v[156:159], a[156:159], a[224:227], v[156:159]
  v_mfma_f32_16x16x32_bf16 v[156:159], a[172:175], a[228:231], v[156:159]
  s_waitcnt lgkmcnt(0) vmcnt(16)
  s_barrier
  v_mfma_f32_16x16x32_bf16 v[16:19], a[112:115], a[176:179], v[16:19]
  ds_read_b128 a[208:211], v232 offset:8192
  v_mfma_f32_16x16x32_bf16 v[16:19], a[128:131], a[180:183], v[16:19]
  buffer_load_dwordx4 v[112:115], v4, s[16:19], s43 offen offset:0 nt
  v_mfma_f32_16x16x32_bf16 v[20:23], a[116:119], a[176:179], v[20:23]
  ds_read_b128 a[212:215], v233 offset:8192
  v_mfma_f32_16x16x32_bf16 v[20:23], a[132:135], a[180:183], v[20:23]
  ds_read_b128 a[216:219], v232 offset:10240
  v_mfma_f32_16x16x32_bf16 v[24:27], a[120:123], a[176:179], v[24:27]
  buffer_load_dwordx4 v[116:119], v5, s[16:19], s43 offen offset:1024 nt
  v_mfma_f32_16x16x32_bf16 v[24:27], a[136:139], a[180:183], v[24:27]
  ds_read_b128 a[220:223], v233 offset:10240
  v_mfma_f32_16x16x32_bf16 v[28:31], a[124:127], a[176:179], v[28:31]
  ds_read_b128 a[224:227], v232 offset:12288
  v_mfma_f32_16x16x32_bf16 v[28:31], a[140:143], a[180:183], v[28:31]
  ds_read_b128 a[228:231], v233 offset:12288
  v_mfma_f32_16x16x32_bf16 v[32:35], a[112:115], a[184:187], v[32:35]
  ds_write_b128 v211, v[184:187] offset:51200
  v_mfma_f32_16x16x32_bf16 v[32:35], a[128:131], a[188:191], v[32:35]
  ds_read_b64_tr_b16 a[144:145], v234 offset:28672
  v_add_u32 v232, 0, v8
  v_mfma_f32_16x16x32_bf16 v[36:39], a[116:119], a[184:187], v[36:39]
  ds_read_b64_tr_b16 a[146:147], v234 offset:29696
  v_add_u32 v233, 0, v9
  v_mfma_f32_16x16x32_bf16 v[36:39], a[132:135], a[188:191], v[36:39]
  ds_write_b128 v211, v[188:191] offset:52224
  v_mfma_f32_16x16x32_bf16 v[40:43], a[120:123], a[184:187], v[40:43]
  ds_read_b64_tr_b16 a[148:149], v234 offset:28680
  v_mfma_f32_16x16x32_bf16 v[40:43], a[136:139], a[188:191], v[40:43]
  ds_read_b64_tr_b16 a[150:151], v234 offset:29704
  v_mfma_f32_16x16x32_bf16 v[44:47], a[124:127], a[184:187], v[44:47]
  s_waitcnt vmcnt(62)
  ds_read_b64_tr_b16 a[152:153], v235 offset:28672
  v_mfma_f32_16x16x32_bf16 v[44:47], a[140:143], a[188:191], v[44:47]
  ds_write_b128 v211, a[0:3] offset:32768
  v_mfma_f32_16x16x32_bf16 v[48:51], a[112:115], a[192:195], v[48:51]
  ds_read_b64_tr_b16 a[154:155], v235 offset:29696
  v_mfma_f32_16x16x32_bf16 v[48:51], a[128:131], a[196:199], v[48:51]
  ds_read_b64_tr_b16 a[156:157], v235 offset:28680
  v_mfma_f32_16x16x32_bf16 v[52:55], a[116:119], a[192:195], v[52:55]
  ds_read_b64_tr_b16 a[158:159], v235 offset:29704
  v_mfma_f32_16x16x32_bf16 v[52:55], a[132:135], a[196:199], v[52:55]
  ds_write_b128 v211, a[4:7] offset:33792
  v_mfma_f32_16x16x32_bf16 v[56:59], a[120:123], a[192:195], v[56:59]
  ds_read_b64_tr_b16 a[160:161], v234 offset:36864
  v_mfma_f32_16x16x32_bf16 v[56:59], a[136:139], a[196:199], v[56:59]
  ds_read_b64_tr_b16 a[162:163], v234 offset:37888
  v_mfma_f32_16x16x32_bf16 v[60:63], a[124:127], a[192:195], v[60:63]
  ds_write_b128 v211, a[8:11] offset:34816
  v_mfma_f32_16x16x32_bf16 v[60:63], a[140:143], a[196:199], v[60:63]
  ds_read_b64_tr_b16 a[164:165], v234 offset:36872
  v_mfma_f32_16x16x32_bf16 v[64:67], a[112:115], a[200:203], v[64:67]
  ds_read_b64_tr_b16 a[166:167], v234 offset:37896
  v_mfma_f32_16x16x32_bf16 v[64:67], a[128:131], a[204:207], v[64:67]
  ds_read_b64_tr_b16 a[168:169], v235 offset:36864
  v_mfma_f32_16x16x32_bf16 v[68:71], a[116:119], a[200:203], v[68:71]
  ds_write_b128 v211, a[12:15] offset:35840
  v_mfma_f32_16x16x32_bf16 v[68:71], a[132:135], a[204:207], v[68:71]
  ds_read_b64_tr_b16 a[170:171], v235 offset:37888
  v_mfma_f32_16x16x32_bf16 v[72:75], a[120:123], a[200:203], v[72:75]
  ds_read_b64_tr_b16 a[172:173], v235 offset:36872
  v_mfma_f32_16x16x32_bf16 v[72:75], a[136:139], a[204:207], v[72:75]
  ds_read_b64_tr_b16 a[174:175], v235 offset:37896
  v_mfma_f32_16x16x32_bf16 v[76:79], a[124:127], a[200:203], v[76:79]
  v_mfma_f32_16x16x32_bf16 v[76:79], a[140:143], a[204:207], v[76:79]
  s_waitcnt lgkmcnt(0) vmcnt(14)
  s_barrier
  v_mfma_f32_16x16x32_bf16 v[80:83], a[112:115], a[208:211], v[80:83]
  ds_read_b128 a[176:179], v232 offset:0
  v_mfma_f32_16x16x32_bf16 v[80:83], a[128:131], a[212:215], v[80:83]
  buffer_load_dwordx4 v[120:123], v6, s[16:19], s43 offen offset:2048 nt
  v_mfma_f32_16x16x32_bf16 v[84:87], a[116:119], a[208:211], v[84:87]
  ds_read_b128 a[180:183], v233 offset:0
  v_mfma_f32_16x16x32_bf16 v[84:87], a[132:135], a[212:215], v[84:87]
  ds_read_b128 a[184:187], v232 offset:2048
  v_mfma_f32_16x16x32_bf16 v[88:91], a[120:123], a[208:211], v[88:91]
  buffer_load_dwordx4 v[124:127], v7, s[16:19], s43 offen offset:3072 nt
  v_mfma_f32_16x16x32_bf16 v[88:91], a[136:139], a[212:215], v[88:91]
  s_add_u32 s43, s43, 16384
  s_and_b32 s43, s43, 0x3ffff
  ds_read_b128 a[188:191], v233 offset:2048
  v_mfma_f32_16x16x32_bf16 v[92:95], a[124:127], a[208:211], v[92:95]
  s_waitcnt vmcnt(57)
  ds_read_b128 a[192:195], v232 offset:4096
  v_mfma_f32_16x16x32_bf16 v[92:95], a[140:143], a[212:215], v[92:95]
  ds_write_b128 v211, a[16:19] offset:16384
  v_mfma_f32_16x16x32_bf16 v[128:131], a[112:115], a[216:219], v[128:131]
  ds_read_b128 a[196:199], v233 offset:4096
  v_mfma_f32_16x16x32_bf16 v[128:131], a[128:131], a[220:223], v[128:131]
  ds_read_b128 a[200:203], v232 offset:6144
  v_mfma_f32_16x16x32_bf16 v[132:135], a[116:119], a[216:219], v[132:135]
  ds_write_b128 v211, a[20:23] offset:17408
  v_mfma_f32_16x16x32_bf16 v[132:135], a[132:135], a[220:223], v[132:135]
  ds_read_b128 a[204:207], v233 offset:6144
  v_mfma_f32_16x16x32_bf16 v[136:139], a[120:123], a[216:219], v[136:139]
  v_mfma_f32_16x16x32_bf16 v[136:139], a[136:139], a[220:223], v[136:139]
  ds_write_b128 v211, a[24:27] offset:18432
  v_mfma_f32_16x16x32_bf16 v[140:143], a[124:127], a[216:219], v[140:143]
  v_mfma_f32_16x16x32_bf16 v[140:143], a[140:143], a[220:223], v[140:143]
  v_mfma_f32_16x16x32_bf16 v[144:147], a[112:115], a[224:227], v[144:147]
  ds_write_b128 v211, a[28:31] offset:19456
  v_mfma_f32_16x16x32_bf16 v[144:147], a[128:131], a[228:231], v[144:147]
  v_mfma_f32_16x16x32_bf16 v[148:151], a[116:119], a[224:227], v[148:151]
  s_waitcnt vmcnt(42)
  v_mfma_f32_16x16x32_bf16 v[148:151], a[132:135], a[228:231], v[148:151]
  ds_write_b128 v211, a[32:35] offset:0
  v_mfma_f32_16x16x32_bf16 v[152:155], a[120:123], a[224:227], v[152:155]
  v_mfma_f32_16x16x32_bf16 v[152:155], a[136:139], a[228:231], v[152:155]
  v_mfma_f32_16x16x32_bf16 v[156:159], a[124:127], a[224:227], v[156:159]
  v_mfma_f32_16x16x32_bf16 v[156:159], a[140:143], a[228:231], v[156:159]
  s_waitcnt lgkmcnt(0) vmcnt(9)
  s_barrier
  v_mfma_f32_16x16x32_bf16 v[16:19], a[144:147], a[176:179], v[16:19]
  ds_read_b128 a[208:211], v232 offset:8192
  v_mfma_f32_16x16x32_bf16 v[16:19], a[160:163], a[180:183], v[16:19]
  buffer_load_dword v250, v254, s[12:15], s62 offen offset:0
  v_mfma_f32_16x16x32_bf16 v[20:23], a[148:151], a[176:179], v[20:23]
  ds_read_b128 a[212:215], v233 offset:8192
  v_mfma_f32_16x16x32_bf16 v[20:23], a[164:167], a[180:183], v[20:23]
  ds_read_b128 a[216:219], v232 offset:10240
  v_mfma_f32_16x16x32_bf16 v[24:27], a[152:155], a[176:179], v[24:27]
  ds_read_b128 a[220:223], v233 offset:10240
  v_mfma_f32_16x16x32_bf16 v[24:27], a[168:171], a[180:183], v[24:27]
  ds_read_b128 a[224:227], v232 offset:12288
  v_mfma_f32_16x16x32_bf16 v[28:31], a[156:159], a[176:179], v[28:31]
  ds_read_b128 a[228:231], v233 offset:12288
  v_mfma_f32_16x16x32_bf16 v[28:31], a[172:175], a[180:183], v[28:31]
  v_mfma_f32_16x16x32_bf16 v[32:35], a[144:147], a[184:187], v[32:35]
  ds_write_b128 v211, a[36:39] offset:1024
  v_mfma_f32_16x16x32_bf16 v[32:35], a[160:163], a[188:191], v[32:35]
  v_mfma_f32_16x16x32_bf16 v[36:39], a[148:151], a[184:187], v[36:39]
  v_mfma_f32_16x16x32_bf16 v[36:39], a[164:167], a[188:191], v[36:39]
  v_mfma_f32_16x16x32_bf16 v[40:43], a[152:155], a[184:187], v[40:43]
  v_mul_f32 v16, s50, v16
  v_mul_f32 v17, s50, v17
  v_mfma_f32_16x16x32_bf16 v[40:43], a[168:171], a[188:191], v[40:43]
  v_mul_f32 v18, s50, v18
  v_mul_f32 v19, s50, v19
  v_mfma_f32_16x16x32_bf16 v[44:47], a[156:159], a[184:187], v[44:47]
  v_mul_f32 v20, s50, v20
  v_mul_f32 v21, s50, v21
  v_mfma_f32_16x16x32_bf16 v[44:47], a[172:175], a[188:191], v[44:47]
  ds_write_b128 v211, a[40:43] offset:2048
  v_mfma_f32_16x16x32_bf16 v[48:51], a[144:147], a[192:195], v[48:51]
  v_mul_f32 v22, s50, v22
  v_mul_f32 v23, s50, v23
  v_mfma_f32_16x16x32_bf16 v[48:51], a[160:163], a[196:199], v[48:51]
  v_cvt_pk_bf16_f32 v160, v16, v17
  v_cvt_pk_bf16_f32 v161, v18, v19
  v_mfma_f32_16x16x32_bf16 v[52:55], a[148:151], a[192:195], v[52:55]
  v_cvt_pk_bf16_f32 v162, v20, v21
  v_cvt_pk_bf16_f32 v163, v22, v23
  v_mfma_f32_16x16x32_bf16 v[52:55], a[164:167], a[196:199], v[52:55]
  v_mul_f32 v24, s50, v24
  v_mul_f32 v25, s50, v25
  v_mfma_f32_16x16x32_bf16 v[56:59], a[152:155], a[192:195], v[56:59]
  v_mul_f32 v26, s50, v26
  v_mul_f32 v27, s50, v27
  v_mfma_f32_16x16x32_bf16 v[56:59], a[168:171], a[196:199], v[56:59]
  v_mul_f32 v28, s50, v28
  v_mul_f32 v29, s50, v29
  v_mfma_f32_16x16x32_bf16 v[60:63], a[156:159], a[192:195], v[60:63]
  ds_write_b128 v211, a[44:47] offset:3072
  v_mfma_f32_16x16x32_bf16 v[60:63], a[172:175], a[196:199], v[60:63]
  v_mul_f32 v30, s50, v30
  v_mul_f32 v31, s50, v31
  v_mfma_f32_16x16x32_bf16 v[64:67], a[144:147], a[200:203], v[64:67]
  v_cvt_pk_bf16_f32 v164, v24, v25
  v_cvt_pk_bf16_f32 v165, v26, v27
  v_mfma_f32_16x16x32_bf16 v[64:67], a[160:163], a[204:207], v[64:67]
  v_cvt_pk_bf16_f32 v166, v28, v29
  v_cvt_pk_bf16_f32 v167, v30, v31
  v_mfma_f32_16x16x32_bf16 v[68:71], a[148:151], a[200:203], v[68:71]
  v_mul_f32 v32, s50, v32
  v_mul_f32 v33, s50, v33
  v_mfma_f32_16x16x32_bf16 v[68:71], a[164:167], a[204:207], v[68:71]
  v_mul_f32 v34, s50, v34
  v_mul_f32 v35, s50, v35
  v_mfma_f32_16x16x32_bf16 v[72:75], a[152:155], a[200:203], v[72:75]
  v_mul_f32 v36, s50, v36
  v_mul_f32 v37, s50, v37
  v_mfma_f32_16x16x32_bf16 v[72:75], a[168:171], a[204:207], v[72:75]
  v_mul_f32 v38, s50, v38
  v_mul_f32 v39, s50, v39
  v_mfma_f32_16x16x32_bf16 v[76:79], a[156:159], a[200:203], v[76:79]
  v_cvt_pk_bf16_f32 v168, v32, v33
  v_cvt_pk_bf16_f32 v169, v34, v35
  v_mfma_f32_16x16x32_bf16 v[76:79], a[172:175], a[204:207], v[76:79]
  s_waitcnt lgkmcnt(0)
  s_barrier
  v_cvt_pk_bf16_f32 v170, v36, v37
  v_cvt_pk_bf16_f32 v171, v38, v39
  v_mfma_f32_16x16x32_bf16 v[80:83], a[144:147], a[208:211], v[80:83]
  ds_write_b128 v14, v[160:163] offset:0
  v_mfma_f32_16x16x32_bf16 v[80:83], a[160:163], a[212:215], v[80:83]
  buffer_load_dword v250, v254, s[12:15], s62 offen offset:2048
  v_mfma_f32_16x16x32_bf16 v[84:87], a[148:151], a[208:211], v[84:87]
  v_mul_f32 v40, s50, v40
  v_mul_f32 v41, s50, v41
  v_mfma_f32_16x16x32_bf16 v[84:87], a[164:167], a[212:215], v[84:87]
  ds_write_b128 v14, v[164:167] offset:1024
  v_mfma_f32_16x16x32_bf16 v[88:91], a[152:155], a[208:211], v[88:91]
  v_mul_f32 v42, s50, v42
  v_mul_f32 v43, s50, v43
  v_mfma_f32_16x16x32_bf16 v[88:91], a[168:171], a[212:215], v[88:91]
  v_mul_f32 v44, s50, v44
  v_mul_f32 v45, s50, v45
  v_mfma_f32_16x16x32_bf16 v[92:95], a[156:159], a[208:211], v[92:95]
  ds_write_b128 v14, v[168:171] offset:2048
  v_mfma_f32_16x16x32_bf16 v[92:95], a[172:175], a[212:215], v[92:95]
  v_mul_f32 v46, s50, v46
  v_mul_f32 v47, s50, v47
  v_mfma_f32_16x16x32_bf16 v[128:131], a[144:147], a[216:219], v[128:131]
  v_cvt_pk_bf16_f32 v172, v40, v41
  v_cvt_pk_bf16_f32 v173, v42, v43
  v_mfma_f32_16x16x32_bf16 v[128:131], a[160:163], a[220:223], v[128:131]
  v_cvt_pk_bf16_f32 v174, v44, v45
  v_cvt_pk_bf16_f32 v175, v46, v47
  v_mfma_f32_16x16x32_bf16 v[132:135], a[148:151], a[216:219], v[132:135]
  ds_write_b128 v14, v[172:175] offset:3072
  v_mfma_f32_16x16x32_bf16 v[132:135], a[164:167], a[220:223], v[132:135]
  v_mul_f32 v48, s50, v48
  v_mul_f32 v49, s50, v49
  v_mfma_f32_16x16x32_bf16 v[136:139], a[152:155], a[216:219], v[136:139]
  v_mul_f32 v50, s50, v50
  v_mul_f32 v51, s50, v51
  v_mfma_f32_16x16x32_bf16 v[136:139], a[168:171], a[220:223], v[136:139]
  v_mul_f32 v52, s50, v52
  v_mul_f32 v53, s50, v53
  v_mfma_f32_16x16x32_bf16 v[140:143], a[156:159], a[216:219], v[140:143]
  v_mul_f32 v54, s50, v54
  v_mul_f32 v55, s50, v55
  v_mfma_f32_16x16x32_bf16 v[140:143], a[172:175], a[220:223], v[140:143]
  v_cvt_pk_bf16_f32 v176, v48, v49
  v_cvt_pk_bf16_f32 v177, v50, v51
  v_mfma_f32_16x16x32_bf16 v[144:147], a[144:147], a[224:227], v[144:147]
  v_cvt_pk_bf16_f32 v178, v52, v53
  v_cvt_pk_bf16_f32 v179, v54, v55
  v_mfma_f32_16x16x32_bf16 v[144:147], a[160:163], a[228:231], v[144:147]
  ds_write_b128 v14, v[176:179] offset:4096
  v_mfma_f32_16x16x32_bf16 v[148:151], a[148:151], a[224:227], v[148:151]
  v_mul_f32 v56, s50, v56
  v_mul_f32 v57, s50, v57
  v_mfma_f32_16x16x32_bf16 v[148:151], a[164:167], a[228:231], v[148:151]
  v_mul_f32 v58, s50, v58
  v_mul_f32 v59, s50, v59
  v_mfma_f32_16x16x32_bf16 v[152:155], a[152:155], a[224:227], v[152:155]
  v_mul_f32 v60, s50, v60
  v_mul_f32 v61, s50, v61
  v_mfma_f32_16x16x32_bf16 v[152:155], a[168:171], a[228:231], v[152:155]
  v_mul_f32 v62, s50, v62
  v_mul_f32 v63, s50, v63
  v_mfma_f32_16x16x32_bf16 v[156:159], a[156:159], a[224:227], v[156:159]
  v_cvt_pk_bf16_f32 v180, v56, v57
  v_cvt_pk_bf16_f32 v181, v58, v59
  v_mfma_f32_16x16x32_bf16 v[156:159], a[172:175], a[228:231], v[156:159]
  v_cvt_pk_bf16_f32 v182, v60, v61
  v_cvt_pk_bf16_f32 v183, v62, v63
L_trans:
  v_add_u32 v232, 131072, v12
  v_xor_b32 v233, 64, v232
  v_xor_b32 v234, 128, v232
  v_xor_b32 v235, 192, v232
  ds_read_b128 a[224:227], v232 offset:0
  ds_read_b128 a[228:231], v233 offset:0
  ds_read_b128 a[232:235], v234 offset:0
  ds_read_b128 a[236:239], v235 offset:0
  ds_read_b128 a[240:243], v232 offset:4096
  ds_read_b128 a[244:247], v233 offset:4096
  ds_read_b128 a[248:251], v234 offset:4096
  ds_read_b128 a[252:255], v235 offset:4096
  buffer_load_dword v250, v254, s[16:19], s62 offen offset:0
  ds_write_b128 v14, v[180:183] offset:5120
  v_mul_f32 v64, s50, v64
  v_mul_f32 v65, s50, v65
  v_mul_f32 v66, s50, v66
  v_mul_f32 v67, s50, v67
  v_mul_f32 v68, s50, v68
  v_mul_f32 v69, s50, v69
  v_mul_f32 v70, s50, v70
  v_mul_f32 v71, s50, v71
  v_cvt_pk_bf16_f32 v184, v64, v65
  v_cvt_pk_bf16_f32 v185, v66, v67
  v_cvt_pk_bf16_f32 v186, v68, v69
  v_cvt_pk_bf16_f32 v187, v70, v71
  ds_write_b128 v14, v[184:187] offset:6144
  v_mul_f32 v72, s50, v72
  v_mul_f32 v73, s50, v73
  v_mul_f32 v74, s50, v74
  v_mul_f32 v75, s50, v75
  v_mul_f32 v76, s50, v76
  v_mul_f32 v77, s50, v77
  v_mul_f32 v78, s50, v78
  v_mul_f32 v79, s50, v79
  v_cvt_pk_bf16_f32 v188, v72, v73
  v_cvt_pk_bf16_f32 v189, v74, v75
  v_cvt_pk_bf16_f32 v190, v76, v77
  v_cvt_pk_bf16_f32 v191, v78, v79
  ds_write_b128 v14, v[188:191] offset:7168
  v_mul_f32 v80, s50, v80
  v_mul_f32 v81, s50, v81
  v_mul_f32 v82, s50, v82
  v_mul_f32 v83, s50, v83
  v_mul_f32 v84, s50, v84
  v_mul_f32 v85, s50, v85
  v_mul_f32 v86, s50, v86
  v_mul_f32 v87, s50, v87
  v_cvt_pk_bf16_f32 v160, v80, v81
  v_cvt_pk_bf16_f32 v161, v82, v83
  v_cvt_pk_bf16_f32 v162, v84, v85
  v_cvt_pk_bf16_f32 v163, v86, v87
  ds_write_b128 v14, v[160:163] offset:8192
  v_mul_f32 v88, s50, v88
  v_mul_f32 v89, s50, v89
  v_mul_f32 v90, s50, v90
  v_mul_f32 v91, s50, v91
  v_mul_f32 v92, s50, v92
  v_mul_f32 v93, s50, v93
  v_mul_f32 v94, s50, v94
  v_mul_f32 v95, s50, v95
  v_cvt_pk_bf16_f32 v164, v88, v89
  v_cvt_pk_bf16_f32 v165, v90, v91
  v_cvt_pk_bf16_f32 v166, v92, v93
  v_cvt_pk_bf16_f32 v167, v94, v95
  ds_write_b128 v14, v[164:167] offset:9216
  v_mul_f32 v128, s50, v128
  v_mul_f32 v129, s50, v129
  v_mul_f32 v130, s50, v130
  v_mul_f32 v131, s50, v131
  v_mul_f32 v132, s50, v132
  v_mul_f32 v133, s50, v133
  v_mul_f32 v134, s50, v134
  v_mul_f32 v135, s50, v135
  v_cvt_pk_bf16_f32 v168, v128, v129
  v_cvt_pk_bf16_f32 v169, v130, v131
  v_cvt_pk_bf16_f32 v170, v132, v133
  v_cvt_pk_bf16_f32 v171, v134, v135
  ds_write_b128 v14, v[168:171] offset:10240
  v_mul_f32 v136, s50, v136
  v_mul_f32 v137, s50, v137
  v_mul_f32 v138, s50, v138
  v_mul_f32 v139, s50, v139
  v_mul_f32 v140, s50, v140
  v_mul_f32 v141, s50, v141
  v_mul_f32 v142, s50, v142
  v_mul_f32 v143, s50, v143
  v_cvt_pk_bf16_f32 v172, v136, v137
  v_cvt_pk_bf16_f32 v173, v138, v139
  v_cvt_pk_bf16_f32 v174, v140, v141
  v_cvt_pk_bf16_f32 v175, v142, v143
  ds_write_b128 v14, v[172:175] offset:11264
  v_mul_f32 v144, s50, v144
  v_mul_f32 v145, s50, v145
  v_mul_f32 v146, s50, v146
  v_mul_f32 v147, s50, v147
  v_mul_f32 v148, s50, v148
  v_mul_f32 v149, s50, v149
  v_mul_f32 v150, s50, v150
  v_mul_f32 v151, s50, v151
  v_cvt_pk_bf16_f32 v176, v144, v145
  v_cvt_pk_bf16_f32 v177, v146, v147
  v_cvt_pk_bf16_f32 v178, v148, v149
  v_cvt_pk_bf16_f32 v179, v150, v151
  ds_write_b128 v14, v[176:179] offset:12288
  v_mul_f32 v152, s50, v152
  v_mul_f32 v153, s50, v153
  v_mul_f32 v154, s50, v154
  v_mul_f32 v155, s50, v155
  v_mul_f32 v156, s50, v156
  v_mul_f32 v157, s50, v157
  v_mul_f32 v158, s50, v158
  v_mul_f32 v159, s50, v159
  v_cvt_pk_bf16_f32 v180, v152, v153
  v_cvt_pk_bf16_f32 v181, v154, v155
  v_cvt_pk_bf16_f32 v182, v156, v157
  v_cvt_pk_bf16_f32 v183, v158, v159
  ds_write_b128 v14, v[180:183] offset:13312
  ds_read_b128 a[112:115], v14 offset:0
  ds_read_b128 a[116:119], v14 offset:1024
  ds_read_b128 a[128:131], v14 offset:2048
  ds_read_b128 a[132:135], v14 offset:3072
  ds_read_b128 a[144:147], v14 offset:4096
  ds_read_b128 a[148:151], v14 offset:5120
  ds_read_b128 a[160:163], v14 offset:6144
  ds_read_b128 a[164:167], v14 offset:7168
  ds_read_b128 a[176:179], v14 offset:8192
  ds_read_b128 a[180:183], v14 offset:9216
  ds_read_b128 a[192:195], v14 offset:10240
  ds_read_b128 a[196:199], v14 offset:11264
  ds_read_b128 a[208:211], v14 offset:12288
  ds_read_b128 a[212:215], v14 offset:13312
  s_mov_b32 s45, 131072
  s_mov_b32 s46, 98304
  s_mov_b32 s38, 0
  s_waitcnt lgkmcnt(14)
  s_barrier
  ds_read_b128 a[120:123], v2 offset:0
  ds_read_b128 a[124:127], v2 offset:1024
  ds_read_b128 a[136:139], v2 offset:2048
  ds_read_b128 a[140:143], v2 offset:3072
  ds_read_b128 a[152:155], v2 offset:4096
  ds_read_b128 a[156:159], v2 offset:5120
  ds_read_b128 a[168:171], v2 offset:6144
  ds_read_b128 a[172:175], v2 offset:7168
  ds_read_b128 a[184:187], v2 offset:8192
  ds_read_b128 a[188:191], v2 offset:9216
  ds_read_b128 a[200:203], v2 offset:10240
  ds_read_b128 a[204:207], v2 offset:11264
  ds_read_b128 a[216:219], v2 offset:12288
  ds_read_b128 a[220:223], v2 offset:13312
  buffer_load_dword v250, v254, s[16:19], s62 offen offset:2048
  v_add_u32 v14, s7, v1
  v_add_u32 v15, s89, v1
  v_mov_b32 v8, v3
  v_add_u32 v9, 15360, v3
  v_add_u32 v10, 30720, v3
  v_add_u32 v11, 46080, v3
  s_waitcnt lgkmcnt(0)
  s_barrier
  v_mfma_f32_16x16x32_bf16 v[176:179], a[224:227], a[112:115], 0
  ds_read_b64_tr_b16 v[128:129], v236
  v_mfma_f32_16x16x32_bf16 v[176:179], a[228:231], a[116:119], v[176:179]
  ds_read_b64_tr_b16 v[130:131], v236 offset:4096
  v_mfma_f32_16x16x32_bf16 v[176:179], a[232:235], a[120:123], v[176:179]
  ds_read_b64_tr_b16 v[132:133], v237
  v_lshlrev_b32 v252, 11, v0
  v_mfma_f32_16x16x32_bf16 v[176:179], a[236:239], a[124:127], v[176:179]
  ds_read_b64_tr_b16 v[134:135], v237 offset:4096
  v_mfma_f32_16x16x32_bf16 v[180:183], a[240:243], a[112:115], 0
  ds_read_b64_tr_b16 v[136:137], v238
  v_mfma_f32_16x16x32_bf16 v[180:183], a[244:247], a[116:119], v[180:183]
  ds_read_b64_tr_b16 v[138:139], v238 offset:4096
  v_mfma_f32_16x16x32_bf16 v[180:183], a[248:251], a[120:123], v[180:183]
  ds_read_b64_tr_b16 v[140:141], v239
  v_mfma_f32_16x16x32_bf16 v[180:183], a[252:255], a[124:127], v[180:183]
  ds_read_b64_tr_b16 v[142:143], v239 offset:4096
  v_mfma_f32_16x16x32_bf16 v[168:171], a[224:227], a[128:131], 0
  ds_read_b64_tr_b16 v[144:145], v240
  v_mfma_f32_16x16x32_bf16 v[168:171], a[228:231], a[132:135], v[168:171]
  ds_read_b64_tr_b16 v[146:147], v240 offset:4096
  v_mfma_f32_16x16x32_bf16 v[168:171], a[232:235], a[136:139], v[168:171]
  ds_read_b64_tr_b16 v[148:149], v241
  v_mfma_f32_16x16x32_bf16 v[168:171], a[236:239], a[140:143], v[168:171]
  ds_read_b64_tr_b16 v[150:151], v241 offset:4096
  v_max3_f32 v244, v176, v177, v178
  v_max3_f32 v245, v179, v180, v181
  v_max3_f32 v244, v244, v182, v183
  v_mfma_f32_16x16x32_bf16 v[172:175], a[240:243], a[128:131], 0
  ds_read_b64_tr_b16 v[152:153], v242
  v_max_f32 v244, v244, v245
  v_max_f32 v245, v244, v245
  s_nop 0
  v_mfma_f32_16x16x32_bf16 v[172:175], a[244:247], a[132:135], v[172:175]
  ds_read_b64_tr_b16 v[154:155], v242 offset:4096
  v_permlane32_swap_b32 v244, v245
  v_max_f32 v244, v244, v245
  v_mov_b32 v245, v244
  s_nop 0
  v_mfma_f32_16x16x32_bf16 v[172:175], a[248:251], a[136:139], v[172:175]
  ds_read_b64_tr_b16 v[156:157], v243
  v_permlane16_swap_b32 v244, v245
  v_max_f32 v244, v244, v245
  v_sub_f32 v176, v176, v244
  v_mfma_f32_16x16x32_bf16 v[172:175], a[252:255], a[140:143], v[172:175]
  ds_read_b64_tr_b16 v[158:159], v243 offset:4096
  v_exp_f32 v176, v176
  v_sub_f32 v177, v177, v244
  v_exp_f32 v177, v177
  v_sub_f32 v178, v178, v244
  v_mfma_f32_16x16x32_bf16 v[160:163], a[224:227], a[144:147], 0
  v_exp_f32 v178, v178
  v_sub_f32 v179, v179, v244
  v_exp_f32 v179, v179
  v_sub_f32 v180, v180, v244
  v_add_f32 v224, v176, v177
  v_mfma_f32_16x16x32_bf16 v[160:163], a[228:231], a[148:151], v[160:163]
  buffer_load_dword v250, v254, s[12:15], s63 offen offset:0
  v_exp_f32 v180, v180
  v_sub_f32 v181, v181, v244
  v_cvt_pk_bf16_f32 v184, v176, v177
  v_exp_f32 v181, v181
  v_sub_f32 v182, v182, v244
  v_add_f32 v224, v224, v178
  v_mfma_f32_16x16x32_bf16 v[160:163], a[232:235], a[152:155], v[160:163]
  v_exp_f32 v182, v182
  v_sub_f32 v183, v183, v244
  v_add_f32 v224, v224, v179
  v_exp_f32 v183, v183
  v_cvt_pk_bf16_f32 v185, v178, v179
  v_add_f32 v224, v224, v180
  v_mfma_f32_16x16x32_bf16 v[160:163], a[236:239], a[156:159], v[160:163]
  v_cvt_pk_bf16_f32 v186, v180, v181
  v_add_f32 v224, v224, v181
  v_cvt_pk_bf16_f32 v187, v182, v183
  v_add_f32 v224, v224, v182
  v_mfma_f32_16x16x32_bf16 v[164:167], a[240:243], a[144:147], 0
  s_waitcnt vmcnt(32)
  v_add_f32 v224, v224, v183
  v_max3_f32 v246, v168, v169, v170
  v_max3_f32 v247, v171, v172, v173
  v_max3_f32 v246, v246, v174, v175
  v_mfma_f32_16x16x32_bf16 v[164:167], a[244:247], a[148:151], v[164:167]
  ds_write_b128 v253, a[48:51] offset:49152
  v_max_f32 v246, v246, v247
  v_max_f32 v247, v246, v247
  v_sub_f32 v196, 0, v244
  v_mfma_f32_16x16x32_bf16 v[164:167], a[248:251], a[152:155], v[164:167]
  s_waitcnt lgkmcnt(1)
  v_permlane32_swap_b32 v246, v247
  v_max_f32 v246, v246, v247
  v_mov_b32 v247, v246
  v_sub_f32 v197, 0, v244
  v_mfma_f32_16x16x32_bf16 v[164:167], a[252:255], a[156:159], v[164:167]
  v_permlane16_swap_b32 v246, v247
  v_max_f32 v246, v246, v247
  v_sub_f32 v168, v168, v246
  v_mfma_f32_16x16x32_bf16 v[16:19], v[128:131], v[184:187], 0
  v_exp_f32 v168, v168
  v_sub_f32 v169, v169, v246
  v_exp_f32 v169, v169
  v_sub_f32 v170, v170, v246
  v_mfma_f32_16x16x32_bf16 v[20:23], v[132:135], v[184:187], 0
  ds_write_b128 v253, a[52:55] offset:50176
  v_exp_f32 v170, v170
  v_sub_f32 v171, v171, v246
  v_mfma_f32_16x16x32_bf16 v[24:27], v[136:139], v[184:187], 0
  v_exp_f32 v171, v171
  v_sub_f32 v172, v172, v246
  v_add_f32 v225, v168, v169
  v_mfma_f32_16x16x32_bf16 v[28:31], v[140:143], v[184:187], 0
  v_exp_f32 v172, v172
  v_sub_f32 v173, v173, v246
  v_cvt_pk_bf16_f32 v188, v168, v169
  v_mfma_f32_16x16x32_bf16 a[0:3], v[144:147], v[184:187], 0
  ds_write_b128 v253, a[56:59] offset:51200
  v_exp_f32 v173, v173
  v_sub_f32 v174, v174, v246
  v_add_f32 v225, v225, v170
  v_mfma_f32_16x16x32_bf16 a[4:7], v[148:151], v[184:187], 0
  v_exp_f32 v174, v174
  v_sub_f32 v175, v175, v246
  v_add_f32 v225, v225, v171
  v_mfma_f32_16x16x32_bf16 a[8:11], v[152:155], v[184:187], 0
  v_exp_f32 v175, v175
  v_cvt_pk_bf16_f32 v189, v170, v171
  v_add_f32 v225, v225, v172
  v_mfma_f32_16x16x32_bf16 a[12:15], v[156:159], v[184:187], 0
  ds_write_b128 v253, a[60:63] offset:52224
  v_cvt_pk_bf16_f32 v190, v172, v173
  v_add_f32 v225, v225, v173
  v_sub_f32 v198, 0, v244
  v_cvt_pk_bf16_f32 v191, v174, v175
  v_add_f32 v225, v225, v174
  v_add_f32 v225, v225, v175
  v_sub_f32 v199, 0, v244
  v_mfma_f32_16x16x32_bf16 v[168:171], a[224:227], a[160:163], 0
  v_max3_f32 v244, v160, v161, v162
  v_max3_f32 v245, v163, v164, v165
  v_max3_f32 v244, v244, v166, v167
  v_mfma_f32_16x16x32_bf16 v[168:171], a[228:231], a[164:167], v[168:171]
  v_max_f32 v244, v244, v245
  v_max_f32 v245, v244, v245
  v_sub_f32 v200, 0, v246
  v_mfma_f32_16x16x32_bf16 v[168:171], a[232:235], a[168:171], v[168:171]
  buffer_load_dword v250, v254, s[12:15], s63 offen offset:2048
  v_permlane32_swap_b32 v244, v245
  v_max_f32 v244, v244, v245
  v_mov_b32 v245, v244
  v_sub_f32 v201, 0, v246
  v_mfma_f32_16x16x32_bf16 v[168:171], a[236:239], a[172:175], v[168:171]
  s_waitcnt vmcnt(18)
  v_permlane16_swap_b32 v244, v245
  v_max_f32 v244, v244, v245
  v_sub_f32 v160, v160, v244
  v_mfma_f32_16x16x32_bf16 v[172:175], a[240:243], a[160:163], 0
  ds_write_b128 v253, a[64:67] offset:32768
  v_exp_f32 v160, v160
  v_sub_f32 v161, v161, v244
  v_mfma_f32_16x16x32_bf16 v[172:175], a[244:247], a[164:167], v[172:175]
  v_exp_f32 v161, v161
  v_sub_f32 v162, v162, v244
  v_add_u32 v236, s46, v13
  v_mfma_f32_16x16x32_bf16 v[172:175], a[248:251], a[168:171], v[172:175]
  ds_write_b128 v253, a[68:71] offset:33792
  v_exp_f32 v162, v162
  v_sub_f32 v163, v163, v244
  v_mfma_f32_16x16x32_bf16 v[172:175], a[252:255], a[172:175], v[172:175]
  v_exp_f32 v163, v163
  v_sub_f32 v164, v164, v244
  v_add_f32 v226, v160, v161
  v_mfma_f32_16x16x32_bf16 v[32:35], v[128:131], v[188:191], 0
  v_exp_f32 v164, v164
  v_sub_f32 v165, v165, v244
  v_cvt_pk_bf16_f32 v184, v160, v161
  v_mfma_f32_16x16x32_bf16 v[36:39], v[132:135], v[188:191], 0
  v_exp_f32 v165, v165
  v_sub_f32 v166, v166, v244
  v_add_f32 v226, v226, v162
  v_mfma_f32_16x16x32_bf16 v[40:43], v[136:139], v[188:191], 0
  ds_write_b128 v253, a[72:75] offset:34816
  v_exp_f32 v166, v166
  v_sub_f32 v167, v167, v244
  v_add_f32 v226, v226, v163
  v_mfma_f32_16x16x32_bf16 v[44:47], v[140:143], v[188:191], 0
  v_exp_f32 v167, v167
  v_cvt_pk_bf16_f32 v185, v162, v163
  v_add_f32 v226, v226, v164
  v_mfma_f32_16x16x32_bf16 a[16:19], v[144:147], v[188:191], 0
  v_cvt_pk_bf16_f32 v186, v164, v165
  v_add_f32 v226, v226, v165
  v_sub_f32 v202, 0, v246
  v_mfma_f32_16x16x32_bf16 a[20:23], v[148:151], v[188:191], 0
  ds_write_b128 v253, a[76:79] offset:35840
  v_cvt_pk_bf16_f32 v187, v166, v167
  v_add_f32 v226, v226, v166
  v_mfma_f32_16x16x32_bf16 a[24:27], v[152:155], v[188:191], 0
  s_waitcnt vmcnt(10)
  v_add_f32 v226, v226, v167
  v_sub_f32 v203, 0, v246
  v_xor_b32 v237, 32, v236
  v_xor_b32 v238, 64, v236
  v_mfma_f32_16x16x32_bf16 a[28:31], v[156:159], v[188:191], 0
  ds_write_b128 v253, v[96:99] offset:16384
  v_mfma_f32_16x16x32_bf16 v[160:163], a[224:227], a[176:179], 0
  v_max3_f32 v246, v168, v169, v170
  v_max3_f32 v247, v171, v172, v173
  v_max3_f32 v246, v246, v174, v175
  v_mfma_f32_16x16x32_bf16 v[160:163], a[228:231], a[180:183], v[160:163]
  v_max_f32 v246, v246, v247
  v_max_f32 v247, v246, v247
  v_sub_f32 v204, 0, v244
  v_mfma_f32_16x16x32_bf16 v[160:163], a[232:235], a[184:187], v[160:163]
  v_permlane32_swap_b32 v246, v247
  v_max_f32 v246, v246, v247
  v_mov_b32 v247, v246
  v_sub_f32 v205, 0, v244
  v_mfma_f32_16x16x32_bf16 v[160:163], a[236:239], a[188:191], v[160:163]
  v_permlane16_swap_b32 v246, v247
  v_max_f32 v246, v246, v247
  v_sub_f32 v168, v168, v246
  v_mfma_f32_16x16x32_bf16 v[164:167], a[240:243], a[176:179], 0
  ds_write_b128 v253, v[100:103] offset:17408
  v_exp_f32 v168, v168
  v_sub_f32 v169, v169, v246
  v_mfma_f32_16x16x32_bf16 v[164:167], a[244:247], a[180:183], v[164:167]
  v_exp_f32 v169, v169
  v_sub_f32 v170, v170, v246
  v_xor_b32 v239, 96, v236
  v_mfma_f32_16x16x32_bf16 v[164:167], a[248:251], a[184:187], v[164:167]
  ds_write_b128 v253, v[104:107] offset:18432
  v_exp_f32 v170, v170
  v_sub_f32 v171, v171, v246
  v_mfma_f32_16x16x32_bf16 v[164:167], a[252:255], a[188:191], v[164:167]
  v_exp_f32 v171, v171
  v_sub_f32 v172, v172, v246
  v_add_f32 v227, v168, v169
  v_mfma_f32_16x16x32_bf16 v[48:51], v[128:131], v[184:187], 0
  buffer_load_dword v250, v254, s[16:19], s63 offen offset:0
  v_exp_f32 v172, v172
  v_sub_f32 v173, v173, v246
  v_cvt_pk_bf16_f32 v188, v168, v169
  v_mfma_f32_16x16x32_bf16 v[52:55], v[132:135], v[184:187], 0
  v_exp_f32 v173, v173
  v_sub_f32 v174, v174, v246
  v_add_f32 v227, v227, v170
  v_mfma_f32_16x16x32_bf16 v[56:59], v[136:139], v[184:187], 0
  ds_write_b128 v253, v[108:111] offset:19456
  v_exp_f32 v174, v174
  v_sub_f32 v175, v175, v246
  v_add_f32 v227, v227, v171
  v_mfma_f32_16x16x32_bf16 v[60:63], v[140:143], v[184:187], 0
  v_exp_f32 v175, v175
  v_cvt_pk_bf16_f32 v189, v170, v171
  v_add_f32 v227, v227, v172
  v_mfma_f32_16x16x32_bf16 a[32:35], v[144:147], v[184:187], 0
  s_waitcnt vmcnt(7)
  v_cvt_pk_bf16_f32 v190, v172, v173
  v_add_f32 v227, v227, v173
  v_sub_f32 v206, 0, v244
  v_mfma_f32_16x16x32_bf16 a[36:39], v[148:151], v[184:187], 0
  ds_write_b128 v253, v[112:115] offset:0
  v_cvt_pk_bf16_f32 v191, v174, v175
  v_add_f32 v227, v227, v174
  v_mfma_f32_16x16x32_bf16 a[40:43], v[152:155], v[184:187], 0
  v_add_f32 v227, v227, v175
  v_sub_f32 v207, 0, v244
  v_add_u32 v232, s46, v12
  v_xor_b32 v233, 64, v232
  v_mfma_f32_16x16x32_bf16 a[44:47], v[156:159], v[184:187], 0
  ds_write_b128 v253, v[116:119] offset:1024
  v_mfma_f32_16x16x32_bf16 v[168:171], a[224:227], a[192:195], 0
  v_max3_f32 v244, v160, v161, v162
  v_max3_f32 v245, v163, v164, v165
  v_max3_f32 v244, v244, v166, v167
  v_mfma_f32_16x16x32_bf16 v[168:171], a[228:231], a[196:199], v[168:171]
  v_max_f32 v244, v244, v245
  v_max_f32 v245, v244, v245
  v_sub_f32 v208, 0, v246
  v_mfma_f32_16x16x32_bf16 v[168:171], a[232:235], a[200:203], v[168:171]
  s_add_u32 s38, s38, 1
  v_permlane32_swap_b32 v244, v245
  v_max_f32 v244, v244, v245
  v_mov_b32 v245, v244
  v_sub_f32 v209, 0, v246
  v_mfma_f32_16x16x32_bf16 v[168:171], a[236:239], a[204:207], v[168:171]
  v_permlane16_swap_b32 v244, v245
  v_max_f32 v244, v244, v245
  v_sub_f32 v160, v160, v244
  v_mfma_f32_16x16x32_bf16 v[172:175], a[240:243], a[192:195], 0
  s_bitcmp1_b32 s35, s38
  ds_write_b128 v253, v[120:123] offset:2048
  v_exp_f32 v160, v160
  v_sub_f32 v161, v161, v244
  v_mfma_f32_16x16x32_bf16 v[172:175], a[244:247], a[196:199], v[172:175]
  v_exp_f32 v161, v161
  v_sub_f32 v162, v162, v244
  v_xor_b32 v234, 128, v232
  v_mfma_f32_16x16x32_bf16 v[172:175], a[248:251], a[200:203], v[172:175]
  s_cselect_b32 s44, s45, 0x30000
  ds_write_b128 v253, v[124:127] offset:3072
  v_exp_f32 v162, v162
  v_sub_f32 v163, v163, v244
  v_mfma_f32_16x16x32_bf16 v[172:175], a[252:255], a[204:207], v[172:175]
  v_exp_f32 v163, v163
  v_sub_f32 v164, v164, v244
  v_add_f32 v228, v160, v161
  v_mfma_f32_16x16x32_bf16 v[64:67], v[128:131], v[188:191], 0
  s_cselect_b32 s95, s43, 0x40000000
  v_exp_f32 v164, v164
  v_sub_f32 v165, v165, v244
  v_cvt_pk_bf16_f32 v184, v160, v161
  v_mfma_f32_16x16x32_bf16 v[68:71], v[132:135], v[188:191], 0
  v_exp_f32 v165, v165
  v_sub_f32 v166, v166, v244
  v_add_f32 v228, v228, v162
  v_mfma_f32_16x16x32_bf16 v[72:75], v[136:139], v[188:191], 0
  s_cselect_b32 s42, 32768, 0
  v_exp_f32 v166, v166
  v_sub_f32 v167, v167, v244
  v_add_f32 v228, v228, v163
  v_mfma_f32_16x16x32_bf16 v[76:79], v[140:143], v[188:191], 0
  s_waitcnt lgkmcnt(0)
  v_exp_f32 v167, v167
  v_cvt_pk_bf16_f32 v185, v162, v163
  v_add_f32 v228, v228, v164
  v_mfma_f32_16x16x32_bf16 a[48:51], v[144:147], v[188:191], 0
  s_sub_u32 s45, s45, s42
  buffer_load_dword v250, v254, s[16:19], s63 offen offset:2048
  v_cvt_pk_bf16_f32 v186, v164, v165
  v_add_f32 v228, v228, v165
  v_sub_f32 v210, 0, v246
  v_mfma_f32_16x16x32_bf16 a[52:55], v[148:151], v[188:191], 0
  v_cvt_pk_bf16_f32 v187, v166, v167
  v_add_f32 v228, v228, v166
  v_mov_b32 v96, 0
  v_mov_b32 v106, 0
  v_mov_b32 v116, 0
  v_mov_b32 v126, 0
  v_mfma_f32_16x16x32_bf16 a[56:59], v[152:155], v[188:191], 0
  v_add_f32 v228, v228, v167
  v_sub_f32 v211, 0, v246
  v_mov_b32 v97, 0
  v_mov_b32 v107, 0
  v_mov_b32 v117, 0
  v_mov_b32 v127, 0
  v_xor_b32 v235, 192, v232
  v_mfma_f32_16x16x32_bf16 a[60:63], v[156:159], v[188:191], 0
  s_barrier
  v_mov_b32 v98, 0
  v_mov_b32 v99, 0
  v_mov_b32 v108, 0
  v_mov_b32 v109, 0
  v_mov_b32 v118, 0
  v_mov_b32 v119, 0
  v_mfma_f32_16x16x32_bf16 v[176:179], a[224:227], a[208:211], 0
  s_cselect_b32 s45, 131072, s45
  v_max3_f32 v246, v168, v169, v170
  v_max3_f32 v247, v171, v172, v173
  v_max3_f32 v246, v246, v174, v175
  v_mfma_f32_16x16x32_bf16 v[176:179], a[228:231], a[212:215], v[176:179]
  ds_read_b128 a[224:227], v232 offset:0
  v_max_f32 v246, v246, v247
  v_max_f32 v247, v246, v247
  v_sub_f32 v212, 0, v244
  v_mfma_f32_16x16x32_bf16 v[176:179], a[232:235], a[216:219], v[176:179]
  s_lshr_b32 s42, s42, 1
  v_permlane32_swap_b32 v246, v247
  v_max_f32 v246, v246, v247
  v_mov_b32 v247, v246
  v_sub_f32 v213, 0, v244
  v_mfma_f32_16x16x32_bf16 v[176:179], a[236:239], a[220:223], v[176:179]
  ds_read_b128 a[228:231], v233 offset:0
  v_permlane16_swap_b32 v246, v247
  v_max_f32 v246, v246, v247
  v_sub_f32 v168, v168, v246
  v_mfma_f32_16x16x32_bf16 v[180:183], a[240:243], a[208:211], 0
  s_add_u32 s43, s43, s42
  v_exp_f32 v168, v168
  v_sub_f32 v169, v169, v246
  v_mov_b32 v100, 0
  v_mov_b32 v110, 0
  v_mov_b32 v120, 0
  v_mfma_f32_16x16x32_bf16 v[180:183], a[244:247], a[212:215], v[180:183]
  ds_read_b128 a[232:235], v234 offset:0
  v_exp_f32 v169, v169
  v_sub_f32 v170, v170, v246
  v_mfma_f32_16x16x32_bf16 v[180:183], a[248:251], a[216:219], v[180:183]
  s_and_b32 s43, s43, 0x3ffff
  v_exp_f32 v170, v170
  v_sub_f32 v171, v171, v246
  v_mov_b32 v101, 0
  v_mov_b32 v111, 0
  v_mov_b32 v121, 0
  v_mfma_f32_16x16x32_bf16 v[180:183], a[252:255], a[220:223], v[180:183]
  ds_read_b128 a[236:239], v235 offset:0
  v_exp_f32 v171, v171
  v_sub_f32 v172, v172, v246
  v_add_f32 v229, v168, v169
  v_mfma_f32_16x16x32_bf16 v[80:83], v[128:131], v[184:187], 0
  s_sub_u32 s46, s46, 32768
  v_exp_f32 v172, v172
  v_sub_f32 v173, v173, v246
  v_cvt_pk_bf16_f32 v188, v168, v169
  v_mfma_f32_16x16x32_bf16 v[84:87], v[132:135], v[184:187], 0
  ds_read_b128 a[240:243], v232 offset:4096
  v_exp_f32 v173, v173
  v_sub_f32 v174, v174, v246
  v_add_f32 v229, v229, v170
  v_mfma_f32_16x16x32_bf16 v[88:91], v[136:139], v[184:187], 0
  s_cselect_b32 s46, 131072, s46
  v_exp_f32 v174, v174
  v_sub_f32 v175, v175, v246
  v_add_f32 v229, v229, v171
  v_mfma_f32_16x16x32_bf16 v[92:95], v[140:143], v[184:187], 0
  ds_read_b128 a[244:247], v233 offset:4096
  v_exp_f32 v175, v175
  v_cvt_pk_bf16_f32 v189, v170, v171
  v_add_f32 v229, v229, v172
  v_mfma_f32_16x16x32_bf16 a[64:67], v[144:147], v[184:187], 0
  s_cmp_lt_u32 s38, 14
  v_cvt_pk_bf16_f32 v190, v172, v173
  v_add_f32 v229, v229, v173
  v_sub_f32 v214, 0, v244
  v_mfma_f32_16x16x32_bf16 a[68:71], v[148:151], v[184:187], 0
  ds_read_b128 a[248:251], v234 offset:4096
  v_cvt_pk_bf16_f32 v191, v174, v175
  v_add_f32 v229, v229, v174
  v_mov_b32 v102, 0
  v_mov_b32 v112, 0
  v_mov_b32 v122, 0
  v_mfma_f32_16x16x32_bf16 a[72:75], v[152:155], v[184:187], 0
  s_waitcnt lgkmcnt(5)
  v_add_f32 v229, v229, v175
  v_sub_f32 v215, 0, v244
  v_mov_b32 v103, 0
  v_mov_b32 v105, 0
  v_mov_b32 v113, 0
  v_mov_b32 v115, 0
  v_mov_b32 v123, 0
  v_mov_b32 v125, 0
  v_mfma_f32_16x16x32_bf16 a[76:79], v[156:159], v[184:187], 0
  ds_read_b128 a[252:255], v235 offset:4096
  v_mov_b32 v104, 0
  v_mov_b32 v114, 0
  v_mov_b32 v124, 0
  v_max3_f32 v244, v176, v177, v178
  v_max3_f32 v245, v179, v180, v181
  v_max3_f32 v244, v244, v182, v183
  v_max_f32 v244, v244, v245
  v_max_f32 v245, v244, v245
  v_sub_f32 v216, 0, v246
  v_sub_f32 v218, 0, v246
  v_permlane32_swap_b32 v244, v245
  v_max_f32 v244, v244, v245
  v_mov_b32 v245, v244
  v_sub_f32 v217, 0, v246
  v_sub_f32 v219, 0, v246
  v_permlane16_swap_b32 v244, v245
  v_max_f32 v244, v244, v245
  v_sub_f32 v176, v176, v244
  v_sub_f32 v177, v177, v244
  v_sub_f32 v178, v178, v244
  v_sub_f32 v179, v179, v244
  v_sub_f32 v180, v180, v244
  v_sub_f32 v181, v181, v244
  v_sub_f32 v182, v182, v244
  v_sub_f32 v183, v183, v244
  v_sub_f32 v220, 0, v244
  v_sub_f32 v221, 0, v244
  v_sub_f32 v222, 0, v244
  v_sub_f32 v223, 0, v244
  v_mov_b32 v230, 0
  v_mov_b32 v248, s91
  v_mov_b32 v249, 0
  v_writelane_b32 v248, s101, 1
  s_mov_b64 exec, 3
  global_store_dword v248, v249, s[66:67] sc1
  s_mov_b64 exec, -1
.p2align 6
L_att:
  v_mfma_f32_16x16x32_bf16 v[160:163], a[224:227], a[112:115], v[196:199]
  s_waitcnt lgkmcnt(4)
  s_add_u32 m0, s44, s49
  v_exp_f32 v176, v176
  v_mfma_f32_16x16x32_bf16 v[160:163], a[228:231], a[116:119], v[160:163]
  buffer_load_dwordx4 v4, s[12:15], s95 offen offset:0 nt lds
  v_add_f32 v230, v230, v176
  v_mfma_f32_16x16x32_bf16 v[160:163], a[232:235], a[120:123], v[160:163]
  s_waitcnt lgkmcnt(2)
  v_exp_f32 v177, v177
  v_mfma_f32_16x16x32_bf16 v[160:163], a[236:239], a[124:127], v[160:163]
  v_cvt_pk_bf16_f32 v192, v176, v177
  v_add_f32 v230, v230, v177
  v_mfma_f32_16x16x32_bf16 v[164:167], a[240:243], a[112:115], v[196:199]
  s_waitcnt lgkmcnt(0)
  v_exp_f32 v178, v178
  v_mfma_f32_16x16x32_bf16 v[164:167], a[244:247], a[116:119], v[164:167]
  v_add_f32 v230, v230, v178
  v_xor_b32 v240, 128, v236
  v_mfma_f32_16x16x32_bf16 v[164:167], a[248:251], a[120:123], v[164:167]
  v_exp_f32 v179, v179
  v_mfma_f32_16x16x32_bf16 v[164:167], a[252:255], a[124:127], v[164:167]
  v_cvt_pk_bf16_f32 v193, v178, v179
  v_add_f32 v230, v230, v179
  v_mfma_f32_16x16x32_bf16 v[96:99], v[128:131], v[188:191], v[96:99]
  v_exp_f32 v180, v180
  v_mfma_f32_16x16x32_bf16 v[100:103], v[132:135], v[188:191], v[100:103]
  v_add_f32 v230, v230, v180
  v_xor_b32 v241, 160, v236
  v_mfma_f32_16x16x32_bf16 v[104:107], v[136:139], v[188:191], v[104:107]
  v_exp_f32 v181, v181
  v_mfma_f32_16x16x32_bf16 v[108:111], v[140:143], v[188:191], v[108:111]
  v_cvt_pk_bf16_f32 v194, v180, v181
  v_add_f32 v230, v230, v181
  v_mfma_f32_16x16x32_bf16 a[80:83], v[144:147], v[188:191], a[80:83]
  v_exp_f32 v182, v182
  v_mfma_f32_16x16x32_bf16 a[84:87], v[148:151], v[188:191], a[84:87]
  buffer_load_dwordx4 v5, s[12:15], s95 offen offset:1024 nt lds
  v_add_f32 v230, v230, v182
  v_mfma_f32_16x16x32_bf16 a[88:91], v[152:155], v[188:191], a[88:91]
  v_exp_f32 v183, v183
  v_mfma_f32_16x16x32_bf16 a[92:95], v[156:159], v[188:191], a[92:95]
  v_cvt_pk_bf16_f32 v195, v182, v183
  v_add_f32 v230, v230, v183
  v_mfma_f32_16x16x32_bf16 v[168:171], a[224:227], a[128:131], v[200:203]
  v_exp_f32 v160, v160
  v_mfma_f32_16x16x32_bf16 v[168:171], a[228:231], a[132:135], v[168:171]
  v_add_f32 v224, v224, v160
  v_xor_b32 v242, 192, v236
  v_mfma_f32_16x16x32_bf16 v[168:171], a[232:235], a[136:139], v[168:171]
  v_exp_f32 v161, v161
  v_mfma_f32_16x16x32_bf16 v[168:171], a[236:239], a[140:143], v[168:171]
  v_cvt_pk_bf16_f32 v184, v160, v161
  v_add_f32 v224, v224, v161
  v_mfma_f32_16x16x32_bf16 v[172:175], a[240:243], a[128:131], v[200:203]
  v_exp_f32 v162, v162
  v_mfma_f32_16x16x32_bf16 v[172:175], a[244:247], a[132:135], v[172:175]
  v_add_f32 v224, v224, v162
  v_xor_b32 v243, 224, v236
  v_mfma_f32_16x16x32_bf16 v[172:175], a[248:251], a[136:139], v[172:175]
  v_exp_f32 v163, v163
  v_mfma_f32_16x16x32_bf16 v[172:175], a[252:255], a[140:143], v[172:175]
  v_cvt_pk_bf16_f32 v185, v162, v163
  v_add_f32 v224, v224, v163
  v_mfma_f32_16x16x32_bf16 v[112:115], v[128:131], v[192:195], v[112:115]
  ds_read_b64_tr_b16 v[128:129], v236
  v_exp_f32 v164, v164
  v_mfma_f32_16x16x32_bf16 v[116:119], v[132:135], v[192:195], v[116:119]
  ds_read_b64_tr_b16 v[130:131], v236 offset:4096
  v_add_f32 v224, v224, v164
  v_mfma_f32_16x16x32_bf16 v[120:123], v[136:139], v[192:195], v[120:123]
  ds_read_b64_tr_b16 v[132:133], v237
  v_exp_f32 v165, v165
  v_mfma_f32_16x16x32_bf16 v[124:127], v[140:143], v[192:195], v[124:127]
  ds_read_b64_tr_b16 v[134:135], v237 offset:4096
  v_cvt_pk_bf16_f32 v186, v164, v165
  v_add_f32 v224, v224, v165
  v_mfma_f32_16x16x32_bf16 a[96:99], v[144:147], v[192:195], a[96:99]
  ds_read_b64_tr_b16 v[136:137], v238
  v_exp_f32 v166, v166
  v_mfma_f32_16x16x32_bf16 a[100:103], v[148:151], v[192:195], a[100:103]
  ds_read_b64_tr_b16 v[138:139], v238 offset:4096
  v_add_f32 v224, v224, v166
  v_mfma_f32_16x16x32_bf16 a[104:107], v[152:155], v[192:195], a[104:107]
  ds_read_b64_tr_b16 v[140:141], v239
  v_exp_f32 v167, v167
  v_mfma_f32_16x16x32_bf16 a[108:111], v[156:159], v[192:195], a[108:111]
  ds_read_b64_tr_b16 v[142:143], v239 offset:4096
  v_cvt_pk_bf16_f32 v187, v166, v167
  v_add_f32 v224, v224, v167
  v_mfma_f32_16x16x32_bf16 v[160:163], a[224:227], a[144:147], v[204:207]
  ds_read_b64_tr_b16 v[144:145], v240
  v_exp_f32 v168, v168
  v_mfma_f32_16x16x32_bf16 v[160:163], a[228:231], a[148:151], v[160:163]
  ds_read_b64_tr_b16 v[146:147], v240 offset:4096
  v_add_f32 v225, v225, v168
  v_mfma_f32_16x16x32_bf16 v[160:163], a[232:235], a[152:155], v[160:163]
  ds_read_b64_tr_b16 v[148:149], v241
  v_exp_f32 v169, v169
  v_mfma_f32_16x16x32_bf16 v[160:163], a[236:239], a[156:159], v[160:163]
  ds_read_b64_tr_b16 v[150:151], v241 offset:4096
  v_cvt_pk_bf16_f32 v188, v168, v169
  v_add_f32 v225, v225, v169
  v_mfma_f32_16x16x32_bf16 v[164:167], a[240:243], a[144:147], v[204:207]
  ds_read_b64_tr_b16 v[152:153], v242
  v_exp_f32 v170, v170
  v_mfma_f32_16x16x32_bf16 v[164:167], a[244:247], a[148:151], v[164:167]
  ds_read_b64_tr_b16 v[154:155], v242 offset:4096
  v_add_f32 v225, v225, v170
  v_mfma_f32_16x16x32_bf16 v[164:167], a[248:251], a[152:155], v[164:167]
  s_waitcnt lgkmcnt(10)
  ds_read_b64_tr_b16 v[156:157], v243
  v_exp_f32 v171, v171
  v_mfma_f32_16x16x32_bf16 v[164:167], a[252:255], a[156:159], v[164:167]
  ds_read_b64_tr_b16 v[158:159], v243 offset:4096
  v_cvt_pk_bf16_f32 v189, v170, v171
  v_add_f32 v225, v225, v171
  v_mfma_f32_16x16x32_bf16 v[16:19], v[128:131], v[184:187], v[16:19]
  s_waitcnt lgkmcnt(8)
  v_exp_f32 v172, v172
  v_mfma_f32_16x16x32_bf16 v[20:23], v[132:135], v[184:187], v[20:23]
  buffer_load_dwordx4 v6, s[12:15], s95 offen offset:2048 nt lds
  v_add_f32 v225, v225, v172
  v_mfma_f32_16x16x32_bf16 v[24:27], v[136:139], v[184:187], v[24:27]
  s_waitcnt lgkmcnt(4)
  v_exp_f32 v173, v173
  v_mfma_f32_16x16x32_bf16 v[28:31], v[140:143], v[184:187], v[28:31]
  v_cvt_pk_bf16_f32 v190, v172, v173
  v_add_f32 v225, v225, v173
  v_mfma_f32_16x16x32_bf16 a[0:3], v[144:147], v[184:187], a[0:3]
  s_waitcnt lgkmcnt(0)
  v_exp_f32 v174, v174
  v_mfma_f32_16x16x32_bf16 a[4:7], v[148:151], v[184:187], a[4:7]
  v_add_f32 v225, v225, v174
  v_add_u32 v236, s46, v13
  v_mfma_f32_16x16x32_bf16 a[8:11], v[152:155], v[184:187], a[8:11]
  v_exp_f32 v175, v175
  v_mfma_f32_16x16x32_bf16 a[12:15], v[156:159], v[184:187], a[12:15]
  v_cvt_pk_bf16_f32 v191, v174, v175
  v_add_f32 v225, v225, v175
  v_mfma_f32_16x16x32_bf16 v[168:171], a[224:227], a[160:163], v[208:211]
  v_exp_f32 v160, v160
  v_mfma_f32_16x16x32_bf16 v[168:171], a[228:231], a[164:167], v[168:171]
  buffer_load_dwordx4 v7, s[12:15], s95 offen offset:3072 nt lds
  v_add_f32 v226, v226, v160
  v_mfma_f32_16x16x32_bf16 v[168:171], a[232:235], a[168:171], v[168:171]
  v_exp_f32 v161, v161
  v_mfma_f32_16x16x32_bf16 v[168:171], a[236:239], a[172:175], v[168:171]
  v_cvt_pk_bf16_f32 v184, v160, v161
  v_add_f32 v226, v226, v161
  v_mfma_f32_16x16x32_bf16 v[172:175], a[240:243], a[160:163], v[208:211]
  v_exp_f32 v162, v162
  v_mfma_f32_16x16x32_bf16 v[172:175], a[244:247], a[164:167], v[172:175]
  v_add_f32 v226, v226, v162
  v_xor_b32 v237, 32, v236
  v_mfma_f32_16x16x32_bf16 v[172:175], a[248:251], a[168:171], v[172:175]
  v_exp_f32 v163, v163
  v_mfma_f32_16x16x32_bf16 v[172:175], a[252:255], a[172:175], v[172:175]
  v_cvt_pk_bf16_f32 v185, v162, v163
  v_add_f32 v226, v226, v163
  v_mfma_f32_16x16x32_bf16 v[32:35], v[128:131], v[188:191], v[32:35]
  s_add_u32 m0, s44, s48
  v_exp_f32 v164, v164
  v_mfma_f32_16x16x32_bf16 v[36:39], v[132:135], v[188:191], v[36:39]
  buffer_load_dwordx4 v4, s[16:19], s95 offen offset:0 nt lds
  v_add_f32 v226, v226, v164
  v_mfma_f32_16x16x32_bf16 v[40:43], v[136:139], v[188:191], v[40:43]
  v_exp_f32 v165, v165
  v_mfma_f32_16x16x32_bf16 v[44:47], v[140:143], v[188:191], v[44:47]
  v_cvt_pk_bf16_f32 v186, v164, v165
  v_add_f32 v226, v226, v165
  v_mfma_f32_16x16x32_bf16 a[16:19], v[144:147], v[188:191], a[16:19]
  v_exp_f32 v166, v166
  v_mfma_f32_16x16x32_bf16 a[20:23], v[148:151], v[188:191], a[20:23]
  v_add_f32 v226, v226, v166
  v_xor_b32 v238, 64, v236
  v_mfma_f32_16x16x32_bf16 a[24:27], v[152:155], v[188:191], a[24:27]
  v_exp_f32 v167, v167
  v_mfma_f32_16x16x32_bf16 a[28:31], v[156:159], v[188:191], a[28:31]
  v_cvt_pk_bf16_f32 v187, v166, v167
  v_add_f32 v226, v226, v167
  v_mfma_f32_16x16x32_bf16 v[160:163], a[224:227], a[176:179], v[212:215]
  v_exp_f32 v168, v168
  v_mfma_f32_16x16x32_bf16 v[160:163], a[228:231], a[180:183], v[160:163]
  buffer_load_dwordx4 v5, s[16:19], s95 offen offset:1024 nt lds
  v_add_f32 v227, v227, v168
  v_mfma_f32_16x16x32_bf16 v[160:163], a[232:235], a[184:187], v[160:163]
  v_exp_f32 v169, v169
  v_mfma_f32_16x16x32_bf16 v[160:163], a[236:239], a[188:191], v[160:163]
  v_cvt_pk_bf16_f32 v188, v168, v169
  v_add_f32 v227, v227, v169
  v_mfma_f32_16x16x32_bf16 v[164:167], a[240:243], a[176:179], v[212:215]
  v_exp_f32 v170, v170
  v_mfma_f32_16x16x32_bf16 v[164:167], a[244:247], a[180:183], v[164:167]
  v_add_f32 v227, v227, v170
  v_xor_b32 v239, 96, v236
  v_mfma_f32_16x16x32_bf16 v[164:167], a[248:251], a[184:187], v[164:167]
  v_exp_f32 v171, v171
  v_mfma_f32_16x16x32_bf16 v[164:167], a[252:255], a[188:191], v[164:167]
  v_cvt_pk_bf16_f32 v189, v170, v171
  v_add_f32 v227, v227, v171
  v_mfma_f32_16x16x32_bf16 v[48:51], v[128:131], v[184:187], v[48:51]
  v_exp_f32 v172, v172
  v_mfma_f32_16x16x32_bf16 v[52:55], v[132:135], v[184:187], v[52:55]
  buffer_load_dwordx4 v6, s[16:19], s95 offen offset:2048 nt lds
  v_add_f32 v227, v227, v172
  v_mfma_f32_16x16x32_bf16 v[56:59], v[136:139], v[184:187], v[56:59]
  v_exp_f32 v173, v173
  v_mfma_f32_16x16x32_bf16 v[60:63], v[140:143], v[184:187], v[60:63]
  v_cvt_pk_bf16_f32 v190, v172, v173
  v_add_f32 v227, v227, v173
  v_mfma_f32_16x16x32_bf16 a[32:35], v[144:147], v[184:187], a[32:35]
  v_exp_f32 v174, v174
  v_mfma_f32_16x16x32_bf16 a[36:39], v[148:151], v[184:187], a[36:39]
  v_add_f32 v227, v227, v174
  v_add_u32 v232, s46, v12
  v_mfma_f32_16x16x32_bf16 a[40:43], v[152:155], v[184:187], a[40:43]
  v_exp_f32 v175, v175
  v_mfma_f32_16x16x32_bf16 a[44:47], v[156:159], v[184:187], a[44:47]
  v_cvt_pk_bf16_f32 v191, v174, v175
  v_add_f32 v227, v227, v175
  v_mfma_f32_16x16x32_bf16 v[168:171], a[224:227], a[192:195], v[216:219]
  v_exp_f32 v160, v160
  v_mfma_f32_16x16x32_bf16 v[168:171], a[228:231], a[196:199], v[168:171]
  buffer_load_dwordx4 v7, s[16:19], s95 offen offset:3072 nt lds
  v_add_f32 v228, v228, v160
  v_mfma_f32_16x16x32_bf16 v[168:171], a[232:235], a[200:203], v[168:171]
  s_add_u32 s38, s38, 1
  v_exp_f32 v161, v161
  v_mfma_f32_16x16x32_bf16 v[168:171], a[236:239], a[204:207], v[168:171]
  v_cvt_pk_bf16_f32 v184, v160, v161
  v_add_f32 v228, v228, v161
  v_mfma_f32_16x16x32_bf16 v[172:175], a[240:243], a[192:195], v[216:219]
  s_bitcmp1_b32 s35, s38
  v_exp_f32 v162, v162
  v_mfma_f32_16x16x32_bf16 v[172:175], a[244:247], a[196:199], v[172:175]
  v_add_f32 v228, v228, v162
  v_xor_b32 v233, 64, v232
  v_mfma_f32_16x16x32_bf16 v[172:175], a[248:251], a[200:203], v[172:175]
  s_cselect_b32 s44, s45, 0x30000
  v_exp_f32 v163, v163
  v_mfma_f32_16x16x32_bf16 v[172:175], a[252:255], a[204:207], v[172:175]
  v_cvt_pk_bf16_f32 v185, v162, v163
  v_add_f32 v228, v228, v163
  v_mfma_f32_16x16x32_bf16 v[64:67], v[128:131], v[188:191], v[64:67]
  s_cselect_b32 s95, s43, 0x40000000
  v_exp_f32 v164, v164
  v_mfma_f32_16x16x32_bf16 v[68:71], v[132:135], v[188:191], v[68:71]
  v_add_f32 v228, v228, v164
  v_xor_b32 v234, 128, v232
  v_mfma_f32_16x16x32_bf16 v[72:75], v[136:139], v[188:191], v[72:75]
  s_cselect_b32 s42, 32768, 0
  v_exp_f32 v165, v165
  v_mfma_f32_16x16x32_bf16 v[76:79], v[140:143], v[188:191], v[76:79]
  v_cvt_pk_bf16_f32 v186, v164, v165
  v_add_f32 v228, v228, v165
  v_mfma_f32_16x16x32_bf16 a[48:51], v[144:147], v[188:191], a[48:51]
  s_sub_u32 s45, s45, s42
  v_exp_f32 v166, v166
  v_mfma_f32_16x16x32_bf16 a[52:55], v[148:151], v[188:191], a[52:55]
  v_add_f32 v228, v228, v166
  v_xor_b32 v235, 192, v232
  v_mfma_f32_16x16x32_bf16 a[56:59], v[152:155], v[188:191], a[56:59]
  s_waitcnt vmcnt(24)
  v_exp_f32 v167, v167
  v_mfma_f32_16x16x32_bf16 a[60:63], v[156:159], v[188:191], a[60:63]
  s_barrier
  v_cvt_pk_bf16_f32 v187, v166, v167
  v_add_f32 v228, v228, v167
  v_mfma_f32_16x16x32_bf16 v[176:179], a[224:227], a[208:211], v[220:223]
  s_cselect_b32 s45, 131072, s45
  v_exp_f32 v168, v168
  v_mfma_f32_16x16x32_bf16 v[176:179], a[228:231], a[212:215], v[176:179]
  ds_read_b128 a[224:227], v232 offset:0
  v_add_f32 v229, v229, v168
  v_mfma_f32_16x16x32_bf16 v[176:179], a[232:235], a[216:219], v[176:179]
  s_lshr_b32 s42, s42, 1
  v_exp_f32 v169, v169
  v_mfma_f32_16x16x32_bf16 v[176:179], a[236:239], a[220:223], v[176:179]
  ds_read_b128 a[228:231], v233 offset:0
  v_cvt_pk_bf16_f32 v188, v168, v169
  v_add_f32 v229, v229, v169
  v_mfma_f32_16x16x32_bf16 v[180:183], a[240:243], a[208:211], v[220:223]
  s_add_u32 s43, s43, s42
  v_exp_f32 v170, v170
  v_mfma_f32_16x16x32_bf16 v[180:183], a[244:247], a[212:215], v[180:183]
  ds_read_b128 a[232:235], v234 offset:0
  v_add_f32 v229, v229, v170
  v_mfma_f32_16x16x32_bf16 v[180:183], a[248:251], a[216:219], v[180:183]
  s_and_b32 s43, s43, 0x3ffff
  v_exp_f32 v171, v171
  v_mfma_f32_16x16x32_bf16 v[180:183], a[252:255], a[220:223], v[180:183]
  ds_read_b128 a[236:239], v235 offset:0
  v_cvt_pk_bf16_f32 v189, v170, v171
  v_add_f32 v229, v229, v171
  v_mfma_f32_16x16x32_bf16 v[80:83], v[128:131], v[184:187], v[80:83]
  s_sub_u32 s46, s46, 32768
  v_exp_f32 v172, v172
  v_mfma_f32_16x16x32_bf16 v[84:87], v[132:135], v[184:187], v[84:87]
  ds_read_b128 a[240:243], v232 offset:4096
  v_add_f32 v229, v229, v172
  v_mfma_f32_16x16x32_bf16 v[88:91], v[136:139], v[184:187], v[88:91]
  s_cselect_b32 s46, 131072, s46
  v_exp_f32 v173, v173
  v_mfma_f32_16x16x32_bf16 v[92:95], v[140:143], v[184:187], v[92:95]
  ds_read_b128 a[244:247], v233 offset:4096
  v_cvt_pk_bf16_f32 v190, v172, v173
  v_add_f32 v229, v229, v173
  v_mfma_f32_16x16x32_bf16 a[64:67], v[144:147], v[184:187], a[64:67]
  s_cmp_lt_u32 s38, 7
  v_exp_f32 v174, v174
  v_mfma_f32_16x16x32_bf16 a[68:71], v[148:151], v[184:187], a[68:71]
  ds_read_b128 a[248:251], v234 offset:4096
  v_add_f32 v229, v229, v174
  v_mfma_f32_16x16x32_bf16 a[72:75], v[152:155], v[184:187], a[72:75]
  s_waitcnt lgkmcnt(5)
  v_exp_f32 v175, v175
  v_mfma_f32_16x16x32_bf16 a[76:79], v[156:159], v[184:187], a[76:79]
  ds_read_b128 a[252:255], v235 offset:4096
  v_cvt_pk_bf16_f32 v191, v174, v175
  v_add_f32 v229, v229, v175
  s_cbranch_scc1 L_att
  s_or_b32 s39, s28, s47
  s_cbranch_scc1 L_nosig0
  v_mov_b32 v249, 0
  v_mov_b32 v251, 1
  s_mov_b64 exec, 1
  global_atomic_add v249, v251, s[64:65] sc1
  s_mov_b64 exec, -1
L_nosig0:
.p2align 6
L_att2:
  v_mfma_f32_16x16x32_bf16 v[160:163], a[224:227], a[112:115], v[196:199]
  s_waitcnt lgkmcnt(4)
  s_add_u32 m0, s44, s49
  v_exp_f32 v176, v176
  v_mfma_f32_16x16x32_bf16 v[160:163], a[228:231], a[116:119], v[160:163]
  buffer_load_dwordx4 v4, s[12:15], s95 offen offset:0 nt lds
  v_add_f32 v230, v230, v176
  v_mfma_f32_16x16x32_bf16 v[160:163], a[232:235], a[120:123], v[160:163]
  s_waitcnt lgkmcnt(2)
  v_exp_f32 v177, v177
  v_mfma_f32_16x16x32_bf16 v[160:163], a[236:239], a[124:127], v[160:163]
  v_cvt_pk_bf16_f32 v192, v176, v177
  v_add_f32 v230, v230, v177
  v_mfma_f32_16x16x32_bf16 v[164:167], a[240:243], a[112:115], v[196:199]
  s_waitcnt lgkmcnt(0)
  v_exp_f32 v178, v178
  v_mfma_f32_16x16x32_bf16 v[164:167], a[244:247], a[116:119], v[164:167]
  v_add_f32 v230, v230, v178
  v_xor_b32 v240, 128, v236
  v_mfma_f32_16x16x32_bf16 v[164:167], a[248:251], a[120:123], v[164:167]
  v_exp_f32 v179, v179
  v_mfma_f32_16x16x32_bf16 v[164:167], a[252:255], a[124:127], v[164:167]
  v_cvt_pk_bf16_f32 v193, v178, v179
  v_add_f32 v230, v230, v179
  v_mfma_f32_16x16x32_bf16 v[96:99], v[128:131], v[188:191], v[96:99]
  v_exp_f32 v180, v180
  v_mfma_f32_16x16x32_bf16 v[100:103], v[132:135], v[188:191], v[100:103]
  v_add_f32 v230, v230, v180
  v_xor_b32 v241, 160, v236
  v_mfma_f32_16x16x32_bf16 v[104:107], v[136:139], v[188:191], v[104:107]
  v_exp_f32 v181, v181
  v_mfma_f32_16x16x32_bf16 v[108:111], v[140:143], v[188:191], v[108:111]
  v_cvt_pk_bf16_f32 v194, v180, v181
  v_add_f32 v230, v230, v181
  v_mfma_f32_16x16x32_bf16 a[80:83], v[144:147], v[188:191], a[80:83]
  v_exp_f32 v182, v182
  v_mfma_f32_16x16x32_bf16 a[84:87], v[148:151], v[188:191], a[84:87]
  buffer_load_dwordx4 v5, s[12:15], s95 offen offset:1024 nt lds
  v_add_f32 v230, v230, v182
  v_mfma_f32_16x16x32_bf16 a[88:91], v[152:155], v[188:191], a[88:91]
  v_exp_f32 v183, v183
  v_mfma_f32_16x16x32_bf16 a[92:95], v[156:159], v[188:191], a[92:95]
  v_cvt_pk_bf16_f32 v195, v182, v183
  v_add_f32 v230, v230, v183
  v_mfma_f32_16x16x32_bf16 v[168:171], a[224:227], a[128:131], v[200:203]
  v_exp_f32 v160, v160
  v_mfma_f32_16x16x32_bf16 v[168:171], a[228:231], a[132:135], v[168:171]
  v_add_f32 v224, v224, v160
  v_xor_b32 v242, 192, v236
  v_mfma_f32_16x16x32_bf16 v[168:171], a[232:235], a[136:139], v[168:171]
  v_exp_f32 v161, v161
  v_mfma_f32_16x16x32_bf16 v[168:171], a[236:239], a[140:143], v[168:171]
  v_cvt_pk_bf16_f32 v184, v160, v161
  v_add_f32 v224, v224, v161
  v_mfma_f32_16x16x32_bf16 v[172:175], a[240:243], a[128:131], v[200:203]
  v_exp_f32 v162, v162
  v_mfma_f32_16x16x32_bf16 v[172:175], a[244:247], a[132:135], v[172:175]
  v_add_f32 v224, v224, v162
  v_xor_b32 v243, 224, v236
  v_mfma_f32_16x16x32_bf16 v[172:175], a[248:251], a[136:139], v[172:175]
  v_exp_f32 v163, v163
  v_mfma_f32_16x16x32_bf16 v[172:175], a[252:255], a[140:143], v[172:175]
  v_cvt_pk_bf16_f32 v185, v162, v163
  v_add_f32 v224, v224, v163
  v_mfma_f32_16x16x32_bf16 v[112:115], v[128:131], v[192:195], v[112:115]
  ds_read_b64_tr_b16 v[128:129], v236
  v_exp_f32 v164, v164
  v_mfma_f32_16x16x32_bf16 v[116:119], v[132:135], v[192:195], v[116:119]
  ds_read_b64_tr_b16 v[130:131], v236 offset:4096
  v_add_f32 v224, v224, v164
  v_mfma_f32_16x16x32_bf16 v[120:123], v[136:139], v[192:195], v[120:123]
  ds_read_b64_tr_b16 v[132:133], v237
  v_exp_f32 v165, v165
  v_mfma_f32_16x16x32_bf16 v[124:127], v[140:143], v[192:195], v[124:127]
  ds_read_b64_tr_b16 v[134:135], v237 offset:4096
  v_cvt_pk_bf16_f32 v186, v164, v165
  v_add_f32 v224, v224, v165
  v_mfma_f32_16x16x32_bf16 a[96:99], v[144:147], v[192:195], a[96:99]
  ds_read_b64_tr_b16 v[136:137], v238
  v_exp_f32 v166, v166
  v_mfma_f32_16x16x32_bf16 a[100:103], v[148:151], v[192:195], a[100:103]
  ds_read_b64_tr_b16 v[138:139], v238 offset:4096
  v_add_f32 v224, v224, v166
  v_mfma_f32_16x16x32_bf16 a[104:107], v[152:155], v[192:195], a[104:107]
  ds_read_b64_tr_b16 v[140:141], v239
  v_exp_f32 v167, v167
  v_mfma_f32_16x16x32_bf16 a[108:111], v[156:159], v[192:195], a[108:111]
  ds_read_b64_tr_b16 v[142:143], v239 offset:4096
  v_cvt_pk_bf16_f32 v187, v166, v167
  v_add_f32 v224, v224, v167
  v_mfma_f32_16x16x32_bf16 v[160:163], a[224:227], a[144:147], v[204:207]
  ds_read_b64_tr_b16 v[144:145], v240
  v_exp_f32 v168, v168
  v_mfma_f32_16x16x32_bf16 v[160:163], a[228:231], a[148:151], v[160:163]
  ds_read_b64_tr_b16 v[146:147], v240 offset:4096
  v_add_f32 v225, v225, v168
  v_mfma_f32_16x16x32_bf16 v[160:163], a[232:235], a[152:155], v[160:163]
  ds_read_b64_tr_b16 v[148:149], v241
  v_exp_f32 v169, v169
  v_mfma_f32_16x16x32_bf16 v[160:163], a[236:239], a[156:159], v[160:163]
  ds_read_b64_tr_b16 v[150:151], v241 offset:4096
  v_cvt_pk_bf16_f32 v188, v168, v169
  v_add_f32 v225, v225, v169
  v_mfma_f32_16x16x32_bf16 v[164:167], a[240:243], a[144:147], v[204:207]
  ds_read_b64_tr_b16 v[152:153], v242
  v_exp_f32 v170, v170
  v_mfma_f32_16x16x32_bf16 v[164:167], a[244:247], a[148:151], v[164:167]
  ds_read_b64_tr_b16 v[154:155], v242 offset:4096
  v_add_f32 v225, v225, v170
  v_mfma_f32_16x16x32_bf16 v[164:167], a[248:251], a[152:155], v[164:167]
  s_waitcnt lgkmcnt(10)
  ds_read_b64_tr_b16 v[156:157], v243
  v_exp_f32 v171, v171
  v_mfma_f32_16x16x32_bf16 v[164:167], a[252:255], a[156:159], v[164:167]
  ds_read_b64_tr_b16 v[158:159], v243 offset:4096
  v_cvt_pk_bf16_f32 v189, v170, v171
  v_add_f32 v225, v225, v171
  v_mfma_f32_16x16x32_bf16 v[16:19], v[128:131], v[184:187], v[16:19]
  s_waitcnt lgkmcnt(8)
  v_exp_f32 v172, v172
  v_mfma_f32_16x16x32_bf16 v[20:23], v[132:135], v[184:187], v[20:23]
  buffer_load_dwordx4 v6, s[12:15], s95 offen offset:2048 nt lds
  v_add_f32 v225, v225, v172
  v_mfma_f32_16x16x32_bf16 v[24:27], v[136:139], v[184:187], v[24:27]
  s_waitcnt lgkmcnt(4)
  v_exp_f32 v173, v173
  v_mfma_f32_16x16x32_bf16 v[28:31], v[140:143], v[184:187], v[28:31]
  v_cvt_pk_bf16_f32 v190, v172, v173
  v_add_f32 v225, v225, v173
  v_mfma_f32_16x16x32_bf16 a[0:3], v[144:147], v[184:187], a[0:3]
  s_waitcnt lgkmcnt(0)
  v_exp_f32 v174, v174
  v_mfma_f32_16x16x32_bf16 a[4:7], v[148:151], v[184:187], a[4:7]
  v_add_f32 v225, v225, v174
  v_add_u32 v236, s46, v13
  v_mfma_f32_16x16x32_bf16 a[8:11], v[152:155], v[184:187], a[8:11]
  v_exp_f32 v175, v175
  v_mfma_f32_16x16x32_bf16 a[12:15], v[156:159], v[184:187], a[12:15]
  v_cvt_pk_bf16_f32 v191, v174, v175
  v_add_f32 v225, v225, v175
  v_mfma_f32_16x16x32_bf16 v[168:171], a[224:227], a[160:163], v[208:211]
  v_exp_f32 v160, v160
  v_mfma_f32_16x16x32_bf16 v[168:171], a[228:231], a[164:167], v[168:171]
  buffer_load_dwordx4 v7, s[12:15], s95 offen offset:3072 nt lds
  v_add_f32 v226, v226, v160
  v_mfma_f32_16x16x32_bf16 v[168:171], a[232:235], a[168:171], v[168:171]
  v_exp_f32 v161, v161
  v_mfma_f32_16x16x32_bf16 v[168:171], a[236:239], a[172:175], v[168:171]
  v_cvt_pk_bf16_f32 v184, v160, v161
  v_add_f32 v226, v226, v161
  v_mfma_f32_16x16x32_bf16 v[172:175], a[240:243], a[160:163], v[208:211]
  v_exp_f32 v162, v162
  v_mfma_f32_16x16x32_bf16 v[172:175], a[244:247], a[164:167], v[172:175]
  v_add_f32 v226, v226, v162
  v_xor_b32 v237, 32, v236
  v_mfma_f32_16x16x32_bf16 v[172:175], a[248:251], a[168:171], v[172:175]
  v_exp_f32 v163, v163
  v_mfma_f32_16x16x32_bf16 v[172:175], a[252:255], a[172:175], v[172:175]
  v_cvt_pk_bf16_f32 v185, v162, v163
  v_add_f32 v226, v226, v163
  v_mfma_f32_16x16x32_bf16 v[32:35], v[128:131], v[188:191], v[32:35]
  s_add_u32 m0, s44, s48
  v_exp_f32 v164, v164
  v_mfma_f32_16x16x32_bf16 v[36:39], v[132:135], v[188:191], v[36:39]
  buffer_load_dwordx4 v4, s[16:19], s95 offen offset:0 nt lds
  v_add_f32 v226, v226, v164
  v_mfma_f32_16x16x32_bf16 v[40:43], v[136:139], v[188:191], v[40:43]
  v_exp_f32 v165, v165
  v_mfma_f32_16x16x32_bf16 v[44:47], v[140:143], v[188:191], v[44:47]
  v_cvt_pk_bf16_f32 v186, v164, v165
  v_add_f32 v226, v226, v165
  v_mfma_f32_16x16x32_bf16 a[16:19], v[144:147], v[188:191], a[16:19]
  v_exp_f32 v166, v166
  v_mfma_f32_16x16x32_bf16 a[20:23], v[148:151], v[188:191], a[20:23]
  v_add_f32 v226, v226, v166
  v_xor_b32 v238, 64, v236
  v_mfma_f32_16x16x32_bf16 a[24:27], v[152:155], v[188:191], a[24:27]
  v_exp_f32 v167, v167
  v_mfma_f32_16x16x32_bf16 a[28:31], v[156:159], v[188:191], a[28:31]
  v_cvt_pk_bf16_f32 v187, v166, v167
  v_add_f32 v226, v226, v167
  v_mfma_f32_16x16x32_bf16 v[160:163], a[224:227], a[176:179], v[212:215]
  v_exp_f32 v168, v168
  v_mfma_f32_16x16x32_bf16 v[160:163], a[228:231], a[180:183], v[160:163]
  buffer_load_dwordx4 v5, s[16:19], s95 offen offset:1024 nt lds
  v_add_f32 v227, v227, v168
  v_mfma_f32_16x16x32_bf16 v[160:163], a[232:235], a[184:187], v[160:163]
  v_exp_f32 v169, v169
  v_mfma_f32_16x16x32_bf16 v[160:163], a[236:239], a[188:191], v[160:163]
  v_cvt_pk_bf16_f32 v188, v168, v169
  v_add_f32 v227, v227, v169
  v_mfma_f32_16x16x32_bf16 v[164:167], a[240:243], a[176:179], v[212:215]
  v_exp_f32 v170, v170
  v_mfma_f32_16x16x32_bf16 v[164:167], a[244:247], a[180:183], v[164:167]
  v_add_f32 v227, v227, v170
  v_xor_b32 v239, 96, v236
  v_mfma_f32_16x16x32_bf16 v[164:167], a[248:251], a[184:187], v[164:167]
  v_exp_f32 v171, v171
  v_mfma_f32_16x16x32_bf16 v[164:167], a[252:255], a[188:191], v[164:167]
  v_cvt_pk_bf16_f32 v189, v170, v171
  v_add_f32 v227, v227, v171
  v_mfma_f32_16x16x32_bf16 v[48:51], v[128:131], v[184:187], v[48:51]
  v_exp_f32 v172, v172
  v_mfma_f32_16x16x32_bf16 v[52:55], v[132:135], v[184:187], v[52:55]
  buffer_load_dwordx4 v6, s[16:19], s95 offen offset:2048 nt lds
  v_add_f32 v227, v227, v172
  v_mfma_f32_16x16x32_bf16 v[56:59], v[136:139], v[184:187], v[56:59]
  v_exp_f32 v173, v173
  v_mfma_f32_16x16x32_bf16 v[60:63], v[140:143], v[184:187], v[60:63]
  v_cvt_pk_bf16_f32 v190, v172, v173
  v_add_f32 v227, v227, v173
  v_mfma_f32_16x16x32_bf16 a[32:35], v[144:147], v[184:187], a[32:35]
  v_exp_f32 v174, v174
  v_mfma_f32_16x16x32_bf16 a[36:39], v[148:151], v[184:187], a[36:39]
  v_add_f32 v227, v227, v174
  v_add_u32 v232, s46, v12
  v_mfma_f32_16x16x32_bf16 a[40:43], v[152:155], v[184:187], a[40:43]
  v_exp_f32 v175, v175
  v_mfma_f32_16x16x32_bf16 a[44:47], v[156:159], v[184:187], a[44:47]
  v_cvt_pk_bf16_f32 v191, v174, v175
  v_add_f32 v227, v227, v175
  v_mfma_f32_16x16x32_bf16 v[168:171], a[224:227], a[192:195], v[216:219]
  v_exp_f32 v160, v160
  v_mfma_f32_16x16x32_bf16 v[168:171], a[228:231], a[196:199], v[168:171]
  buffer_load_dwordx4 v7, s[16:19], s95 offen offset:3072 nt lds
  v_add_f32 v228, v228, v160
  v_mfma_f32_16x16x32_bf16 v[168:171], a[232:235], a[200:203], v[168:171]
  s_add_u32 s38, s38, 1
  v_exp_f32 v161, v161
  v_mfma_f32_16x16x32_bf16 v[168:171], a[236:239], a[204:207], v[168:171]
  v_cvt_pk_bf16_f32 v184, v160, v161
  v_add_f32 v228, v228, v161
  v_mfma_f32_16x16x32_bf16 v[172:175], a[240:243], a[192:195], v[216:219]
  s_bitcmp1_b32 s35, s38
  v_exp_f32 v162, v162
  v_mfma_f32_16x16x32_bf16 v[172:175], a[244:247], a[196:199], v[172:175]
  v_add_f32 v228, v228, v162
  v_xor_b32 v233, 64, v232
  v_mfma_f32_16x16x32_bf16 v[172:175], a[248:251], a[200:203], v[172:175]
  s_cselect_b32 s44, s45, 0x30000
  v_exp_f32 v163, v163
  v_mfma_f32_16x16x32_bf16 v[172:175], a[252:255], a[204:207], v[172:175]
  v_cvt_pk_bf16_f32 v185, v162, v163
  v_add_f32 v228, v228, v163
  v_mfma_f32_16x16x32_bf16 v[64:67], v[128:131], v[188:191], v[64:67]
  s_cselect_b32 s95, s43, 0x40000000
  v_exp_f32 v164, v164
  v_mfma_f32_16x16x32_bf16 v[68:71], v[132:135], v[188:191], v[68:71]
  v_add_f32 v228, v228, v164
  v_xor_b32 v234, 128, v232
  v_mfma_f32_16x16x32_bf16 v[72:75], v[136:139], v[188:191], v[72:75]
  s_cselect_b32 s42, 32768, 0
  v_exp_f32 v165, v165
  v_mfma_f32_16x16x32_bf16 v[76:79], v[140:143], v[188:191], v[76:79]
  v_cvt_pk_bf16_f32 v186, v164, v165
  v_add_f32 v228, v228, v165
  v_mfma_f32_16x16x32_bf16 a[48:51], v[144:147], v[188:191], a[48:51]
  s_sub_u32 s45, s45, s42
  v_exp_f32 v166, v166
  v_mfma_f32_16x16x32_bf16 a[52:55], v[148:151], v[188:191], a[52:55]
  v_add_f32 v228, v228, v166
  v_xor_b32 v235, 192, v232
  v_mfma_f32_16x16x32_bf16 a[56:59], v[152:155], v[188:191], a[56:59]
  s_waitcnt vmcnt(8)
  v_exp_f32 v167, v167
  v_mfma_f32_16x16x32_bf16 a[60:63], v[156:159], v[188:191], a[60:63]
  s_barrier
  v_cvt_pk_bf16_f32 v187, v166, v167
  v_add_f32 v228, v228, v167
  v_mfma_f32_16x16x32_bf16 v[176:179], a[224:227], a[208:211], v[220:223]
  s_cselect_b32 s45, 131072, s45
  v_exp_f32 v168, v168
  v_mfma_f32_16x16x32_bf16 v[176:179], a[228:231], a[212:215], v[176:179]
  ds_read_b128 a[224:227], v232 offset:0
  v_add_f32 v229, v229, v168
  v_mfma_f32_16x16x32_bf16 v[176:179], a[232:235], a[216:219], v[176:179]
  s_lshr_b32 s42, s42, 1
  v_exp_f32 v169, v169
  v_mfma_f32_16x16x32_bf16 v[176:179], a[236:239], a[220:223], v[176:179]
  ds_read_b128 a[228:231], v233 offset:0
  v_cvt_pk_bf16_f32 v188, v168, v169
  v_add_f32 v229, v229, v169
  v_mfma_f32_16x16x32_bf16 v[180:183], a[240:243], a[208:211], v[220:223]
  s_add_u32 s43, s43, s42
  v_exp_f32 v170, v170
  v_mfma_f32_16x16x32_bf16 v[180:183], a[244:247], a[212:215], v[180:183]
  ds_read_b128 a[232:235], v234 offset:0
  v_add_f32 v229, v229, v170
  v_mfma_f32_16x16x32_bf16 v[180:183], a[248:251], a[216:219], v[180:183]
  s_and_b32 s43, s43, 0x3ffff
  v_exp_f32 v171, v171
  v_mfma_f32_16x16x32_bf16 v[180:183], a[252:255], a[220:223], v[180:183]
  ds_read_b128 a[236:239], v235 offset:0
  v_cvt_pk_bf16_f32 v189, v170, v171
  v_add_f32 v229, v229, v171
  v_mfma_f32_16x16x32_bf16 v[80:83], v[128:131], v[184:187], v[80:83]
  s_sub_u32 s46, s46, 32768
  v_exp_f32 v172, v172
  v_mfma_f32_16x16x32_bf16 v[84:87], v[132:135], v[184:187], v[84:87]
  ds_read_b128 a[240:243], v232 offset:4096
  v_add_f32 v229, v229, v172
  v_mfma_f32_16x16x32_bf16 v[88:91], v[136:139], v[184:187], v[88:91]
  s_cselect_b32 s46, 131072, s46
  v_exp_f32 v173, v173
  v_mfma_f32_16x16x32_bf16 v[92:95], v[140:143], v[184:187], v[92:95]
  ds_read_b128 a[244:247], v233 offset:4096
  v_cvt_pk_bf16_f32 v190, v172, v173
  v_add_f32 v229, v229, v173
  v_mfma_f32_16x16x32_bf16 a[64:67], v[144:147], v[184:187], a[64:67]
  s_cmp_lt_u32 s38, 14
  v_exp_f32 v174, v174
  v_mfma_f32_16x16x32_bf16 a[68:71], v[148:151], v[184:187], a[68:71]
  ds_read_b128 a[248:251], v234 offset:4096
  v_add_f32 v229, v229, v174
  v_mfma_f32_16x16x32_bf16 a[72:75], v[152:155], v[184:187], a[72:75]
  s_waitcnt lgkmcnt(5)
  v_exp_f32 v175, v175
  v_mfma_f32_16x16x32_bf16 a[76:79], v[156:159], v[184:187], a[76:79]
  ds_read_b128 a[252:255], v235 offset:4096
  v_cvt_pk_bf16_f32 v191, v174, v175
  v_add_f32 v229, v229, v175
  s_cbranch_scc1 L_att2
  v_mfma_f32_16x16x32_bf16 v[160:163], a[224:227], a[112:115], v[196:199]
  s_waitcnt lgkmcnt(4)
  s_add_u32 m0, s88, 0
  v_exp_f32 v176, v176
  v_mfma_f32_16x16x32_bf16 v[160:163], a[228:231], a[116:119], v[160:163]
  buffer_load_dwordx4 v8, s[68:71], s80 offen offset:0 lds
  v_add_f32 v230, v230, v176
  v_and_b32 v252, 7, v0
  v_mfma_f32_16x16x32_bf16 v[160:163], a[232:235], a[120:123], v[160:163]
  s_waitcnt lgkmcnt(2)
  v_exp_f32 v177, v177
  v_mfma_f32_16x16x32_bf16 v[160:163], a[236:239], a[124:127], v[160:163]
  v_cvt_pk_bf16_f32 v192, v176, v177
  v_add_f32 v230, v230, v177
  v_and_b32 v251, 8, v0
  v_mfma_f32_16x16x32_bf16 v[164:167], a[240:243], a[112:115], v[196:199]
  s_waitcnt lgkmcnt(0)
  v_exp_f32 v178, v178
  v_mfma_f32_16x16x32_bf16 v[164:167], a[244:247], a[116:119], v[164:167]
  v_add_f32 v230, v230, v178
  v_xor_b32 v240, 128, v236
  v_lshl_add_u32 v252, v251, 1, v252
  v_mfma_f32_16x16x32_bf16 v[164:167], a[248:251], a[120:123], v[164:167]
  s_lshl_b32 s6, s28, 12
  v_exp_f32 v179, v179
  v_mfma_f32_16x16x32_bf16 v[164:167], a[252:255], a[124:127], v[164:167]
  v_cvt_pk_bf16_f32 v193, v178, v179
  v_add_f32 v230, v230, v179
  v_lshlrev_b32 v252, 7, v252
  v_mfma_f32_16x16x32_bf16 v[96:99], v[128:131], v[188:191], v[96:99]
  s_add_u32 s6, s6, L_last+2048-L_pc
  v_exp_f32 v180, v180
  v_mfma_f32_16x16x32_bf16 v[100:103], v[132:135], v[188:191], v[100:103]
  v_add_f32 v230, v230, v180
  v_xor_b32 v241, 160, v236
  v_mfma_f32_16x16x32_bf16 v[104:107], v[136:139], v[188:191], v[104:107]
  v_exp_f32 v181, v181
  v_lshl_add_u32 v249, v0, 6, s6
  v_mfma_f32_16x16x32_bf16 v[108:111], v[140:143], v[188:191], v[108:111]
  global_load_dword v2, v249, s[4:5]
  v_cvt_pk_bf16_f32 v194, v180, v181
  v_add_f32 v230, v230, v181
  v_mfma_f32_16x16x32_bf16 a[80:83], v[144:147], v[188:191], a[80:83]
  s_add_u32 s39, s93, 0
  v_exp_f32 v182, v182
  v_mfma_f32_16x16x32_bf16 a[84:87], v[148:151], v[188:191], a[84:87]
  buffer_load_dword v2, v252, s[68:71], s39 offen
  v_add_f32 v230, v230, v182
  v_mfma_f32_16x16x32_bf16 a[88:91], v[152:155], v[188:191], a[88:91]
  v_exp_f32 v183, v183
  v_mfma_f32_16x16x32_bf16 a[92:95], v[156:159], v[188:191], a[92:95]
  v_cvt_pk_bf16_f32 v195, v182, v183
  v_add_f32 v230, v230, v183
  v_mfma_f32_16x16x32_bf16 v[168:171], a[224:227], a[128:131], v[200:203]
  v_exp_f32 v160, v160
  v_mfma_f32_16x16x32_bf16 v[168:171], a[228:231], a[132:135], v[168:171]
  v_add_f32 v224, v224, v160
  v_xor_b32 v242, 192, v236
  v_mfma_f32_16x16x32_bf16 v[168:171], a[232:235], a[136:139], v[168:171]
  v_exp_f32 v161, v161
  v_mfma_f32_16x16x32_bf16 v[168:171], a[236:239], a[140:143], v[168:171]
  buffer_load_dwordx4 v9, s[68:71], s80 offen offset:1024 lds
  v_cvt_pk_bf16_f32 v184, v160, v161
  v_add_f32 v224, v224, v161
  v_mfma_f32_16x16x32_bf16 v[172:175], a[240:243], a[128:131], v[200:203]
  v_exp_f32 v162, v162
  v_mfma_f32_16x16x32_bf16 v[172:175], a[244:247], a[132:135], v[172:175]
  v_add_f32 v224, v224, v162
  v_xor_b32 v243, 224, v236
  v_mfma_f32_16x16x32_bf16 v[172:175], a[248:251], a[136:139], v[172:175]
  v_exp_f32 v163, v163
  v_mfma_f32_16x16x32_bf16 v[172:175], a[252:255], a[140:143], v[172:175]
  v_cvt_pk_bf16_f32 v185, v162, v163
  v_add_f32 v224, v224, v163
  v_mfma_f32_16x16x32_bf16 v[112:115], v[128:131], v[192:195], v[112:115]
  ds_read_b64_tr_b16 v[128:129], v236
  v_exp_f32 v164, v164
  v_mfma_f32_16x16x32_bf16 v[116:119], v[132:135], v[192:195], v[116:119]
  ds_read_b64_tr_b16 v[130:131], v236 offset:4096
  v_add_f32 v224, v224, v164
  v_mfma_f32_16x16x32_bf16 v[120:123], v[136:139], v[192:195], v[120:123]
  ds_read_b64_tr_b16 v[132:133], v237
  v_exp_f32 v165, v165
  v_mfma_f32_16x16x32_bf16 v[124:127], v[140:143], v[192:195], v[124:127]
  ds_read_b64_tr_b16 v[134:135], v237 offset:4096
  v_cvt_pk_bf16_f32 v186, v164, v165
  v_add_f32 v224, v224, v165
  v_mfma_f32_16x16x32_bf16 a[96:99], v[144:147], v[192:195], a[96:99]
  ds_read_b64_tr_b16 v[136:137], v238
  v_exp_f32 v166, v166
  v_mfma_f32_16x16x32_bf16 a[100:103], v[148:151], v[192:195], a[100:103]
  ds_read_b64_tr_b16 v[138:139], v238 offset:4096
  v_add_f32 v224, v224, v166
  v_mfma_f32_16x16x32_bf16 a[104:107], v[152:155], v[192:195], a[104:107]
  ds_read_b64_tr_b16 v[140:141], v239
  v_exp_f32 v167, v167
  v_mfma_f32_16x16x32_bf16 a[108:111], v[156:159], v[192:195], a[108:111]
  ds_read_b64_tr_b16 v[142:143], v239 offset:4096
  v_cvt_pk_bf16_f32 v187, v166, v167
  v_add_f32 v224, v224, v167
  v_mfma_f32_16x16x32_bf16 v[160:163], a[224:227], a[144:147], v[204:207]
  ds_read_b64_tr_b16 v[144:145], v240
  v_exp_f32 v168, v168
  v_mfma_f32_16x16x32_bf16 v[160:163], a[228:231], a[148:151], v[160:163]
  ds_read_b64_tr_b16 v[146:147], v240 offset:4096
  v_add_f32 v225, v225, v168
  v_mfma_f32_16x16x32_bf16 v[160:163], a[232:235], a[152:155], v[160:163]
  ds_read_b64_tr_b16 v[148:149], v241
  v_exp_f32 v169, v169
  v_mfma_f32_16x16x32_bf16 v[160:163], a[236:239], a[156:159], v[160:163]
  ds_read_b64_tr_b16 v[150:151], v241 offset:4096
  v_cvt_pk_bf16_f32 v188, v168, v169
  v_add_f32 v225, v225, v169
  v_mfma_f32_16x16x32_bf16 v[164:167], a[240:243], a[144:147], v[204:207]
  ds_read_b64_tr_b16 v[152:153], v242
  v_exp_f32 v170, v170
  v_mfma_f32_16x16x32_bf16 v[164:167], a[244:247], a[148:151], v[164:167]
  ds_read_b64_tr_b16 v[154:155], v242 offset:4096
  v_add_f32 v225, v225, v170
  v_mfma_f32_16x16x32_bf16 v[164:167], a[248:251], a[152:155], v[164:167]
  s_waitcnt lgkmcnt(10)
  ds_read_b64_tr_b16 v[156:157], v243
  v_exp_f32 v171, v171
  v_mfma_f32_16x16x32_bf16 v[164:167], a[252:255], a[156:159], v[164:167]
  ds_read_b64_tr_b16 v[158:159], v243 offset:4096
  v_cvt_pk_bf16_f32 v189, v170, v171
  v_add_f32 v225, v225, v171
  v_mfma_f32_16x16x32_bf16 v[16:19], v[128:131], v[184:187], v[16:19]
  s_waitcnt lgkmcnt(8)
  s_add_u32 s39, s93, 4096
  v_exp_f32 v172, v172
  v_mfma_f32_16x16x32_bf16 v[20:23], v[132:135], v[184:187], v[20:23]
  buffer_load_dword v2, v252, s[68:71], s39 offen
  buffer_load_dwordx4 v10, s[68:71], s80 offen offset:2048 lds
  v_add_f32 v225, v225, v172
  v_mfma_f32_16x16x32_bf16 v[24:27], v[136:139], v[184:187], v[24:27]
  s_waitcnt lgkmcnt(4)
  v_exp_f32 v173, v173
  v_mfma_f32_16x16x32_bf16 v[28:31], v[140:143], v[184:187], v[28:31]
  v_cvt_pk_bf16_f32 v190, v172, v173
  v_add_f32 v225, v225, v173
  v_mfma_f32_16x16x32_bf16 a[0:3], v[144:147], v[184:187], a[0:3]
  s_waitcnt lgkmcnt(0)
  v_exp_f32 v174, v174
  v_mfma_f32_16x16x32_bf16 a[4:7], v[148:151], v[184:187], a[4:7]
  v_add_f32 v225, v225, v174
  v_add_u32 v236, s46, v13
  v_mfma_f32_16x16x32_bf16 a[8:11], v[152:155], v[184:187], a[8:11]
  v_exp_f32 v175, v175
  v_mfma_f32_16x16x32_bf16 a[12:15], v[156:159], v[184:187], a[12:15]
  v_cvt_pk_bf16_f32 v191, v174, v175
  v_add_f32 v225, v225, v175
  v_mfma_f32_16x16x32_bf16 v[168:171], a[224:227], a[160:163], v[208:211]
  v_exp_f32 v160, v160
  v_mfma_f32_16x16x32_bf16 v[168:171], a[228:231], a[164:167], v[168:171]
  buffer_load_dwordx4 v11, s[68:71], s80 offen offset:3072 lds
  v_add_f32 v226, v226, v160
  v_mfma_f32_16x16x32_bf16 v[168:171], a[232:235], a[168:171], v[168:171]
  v_exp_f32 v161, v161
  v_mfma_f32_16x16x32_bf16 v[168:171], a[236:239], a[172:175], v[168:171]
  v_cvt_pk_bf16_f32 v184, v160, v161
  v_add_f32 v226, v226, v161
  v_mfma_f32_16x16x32_bf16 v[172:175], a[240:243], a[160:163], v[208:211]
  v_exp_f32 v162, v162
  v_mfma_f32_16x16x32_bf16 v[172:175], a[244:247], a[164:167], v[172:175]
  v_add_f32 v226, v226, v162
  v_xor_b32 v237, 32, v236
  v_mfma_f32_16x16x32_bf16 v[172:175], a[248:251], a[168:171], v[172:175]
  v_exp_f32 v163, v163
  v_mfma_f32_16x16x32_bf16 v[172:175], a[252:255], a[172:175], v[172:175]
  v_cvt_pk_bf16_f32 v185, v162, v163
  v_add_f32 v226, v226, v163
  v_mfma_f32_16x16x32_bf16 v[32:35], v[128:131], v[188:191], v[32:35]
  s_add_u32 m0, s88, 4096
  v_exp_f32 v164, v164
  v_mfma_f32_16x16x32_bf16 v[36:39], v[132:135], v[188:191], v[36:39]
  buffer_load_dwordx4 v8, s[68:71], s81 offen offset:0 lds
  v_add_f32 v226, v226, v164
  v_mfma_f32_16x16x32_bf16 v[40:43], v[136:139], v[188:191], v[40:43]
  v_exp_f32 v165, v165
  v_mfma_f32_16x16x32_bf16 v[44:47], v[140:143], v[188:191], v[44:47]
  v_cvt_pk_bf16_f32 v186, v164, v165
  v_add_f32 v226, v226, v165
  v_mfma_f32_16x16x32_bf16 a[16:19], v[144:147], v[188:191], a[16:19]
  v_exp_f32 v166, v166
  v_mfma_f32_16x16x32_bf16 a[20:23], v[148:151], v[188:191], a[20:23]
  v_add_f32 v226, v226, v166
  v_xor_b32 v238, 64, v236
  v_mfma_f32_16x16x32_bf16 a[24:27], v[152:155], v[188:191], a[24:27]
  s_add_u32 s39, s93, 8192
  v_exp_f32 v167, v167
  v_mfma_f32_16x16x32_bf16 a[28:31], v[156:159], v[188:191], a[28:31]
  buffer_load_dword v2, v252, s[68:71], s39 offen
  v_cvt_pk_bf16_f32 v187, v166, v167
  v_add_f32 v226, v226, v167
  v_mfma_f32_16x16x32_bf16 v[160:163], a[224:227], a[176:179], v[212:215]
  v_exp_f32 v168, v168
  v_mfma_f32_16x16x32_bf16 v[160:163], a[228:231], a[180:183], v[160:163]
  buffer_load_dwordx4 v9, s[68:71], s81 offen offset:1024 lds
  v_add_f32 v227, v227, v168
  v_mfma_f32_16x16x32_bf16 v[160:163], a[232:235], a[184:187], v[160:163]
  v_exp_f32 v169, v169
  v_mfma_f32_16x16x32_bf16 v[160:163], a[236:239], a[188:191], v[160:163]
  v_cvt_pk_bf16_f32 v188, v168, v169
  v_add_f32 v227, v227, v169
  v_mfma_f32_16x16x32_bf16 v[164:167], a[240:243], a[176:179], v[212:215]
  v_exp_f32 v170, v170
  v_mfma_f32_16x16x32_bf16 v[164:167], a[244:247], a[180:183], v[164:167]
  v_add_f32 v227, v227, v170
  v_xor_b32 v239, 96, v236
  v_mfma_f32_16x16x32_bf16 v[164:167], a[248:251], a[184:187], v[164:167]
  v_exp_f32 v171, v171
  v_mfma_f32_16x16x32_bf16 v[164:167], a[252:255], a[188:191], v[164:167]
  v_cvt_pk_bf16_f32 v189, v170, v171
  v_add_f32 v227, v227, v171
  v_mfma_f32_16x16x32_bf16 v[48:51], v[128:131], v[184:187], v[48:51]
  v_exp_f32 v172, v172
  v_mfma_f32_16x16x32_bf16 v[52:55], v[132:135], v[184:187], v[52:55]
  buffer_load_dwordx4 v10, s[68:71], s81 offen offset:2048 lds
  v_add_f32 v227, v227, v172
  v_mfma_f32_16x16x32_bf16 v[56:59], v[136:139], v[184:187], v[56:59]
  v_exp_f32 v173, v173
  v_mfma_f32_16x16x32_bf16 v[60:63], v[140:143], v[184:187], v[60:63]
  v_cvt_pk_bf16_f32 v190, v172, v173
  v_add_f32 v227, v227, v173
  v_mfma_f32_16x16x32_bf16 a[32:35], v[144:147], v[184:187], a[32:35]
  v_exp_f32 v174, v174
  v_mfma_f32_16x16x32_bf16 a[36:39], v[148:151], v[184:187], a[36:39]
  v_add_f32 v227, v227, v174
  v_add_u32 v232, s46, v12
  v_mfma_f32_16x16x32_bf16 a[40:43], v[152:155], v[184:187], a[40:43]
  v_exp_f32 v175, v175
  v_mfma_f32_16x16x32_bf16 a[44:47], v[156:159], v[184:187], a[44:47]
  v_cvt_pk_bf16_f32 v191, v174, v175
  v_add_f32 v227, v227, v175
  v_mfma_f32_16x16x32_bf16 v[168:171], a[224:227], a[192:195], v[216:219]
  v_exp_f32 v160, v160
  v_mfma_f32_16x16x32_bf16 v[168:171], a[228:231], a[196:199], v[168:171]
  v_add_f32 v228, v228, v160
  v_mfma_f32_16x16x32_bf16 v[168:171], a[232:235], a[200:203], v[168:171]
  v_exp_f32 v161, v161
  v_mfma_f32_16x16x32_bf16 v[168:171], a[236:239], a[204:207], v[168:171]
  v_cvt_pk_bf16_f32 v184, v160, v161
  v_add_f32 v228, v228, v161
  v_mfma_f32_16x16x32_bf16 v[172:175], a[240:243], a[192:195], v[216:219]
  v_exp_f32 v162, v162
  v_mfma_f32_16x16x32_bf16 v[172:175], a[244:247], a[196:199], v[172:175]
  v_add_f32 v228, v228, v162
  v_xor_b32 v233, 64, v232
  v_mfma_f32_16x16x32_bf16 v[172:175], a[248:251], a[200:203], v[172:175]
  s_add_u32 s39, s93, 12288
  v_exp_f32 v163, v163
  v_mfma_f32_16x16x32_bf16 v[172:175], a[252:255], a[204:207], v[172:175]
  buffer_load_dword v2, v252, s[68:71], s39 offen
  v_cvt_pk_bf16_f32 v185, v162, v163
  v_add_f32 v228, v228, v163
  v_mfma_f32_16x16x32_bf16 v[64:67], v[128:131], v[188:191], v[64:67]
  v_exp_f32 v164, v164
  v_mfma_f32_16x16x32_bf16 v[68:71], v[132:135], v[188:191], v[68:71]
  v_add_f32 v228, v228, v164
  v_xor_b32 v234, 128, v232
  v_mfma_f32_16x16x32_bf16 v[72:75], v[136:139], v[188:191], v[72:75]
  v_exp_f32 v165, v165
  v_mfma_f32_16x16x32_bf16 v[76:79], v[140:143], v[188:191], v[76:79]
  buffer_load_dwordx4 v11, s[68:71], s81 offen offset:3072 lds
  v_cvt_pk_bf16_f32 v186, v164, v165
  v_add_f32 v228, v228, v165
  v_mfma_f32_16x16x32_bf16 a[48:51], v[144:147], v[188:191], a[48:51]
  v_exp_f32 v166, v166
  v_mfma_f32_16x16x32_bf16 a[52:55], v[148:151], v[188:191], a[52:55]
  v_add_f32 v228, v228, v166
  v_xor_b32 v235, 192, v232
  v_mfma_f32_16x16x32_bf16 a[56:59], v[152:155], v[188:191], a[56:59]
  s_waitcnt vmcnt(13)
  v_exp_f32 v167, v167
  v_mfma_f32_16x16x32_bf16 a[60:63], v[156:159], v[188:191], a[60:63]
  s_barrier
  v_cvt_pk_bf16_f32 v187, v166, v167
  v_add_f32 v228, v228, v167
  v_mfma_f32_16x16x32_bf16 v[176:179], a[224:227], a[208:211], v[220:223]
  v_exp_f32 v168, v168
  v_mfma_f32_16x16x32_bf16 v[176:179], a[228:231], a[212:215], v[176:179]
  ds_read_b128 a[224:227], v232 offset:0
  v_add_f32 v229, v229, v168
  v_mfma_f32_16x16x32_bf16 v[176:179], a[232:235], a[216:219], v[176:179]
  v_exp_f32 v169, v169
  v_mfma_f32_16x16x32_bf16 v[176:179], a[236:239], a[220:223], v[176:179]
  ds_read_b128 a[228:231], v233 offset:0
  v_cvt_pk_bf16_f32 v188, v168, v169
  v_add_f32 v229, v229, v169
  v_mfma_f32_16x16x32_bf16 v[180:183], a[240:243], a[208:211], v[220:223]
  v_exp_f32 v170, v170
  v_mfma_f32_16x16x32_bf16 v[180:183], a[244:247], a[212:215], v[180:183]
  ds_read_b128 a[232:235], v234 offset:0
  v_add_f32 v229, v229, v170
  v_mfma_f32_16x16x32_bf16 v[180:183], a[248:251], a[216:219], v[180:183]
  v_exp_f32 v171, v171
  v_mfma_f32_16x16x32_bf16 v[180:183], a[252:255], a[220:223], v[180:183]
  ds_read_b128 a[236:239], v235 offset:0
  v_cvt_pk_bf16_f32 v189, v170, v171
  v_add_f32 v229, v229, v171
  v_mfma_f32_16x16x32_bf16 v[80:83], v[128:131], v[184:187], v[80:83]
  s_sub_u32 s46, s46, 32768
  v_exp_f32 v172, v172
  v_mfma_f32_16x16x32_bf16 v[84:87], v[132:135], v[184:187], v[84:87]
  ds_read_b128 a[240:243], v232 offset:4096
  v_add_f32 v229, v229, v172
  v_mfma_f32_16x16x32_bf16 v[88:91], v[136:139], v[184:187], v[88:91]
  s_cselect_b32 s46, 131072, s46
  v_exp_f32 v173, v173
  v_mfma_f32_16x16x32_bf16 v[92:95], v[140:143], v[184:187], v[92:95]
  ds_read_b128 a[244:247], v233 offset:4096
  v_cvt_pk_bf16_f32 v190, v172, v173
  v_add_f32 v229, v229, v173
  v_mfma_f32_16x16x32_bf16 a[64:67], v[144:147], v[184:187], a[64:67]
  s_cmp_lt_u32 s38, 14
  v_exp_f32 v174, v174
  v_mfma_f32_16x16x32_bf16 a[68:71], v[148:151], v[184:187], a[68:71]
  ds_read_b128 a[248:251], v234 offset:4096
  v_add_f32 v229, v229, v174
  v_mfma_f32_16x16x32_bf16 a[72:75], v[152:155], v[184:187], a[72:75]
  s_waitcnt lgkmcnt(5)
  v_exp_f32 v175, v175
  v_mfma_f32_16x16x32_bf16 a[76:79], v[156:159], v[184:187], a[76:79]
  ds_read_b128 a[252:255], v235 offset:4096
  v_cvt_pk_bf16_f32 v191, v174, v175
  v_add_f32 v229, v229, v175
L_last:
  v_mfma_f32_16x16x32_bf16 v[160:163], a[224:227], a[112:115], v[196:199]
  s_waitcnt lgkmcnt(4)
  v_exp_f32 v176, v176
  v_mfma_f32_16x16x32_bf16 v[160:163], a[228:231], a[116:119], v[160:163]
  v_add_f32 v230, v230, v176
  v_add_u32 v232, s88, v231
  v_mfma_f32_16x16x32_bf16 v[160:163], a[232:235], a[120:123], v[160:163]
  s_waitcnt lgkmcnt(2)
  v_exp_f32 v177, v177
  v_mfma_f32_16x16x32_bf16 v[160:163], a[236:239], a[124:127], v[160:163]
  v_cvt_pk_bf16_f32 v192, v176, v177
  v_add_f32 v230, v230, v177
  v_xor_b32 v233, 32, v232
  v_mfma_f32_16x16x32_bf16 v[164:167], a[240:243], a[112:115], v[196:199]
  s_waitcnt lgkmcnt(0)
  v_exp_f32 v178, v178
  v_mfma_f32_16x16x32_bf16 v[164:167], a[244:247], a[116:119], v[164:167]
  v_add_f32 v230, v230, v178
  v_xor_b32 v240, 128, v236
  v_mfma_f32_16x16x32_bf16 v[164:167], a[248:251], a[120:123], v[164:167]
  v_exp_f32 v179, v179
  v_mfma_f32_16x16x32_bf16 v[164:167], a[252:255], a[124:127], v[164:167]
  v_cvt_pk_bf16_f32 v193, v178, v179
  v_add_f32 v230, v230, v179
  v_xor_b32 v234, 64, v232
  v_mfma_f32_16x16x32_bf16 v[96:99], v[128:131], v[188:191], v[96:99]
  v_exp_f32 v180, v180
  v_mfma_f32_16x16x32_bf16 v[100:103], v[132:135], v[188:191], v[100:103]
  v_add_f32 v230, v230, v180
  v_xor_b32 v241, 160, v236
  v_mov_b32 v253, 0
  v_mfma_f32_16x16x32_bf16 v[104:107], v[136:139], v[188:191], v[104:107]
  v_exp_f32 v181, v181
  v_mfma_f32_16x16x32_bf16 v[108:111], v[140:143], v[188:191], v[108:111]
  v_cvt_pk_bf16_f32 v194, v180, v181
  v_add_f32 v230, v230, v181
  v_mfma_f32_16x16x32_bf16 a[80:83], v[144:147], v[188:191], a[80:83]
  s_add_u32 s39, s93, 524288
  v_exp_f32 v182, v182
  v_mfma_f32_16x16x32_bf16 a[84:87], v[148:151], v[188:191], a[84:87]
  buffer_load_dword v2, v252, s[68:71], s39 offen
  v_add_f32 v230, v230, v182
  v_xor_b32 v235, 96, v232
  v_mfma_f32_16x16x32_bf16 a[88:91], v[152:155], v[188:191], a[88:91]
  v_exp_f32 v183, v183
  v_mfma_f32_16x16x32_bf16 a[92:95], v[156:159], v[188:191], a[92:95]
  v_cvt_pk_bf16_f32 v195, v182, v183
  v_add_f32 v230, v230, v183
  v_mfma_f32_16x16x32_bf16 v[168:171], a[224:227], a[128:131], v[200:203]
  v_exp_f32 v160, v160
  v_mfma_f32_16x16x32_bf16 v[168:171], a[228:231], a[132:135], v[168:171]
  global_load_dword v254, v253, s[64:65] sc1
  v_add_f32 v224, v224, v160
  v_xor_b32 v242, 192, v236
  v_mfma_f32_16x16x32_bf16 v[168:171], a[232:235], a[136:139], v[168:171]
  v_exp_f32 v161, v161
  v_mfma_f32_16x16x32_bf16 v[168:171], a[236:239], a[140:143], v[168:171]
  v_cvt_pk_bf16_f32 v184, v160, v161
  v_add_f32 v224, v224, v161
  v_mfma_f32_16x16x32_bf16 v[172:175], a[240:243], a[128:131], v[200:203]
  v_exp_f32 v162, v162
  v_mfma_f32_16x16x32_bf16 v[172:175], a[244:247], a[132:135], v[172:175]
  v_add_f32 v224, v224, v162
  v_xor_b32 v243, 224, v236
  v_mfma_f32_16x16x32_bf16 v[172:175], a[248:251], a[136:139], v[172:175]
  v_exp_f32 v163, v163
  v_mfma_f32_16x16x32_bf16 v[172:175], a[252:255], a[140:143], v[172:175]
  v_cvt_pk_bf16_f32 v185, v162, v163
  v_add_f32 v224, v224, v163
  v_mfma_f32_16x16x32_bf16 v[112:115], v[128:131], v[192:195], v[112:115]
  ds_read_b64_tr_b16 v[128:129], v236
  v_exp_f32 v164, v164
  v_mfma_f32_16x16x32_bf16 v[116:119], v[132:135], v[192:195], v[116:119]
  ds_read_b64_tr_b16 v[130:131], v236 offset:4096
  v_add_f32 v224, v224, v164
  v_mfma_f32_16x16x32_bf16 v[120:123], v[136:139], v[192:195], v[120:123]
  ds_read_b64_tr_b16 v[132:133], v237
  v_exp_f32 v165, v165
  v_mfma_f32_16x16x32_bf16 v[124:127], v[140:143], v[192:195], v[124:127]
  ds_read_b64_tr_b16 v[134:135], v237 offset:4096
  v_cvt_pk_bf16_f32 v186, v164, v165
  v_add_f32 v224, v224, v165
  v_mfma_f32_16x16x32_bf16 a[96:99], v[144:147], v[192:195], a[96:99]
  ds_read_b64_tr_b16 v[136:137], v238
  v_exp_f32 v166, v166
  v_mfma_f32_16x16x32_bf16 a[100:103], v[148:151], v[192:195], a[100:103]
  ds_read_b64_tr_b16 v[138:139], v238 offset:4096
  v_add_f32 v224, v224, v166
  v_mfma_f32_16x16x32_bf16 a[104:107], v[152:155], v[192:195], a[104:107]
  ds_read_b64_tr_b16 v[140:141], v239
  v_exp_f32 v167, v167
  v_mfma_f32_16x16x32_bf16 a[108:111], v[156:159], v[192:195], a[108:111]
  ds_read_b64_tr_b16 v[142:143], v239 offset:4096
  v_cvt_pk_bf16_f32 v187, v166, v167
  v_add_f32 v224, v224, v167
  v_mfma_f32_16x16x32_bf16 v[160:163], a[224:227], a[144:147], v[204:207]
  ds_read_b64_tr_b16 v[144:145], v240
  v_exp_f32 v168, v168
  v_mfma_f32_16x16x32_bf16 v[160:163], a[228:231], a[148:151], v[160:163]
  ds_read_b64_tr_b16 v[146:147], v240 offset:4096
  v_add_f32 v225, v225, v168
  v_mfma_f32_16x16x32_bf16 v[160:163], a[232:235], a[152:155], v[160:163]
  ds_read_b64_tr_b16 v[148:149], v241
  v_exp_f32 v169, v169
  v_mfma_f32_16x16x32_bf16 v[160:163], a[236:239], a[156:159], v[160:163]
  ds_read_b64_tr_b16 v[150:151], v241 offset:4096
  v_cvt_pk_bf16_f32 v188, v168, v169
  v_add_f32 v225, v225, v169
  v_mfma_f32_16x16x32_bf16 v[164:167], a[240:243], a[144:147], v[204:207]
  ds_read_b64_tr_b16 v[152:153], v242
  v_exp_f32 v170, v170
  v_mfma_f32_16x16x32_bf16 v[164:167], a[244:247], a[148:151], v[164:167]
  ds_read_b64_tr_b16 v[154:155], v242 offset:4096
  v_add_f32 v225, v225, v170
  v_mfma_f32_16x16x32_bf16 v[164:167], a[248:251], a[152:155], v[164:167]
  s_waitcnt lgkmcnt(10)
  ds_read_b64_tr_b16 v[156:157], v243
  v_exp_f32 v171, v171
  v_mfma_f32_16x16x32_bf16 v[164:167], a[252:255], a[156:159], v[164:167]
  ds_read_b64_tr_b16 v[158:159], v243 offset:4096
  v_cvt_pk_bf16_f32 v189, v170, v171
  v_add_f32 v225, v225, v171
  v_mfma_f32_16x16x32_bf16 v[16:19], v[128:131], v[184:187], v[16:19]
  s_waitcnt lgkmcnt(8)
  s_add_u32 s39, s93, 528384
  v_exp_f32 v172, v172
  v_mfma_f32_16x16x32_bf16 v[20:23], v[132:135], v[184:187], v[20:23]
  buffer_load_dword v2, v252, s[68:71], s39 offen
  v_add_f32 v225, v225, v172
  v_add_u32 v236, s89, v231
  v_mfma_f32_16x16x32_bf16 v[24:27], v[136:139], v[184:187], v[24:27]
  s_waitcnt lgkmcnt(4)
  v_exp_f32 v173, v173
  v_mfma_f32_16x16x32_bf16 v[28:31], v[140:143], v[184:187], v[28:31]
  v_cvt_pk_bf16_f32 v190, v172, v173
  v_add_f32 v225, v225, v173
  v_mfma_f32_16x16x32_bf16 a[0:3], v[144:147], v[184:187], a[0:3]
  s_waitcnt lgkmcnt(0)
  v_exp_f32 v174, v174
  v_mfma_f32_16x16x32_bf16 a[4:7], v[148:151], v[184:187], a[4:7]
  v_add_f32 v225, v225, v174
  v_add_u32 v240, 4096, v1
  v_mfma_f32_16x16x32_bf16 a[8:11], v[152:155], v[184:187], a[8:11]
  s_barrier
  v_exp_f32 v175, v175
  v_mfma_f32_16x16x32_bf16 a[12:15], v[156:159], v[184:187], a[12:15]
  v_cvt_pk_bf16_f32 v191, v174, v175
  v_add_f32 v225, v225, v175
  v_mfma_f32_16x16x32_bf16 v[168:171], a[224:227], a[160:163], v[208:211]
  v_exp_f32 v160, v160
  v_mfma_f32_16x16x32_bf16 v[168:171], a[228:231], a[164:167], v[168:171]
  ds_write_b128 v14, a[0:3] offset:0
  v_add_f32 v226, v226, v160
  v_mfma_f32_16x16x32_bf16 v[168:171], a[232:235], a[168:171], v[168:171]
  v_exp_f32 v161, v161
  v_mfma_f32_16x16x32_bf16 v[168:171], a[236:239], a[172:175], v[168:171]
  v_cvt_pk_bf16_f32 v184, v160, v161
  v_add_f32 v226, v226, v161
  v_xor_b32 v237, 32, v236
  v_mfma_f32_16x16x32_bf16 v[172:175], a[240:243], a[160:163], v[208:211]
  v_exp_f32 v162, v162
  v_mfma_f32_16x16x32_bf16 v[172:175], a[244:247], a[164:167], v[172:175]
  ds_write_b128 v14, a[4:7] offset:1024
  v_add_f32 v226, v226, v162
  v_mfma_f32_16x16x32_bf16 v[172:175], a[248:251], a[168:171], v[172:175]
  v_exp_f32 v163, v163
  v_mfma_f32_16x16x32_bf16 v[172:175], a[252:255], a[172:175], v[172:175]
  v_cvt_pk_bf16_f32 v185, v162, v163
  v_add_f32 v226, v226, v163
  v_xor_b32 v238, 64, v236
  v_mfma_f32_16x16x32_bf16 v[32:35], v[128:131], v[188:191], v[32:35]
  v_exp_f32 v164, v164
  v_mfma_f32_16x16x32_bf16 v[36:39], v[132:135], v[188:191], v[36:39]
  ds_write_b128 v14, a[8:11] offset:2048
  v_add_f32 v226, v226, v164
  v_mfma_f32_16x16x32_bf16 v[40:43], v[136:139], v[188:191], v[40:43]
  v_exp_f32 v165, v165
  v_mfma_f32_16x16x32_bf16 v[44:47], v[140:143], v[188:191], v[44:47]
  v_cvt_pk_bf16_f32 v186, v164, v165
  v_add_f32 v226, v226, v165
  v_xor_b32 v239, 96, v236
  v_mfma_f32_16x16x32_bf16 a[16:19], v[144:147], v[188:191], a[16:19]
  v_exp_f32 v166, v166
  v_mfma_f32_16x16x32_bf16 a[20:23], v[148:151], v[188:191], a[20:23]
  ds_write_b128 v14, a[12:15] offset:3072
  v_add_f32 v226, v226, v166
  v_mfma_f32_16x16x32_bf16 a[24:27], v[152:155], v[188:191], a[24:27]
  s_add_u32 s39, s93, 532480
  v_exp_f32 v167, v167
  v_mfma_f32_16x16x32_bf16 a[28:31], v[156:159], v[188:191], a[28:31]
  buffer_load_dword v2, v252, s[68:71], s39 offen
  v_cvt_pk_bf16_f32 v187, v166, v167
  v_add_f32 v226, v226, v167
  v_and_b32 v241, 15, v0
  v_mfma_f32_16x16x32_bf16 v[160:163], a[224:227], a[176:179], v[212:215]
  v_exp_f32 v168, v168
  v_mfma_f32_16x16x32_bf16 v[160:163], a[228:231], a[180:183], v[160:163]
  ds_write_b128 v14, a[16:19] offset:4096
  v_add_f32 v227, v227, v168
  v_mfma_f32_16x16x32_bf16 v[160:163], a[232:235], a[184:187], v[160:163]
  v_exp_f32 v169, v169
  v_mfma_f32_16x16x32_bf16 v[160:163], a[236:239], a[188:191], v[160:163]
  v_cvt_pk_bf16_f32 v188, v168, v169
  v_add_f32 v227, v227, v169
  v_lshl_add_u32 v241, v241, 3, s61
  v_mfma_f32_16x16x32_bf16 v[164:167], a[240:243], a[176:179], v[212:215]
  v_exp_f32 v170, v170
  v_mfma_f32_16x16x32_bf16 v[164:167], a[244:247], a[180:183], v[164:167]
  ds_write_b128 v14, a[20:23] offset:5120
  v_add_f32 v227, v227, v170
  v_mfma_f32_16x16x32_bf16 v[164:167], a[248:251], a[184:187], v[164:167]
  v_exp_f32 v171, v171
  v_mfma_f32_16x16x32_bf16 v[164:167], a[252:255], a[188:191], v[164:167]
  v_cvt_pk_bf16_f32 v189, v170, v171
  v_add_f32 v227, v227, v171
  v_xor_b32 v242, 1024, v241
  v_mfma_f32_16x16x32_bf16 v[48:51], v[128:131], v[184:187], v[48:51]
  v_exp_f32 v172, v172
  v_mfma_f32_16x16x32_bf16 v[52:55], v[132:135], v[184:187], v[52:55]
  ds_write_b128 v14, a[24:27] offset:6144
  v_add_f32 v227, v227, v172
  v_mfma_f32_16x16x32_bf16 v[56:59], v[136:139], v[184:187], v[56:59]
  v_exp_f32 v173, v173
  v_mfma_f32_16x16x32_bf16 v[60:63], v[140:143], v[184:187], v[60:63]
  v_cvt_pk_bf16_f32 v190, v172, v173
  v_add_f32 v227, v227, v173
  v_and_b32 v243, 3, v0
  v_mfma_f32_16x16x32_bf16 a[32:35], v[144:147], v[184:187], a[32:35]
  v_exp_f32 v174, v174
  v_mfma_f32_16x16x32_bf16 a[36:39], v[148:151], v[184:187], a[36:39]
  ds_write_b128 v14, a[28:31] offset:7168
  v_add_f32 v227, v227, v174
  v_mfma_f32_16x16x32_bf16 a[40:43], v[152:155], v[184:187], a[40:43]
  v_exp_f32 v175, v175
  v_mfma_f32_16x16x32_bf16 a[44:47], v[156:159], v[184:187], a[44:47]
  v_cvt_pk_bf16_f32 v191, v174, v175
  v_add_f32 v227, v227, v175
  v_lshlrev_b32 v243, 10, v243
  v_mfma_f32_16x16x32_bf16 v[168:171], a[224:227], a[192:195], v[216:219]
  v_exp_f32 v160, v160
  v_mfma_f32_16x16x32_bf16 v[168:171], a[228:231], a[196:199], v[168:171]
  ds_write_b128 v14, a[32:35] offset:8192
  v_add_f32 v228, v228, v160
  v_mfma_f32_16x16x32_bf16 v[168:171], a[232:235], a[200:203], v[168:171]
  v_exp_f32 v161, v161
  v_mfma_f32_16x16x32_bf16 v[168:171], a[236:239], a[204:207], v[168:171]
  v_cvt_pk_bf16_f32 v184, v160, v161
  v_add_f32 v228, v228, v161
  v_add_u32 v243, 86912, v243
  v_mfma_f32_16x16x32_bf16 v[172:175], a[240:243], a[192:195], v[216:219]
  v_exp_f32 v162, v162
  v_mfma_f32_16x16x32_bf16 v[172:175], a[244:247], a[196:199], v[172:175]
  ds_write_b128 v14, a[36:39] offset:9216
  v_add_f32 v228, v228, v162
  v_mfma_f32_16x16x32_bf16 v[172:175], a[248:251], a[200:203], v[172:175]
  s_add_u32 s39, s93, 536576
  v_exp_f32 v163, v163
  v_mfma_f32_16x16x32_bf16 v[172:175], a[252:255], a[204:207], v[172:175]
  buffer_load_dword v2, v252, s[68:71], s39 offen
  v_cvt_pk_bf16_f32 v185, v162, v163
  v_add_f32 v228, v228, v163
  v_mfma_f32_16x16x32_bf16 v[64:67], v[128:131], v[188:191], v[64:67]
  v_exp_f32 v164, v164
  v_mfma_f32_16x16x32_bf16 v[68:71], v[132:135], v[188:191], v[68:71]
  ds_write_b128 v14, a[40:43] offset:10240
  v_add_f32 v228, v228, v164
  v_mfma_f32_16x16x32_bf16 v[72:75], v[136:139], v[188:191], v[72:75]
  v_exp_f32 v165, v165
  v_mfma_f32_16x16x32_bf16 v[76:79], v[140:143], v[188:191], v[76:79]
  v_cvt_pk_bf16_f32 v186, v164, v165
  v_add_f32 v228, v228, v165
  v_mfma_f32_16x16x32_bf16 a[48:51], v[144:147], v[188:191], a[48:51]
  v_exp_f32 v166, v166
  v_mfma_f32_16x16x32_bf16 a[52:55], v[148:151], v[188:191], a[52:55]
  ds_write_b128 v14, a[44:47] offset:11264
  v_add_f32 v228, v228, v166
  v_mfma_f32_16x16x32_bf16 a[56:59], v[152:155], v[188:191], a[56:59]
  v_exp_f32 v167, v167
  v_mfma_f32_16x16x32_bf16 a[60:63], v[156:159], v[188:191], a[60:63]
  v_cvt_pk_bf16_f32 v187, v166, v167
  v_add_f32 v228, v228, v167
  v_mfma_f32_16x16x32_bf16 v[176:179], a[224:227], a[208:211], v[220:223]
  v_exp_f32 v168, v168
  v_mfma_f32_16x16x32_bf16 v[176:179], a[228:231], a[212:215], v[176:179]
  ds_write_b128 v14, a[48:51] offset:12288
  v_add_f32 v229, v229, v168
  v_mfma_f32_16x16x32_bf16 v[176:179], a[232:235], a[216:219], v[176:179]
  v_exp_f32 v169, v169
  v_mfma_f32_16x16x32_bf16 v[176:179], a[236:239], a[220:223], v[176:179]
  v_cvt_pk_bf16_f32 v188, v168, v169
  v_add_f32 v229, v229, v169
  v_mfma_f32_16x16x32_bf16 v[180:183], a[240:243], a[208:211], v[220:223]
  v_exp_f32 v170, v170
  v_mfma_f32_16x16x32_bf16 v[180:183], a[244:247], a[212:215], v[180:183]
  ds_write_b128 v14, a[52:55] offset:13312
  v_add_f32 v229, v229, v170
  v_mfma_f32_16x16x32_bf16 v[180:183], a[248:251], a[216:219], v[180:183]
  v_exp_f32 v171, v171
  v_mfma_f32_16x16x32_bf16 v[180:183], a[252:255], a[220:223], v[180:183]
  v_cvt_pk_bf16_f32 v189, v170, v171
  v_add_f32 v229, v229, v171
  v_mfma_f32_16x16x32_bf16 v[80:83], v[128:131], v[184:187], v[80:83]
  v_exp_f32 v172, v172
  v_mfma_f32_16x16x32_bf16 v[84:87], v[132:135], v[184:187], v[84:87]
  ds_write_b128 v14, a[56:59] offset:14336
  v_add_f32 v229, v229, v172
  v_mfma_f32_16x16x32_bf16 v[88:91], v[136:139], v[184:187], v[88:91]
  v_exp_f32 v173, v173
  v_mfma_f32_16x16x32_bf16 v[92:95], v[140:143], v[184:187], v[92:95]
  v_cvt_pk_bf16_f32 v190, v172, v173
  v_add_f32 v229, v229, v173
  v_mfma_f32_16x16x32_bf16 a[64:67], v[144:147], v[184:187], a[64:67]
  v_exp_f32 v174, v174
  v_mfma_f32_16x16x32_bf16 a[68:71], v[148:151], v[184:187], a[68:71]
  ds_write_b128 v14, a[60:63] offset:15360
  v_add_f32 v229, v229, v174
  v_mfma_f32_16x16x32_bf16 a[72:75], v[152:155], v[184:187], a[72:75]
  v_exp_f32 v175, v175
  v_mfma_f32_16x16x32_bf16 a[76:79], v[156:159], v[184:187], a[76:79]
  v_cvt_pk_bf16_f32 v191, v174, v175
  v_add_f32 v229, v229, v175
  s_nop 0
  v_mfma_f32_16x16x32_bf16 a[80:83], v[144:147], v[188:191], a[80:83]
  v_exp_f32 v176, v176
  v_mfma_f32_16x16x32_bf16 a[84:87], v[148:151], v[188:191], a[84:87]
  ds_write_b128 v14, a[64:67] offset:16384
  v_exp_f32 v177, v177
  v_add_f32 v230, v230, v176
  v_mfma_f32_16x16x32_bf16 a[88:91], v[152:155], v[188:191], a[88:91]
  v_exp_f32 v178, v178
  v_add_f32 v230, v230, v177
  v_cvt_pk_bf16_f32 v192, v176, v177
  v_mfma_f32_16x16x32_bf16 a[92:95], v[156:159], v[188:191], a[92:95]
  ds_write_b128 v14, a[68:71] offset:17408
  v_exp_f32 v179, v179
  v_add_f32 v230, v230, v178
  v_mfma_f32_16x16x32_bf16 v[96:99], v[128:131], v[188:191], v[96:99]
  v_exp_f32 v180, v180
  v_add_f32 v230, v230, v179
  v_cvt_pk_bf16_f32 v193, v178, v179
  v_mfma_f32_16x16x32_bf16 v[100:103], v[132:135], v[188:191], v[100:103]
  ds_write_b128 v14, a[72:75] offset:18432
  v_exp_f32 v181, v181
  v_add_f32 v230, v230, v180
  v_mfma_f32_16x16x32_bf16 v[104:107], v[136:139], v[188:191], v[104:107]
  v_exp_f32 v182, v182
  v_add_f32 v230, v230, v181
  v_cvt_pk_bf16_f32 v194, v180, v181
  v_mfma_f32_16x16x32_bf16 v[108:111], v[140:143], v[188:191], v[108:111]
  ds_write_b128 v14, a[76:79] offset:19456
  v_exp_f32 v183, v183
  v_add_f32 v230, v230, v182
  s_nop 0
  v_cvt_pk_bf16_f32 v195, v182, v183
  v_add_f32 v230, v230, v183
  s_mov_b32 s39, 0x53800000
  v_mfma_f32_16x16x32_bf16 a[96:99], v[144:147], v[192:195], a[96:99]
  ds_write_b128 v14, a[80:83] offset:20480
  v_mfma_f32_16x16x32_bf16 a[100:103], v[148:151], v[192:195], a[100:103]
  v_mov_b32 v244, v224
  v_mov_b32 v245, v225
  v_mfma_f32_16x16x32_bf16 a[104:107], v[152:155], v[192:195], a[104:107]
  ds_write_b128 v14, a[84:87] offset:21504
  v_mfma_f32_16x16x32_bf16 a[108:111], v[156:159], v[192:195], a[108:111]
  v_mov_b32 v246, v226
  v_mov_b32 v247, v227
  v_mfma_f32_16x16x32_bf16 v[112:115], v[128:131], v[192:195], v[112:115]
  ds_write_b128 v14, a[88:91] offset:22528
  v_mfma_f32_16x16x32_bf16 v[116:119], v[132:135], v[192:195], v[116:119]
  v_mov_b32 v248, v228
  v_mov_b32 v249, v229
  v_mfma_f32_16x16x32_bf16 v[120:123], v[136:139], v[192:195], v[120:123]
  ds_write_b128 v14, a[92:95] offset:23552
  v_mfma_f32_16x16x32_bf16 v[124:127], v[140:143], v[192:195], v[124:127]
  v_mov_b32 v250, v230
  ds_write_b128 v14, a[96:99] offset:24576
  ds_write_b128 v14, a[100:103] offset:25600
  v_permlane32_swap_b32 v224, v244
  v_permlane32_swap_b32 v225, v245
  v_permlane32_swap_b32 v226, v246
  v_permlane32_swap_b32 v227, v247
  v_permlane32_swap_b32 v228, v248
  v_permlane32_swap_b32 v229, v249
  v_permlane32_swap_b32 v230, v250
  ds_write_b128 v14, a[104:107] offset:26624
  v_add_f32 v224, v224, v244
  v_add_f32 v225, v225, v245
  v_add_f32 v226, v226, v246
  v_add_f32 v227, v227, v247
  v_add_f32 v228, v228, v248
  v_add_f32 v229, v229, v249
  v_add_f32 v230, v230, v250
  v_mov_b32 v244, v224
  v_mov_b32 v245, v225
  v_mov_b32 v246, v226
  v_mov_b32 v247, v227
  v_mov_b32 v248, v228
  v_mov_b32 v249, v229
  v_mov_b32 v250, v230
  ds_write_b128 v14, a[108:111] offset:27648
  s_nop 0
  v_permlane16_swap_b32 v224, v244
  v_permlane16_swap_b32 v225, v245
  v_permlane16_swap_b32 v226, v246
  v_permlane16_swap_b32 v227, v247
  v_permlane16_swap_b32 v228, v248
  v_permlane16_swap_b32 v229, v249
  v_permlane16_swap_b32 v230, v250
  s_nop 0
  v_add_f32 v197, v224, v244
  v_add_f32 v201, v225, v245
  v_add_f32 v205, v226, v246
  v_add_f32 v209, v227, v247
  v_add_f32 v213, v228, v248
  v_add_f32 v217, v229, v249
  v_add_f32 v221, v230, v250
  v_add_f32 v244, v197, v201
  v_add_f32 v245, v205, v209
  v_add_f32 v246, v213, v217
  v_add_f32 v244, v244, v221
  v_add_f32 v245, v245, v246
  v_add_f32 v244, v244, v245
  v_cmp_nlt_f32 vcc, v244, s39
  ds_write_b64 v241, v[196:197] offset:0
  ds_write_b64 v241, v[200:201] offset:128
  ds_write_b64 v241, v[204:205] offset:256
  ds_write_b64 v241, v[208:209] offset:384
  ds_write_b64 v241, v[212:213] offset:512
  ds_write_b64 v241, v[216:217] offset:640
  ds_write_b64 v241, v[220:221] offset:768
  s_cmp_lg_u64 vcc, 0
  s_cselect_b32 s40, 1, 0
  s_andn2_b32 s40, s40, s47
  v_mov_b32 v245, s40
  ds_write_b32 v241, v245 offset:896
  s_waitcnt lgkmcnt(0)
  s_barrier
  ds_read_b32 v248, v243
  ds_read_b64 v[198:199], v242 offset:0
  ds_read_b64 v[202:203], v242 offset:128
  ds_read_b64 v[206:207], v242 offset:256
  ds_read_b64 v[210:211], v242 offset:384
  ds_read_b64 v[214:215], v242 offset:512
  ds_read_b64 v[218:219], v242 offset:640
  ds_read_b64 v[222:223], v242 offset:768
  ds_read_b128 v[128:131], v15 offset:0
  ds_read_b128 v[132:135], v15 offset:1024
  ds_read_b128 v[136:139], v15 offset:2048
  ds_read_b128 v[140:143], v15 offset:3072
  s_waitcnt lgkmcnt(11) vmcnt(5)
  v_cmp_ne_u32 vcc, 0, v248
  ds_read_b128 v[144:147], v15 offset:4096
  ds_read_b128 v[148:151], v15 offset:5120
  ds_read_b128 v[152:155], v15 offset:6144
  ds_read_b128 v[156:159], v15 offset:7168
  s_cbranch_vccnz L_fallback
  ds_read_b64_tr_b16 a[56:57], v232 offset:0
  ds_read_b64_tr_b16 a[58:59], v232 offset:2048
  ds_read_b64_tr_b16 a[60:61], v233 offset:0
  ds_read_b64_tr_b16 a[62:63], v233 offset:2048
  ds_read_b64_tr_b16 a[64:65], v234 offset:0
  ds_read_b64_tr_b16 a[66:67], v234 offset:2048
  ds_read_b64_tr_b16 a[68:69], v235 offset:0
  ds_read_b64_tr_b16 a[70:71], v235 offset:2048
  ds_read_b64_tr_b16 a[72:73], v232 offset:4096
  ds_read_b64_tr_b16 a[74:75], v232 offset:6144
  ds_read_b64_tr_b16 a[76:77], v233 offset:4096
  ds_read_b64_tr_b16 a[78:79], v233 offset:6144
  ds_read_b64_tr_b16 a[80:81], v234 offset:4096
  ds_read_b64_tr_b16 a[82:83], v234 offset:6144
  ds_read_b64_tr_b16 a[84:85], v235 offset:4096
  ds_read_b64_tr_b16 a[86:87], v235 offset:6144
  ds_read_b128 v[160:163], v15 offset:8192
  ds_read_b128 v[164:167], v15 offset:9216
  ds_read_b128 v[168:171], v15 offset:10240
  ds_read_b128 v[172:175], v15 offset:11264
  s_waitcnt lgkmcnt(14)
  v_min_f32 v224, v196, v198
  v_min_f32 v225, v200, v202
  v_min_f32 v226, v204, v206
  v_min_f32 v227, v208, v210
  v_min_f32 v228, v212, v214
  v_min_f32 v229, v216, v218
  v_min_f32 v230, v220, v222
  v_sub_f32 v196, v224, v196
  v_sub_f32 v198, v224, v198
  v_sub_f32 v200, v225, v200
  v_sub_f32 v202, v225, v202
  v_sub_f32 v204, v226, v204
  v_sub_f32 v206, v226, v206
  v_sub_f32 v208, v227, v208
  v_sub_f32 v210, v227, v210
  v_sub_f32 v212, v228, v212
  v_sub_f32 v214, v228, v214
  v_sub_f32 v216, v229, v216
  v_sub_f32 v218, v229, v218
  v_sub_f32 v220, v230, v220
  v_sub_f32 v222, v230, v222
  s_waitcnt lgkmcnt(4)
  s_add_u32 m0, s88, 0
  s_nop 0
  buffer_load_dwordx4 v8, s[68:71], s82 offen offset:0 lds
  buffer_load_dwordx4 v9, s[68:71], s82 offen offset:1024 lds
  buffer_load_dwordx4 v10, s[68:71], s82 offen offset:2048 lds
  buffer_load_dwordx4 v11, s[68:71], s82 offen offset:3072 lds
  s_add_u32 m0, s88, 4096
  s_nop 0
  buffer_load_dwordx4 v8, s[68:71], s83 offen offset:0 lds
  buffer_load_dwordx4 v9, s[68:71], s83 offen offset:1024 lds
  buffer_load_dwordx4 v10, s[68:71], s83 offen offset:2048 lds
  buffer_load_dwordx4 v11, s[68:71], s83 offen offset:3072 lds
  v_exp_f32 v196, v196
  v_exp_f32 v198, v198
  v_exp_f32 v200, v200
  v_exp_f32 v202, v202
  v_exp_f32 v204, v204
  v_exp_f32 v206, v206
  v_exp_f32 v208, v208
  v_exp_f32 v210, v210
  v_exp_f32 v212, v212
  v_exp_f32 v214, v214
  v_exp_f32 v216, v216
  v_exp_f32 v218, v218
  v_exp_f32 v220, v220
  v_exp_f32 v222, v222
  v_mul_f32 v197, v197, v196
  v_mul_f32 v201, v201, v200
  v_mul_f32 v205, v205, v204
  v_mul_f32 v209, v209, v208
  v_mul_f32 v213, v213, v212
  v_mul_f32 v217, v217, v216
  v_mul_f32 v221, v221, v220
  v_fma_f32 v197, v199, v198, v197
  v_fma_f32 v201, v203, v202, v201
  v_fma_f32 v205, v207, v206, v205
  v_fma_f32 v209, v211, v210, v209
  v_fma_f32 v213, v215, v214, v213
  v_fma_f32 v217, v219, v218, v217
  v_fma_f32 v221, v223, v222, v221
  v_rcp_f32 v197, v197
  v_rcp_f32 v201, v201
  v_rcp_f32 v205, v205
  v_rcp_f32 v209, v209
  v_rcp_f32 v213, v213
  v_rcp_f32 v217, v217
  v_rcp_f32 v221, v221
  v_mul_f32 v196, v196, v197
  v_mul_f32 v198, v198, v197
  v_mul_f32 v200, v200, v201
  v_mul_f32 v202, v202, v201
  v_mul_f32 v204, v204, v205
  v_mul_f32 v206, v206, v205
  v_mul_f32 v208, v208, v209
  v_mul_f32 v210, v210, v209
  v_mul_f32 v212, v212, v213
  v_mul_f32 v214, v214, v213
  v_mul_f32 v216, v216, v217
  v_mul_f32 v218, v218, v217
  v_mul_f32 v220, v220, v221
  v_mul_f32 v222, v222, v221
  ds_read_b128 v[176:179], v15 offset:12288
  ds_read_b128 v[180:183], v15 offset:13312
  ds_read_b128 v[184:187], v15 offset:14336
  ds_read_b128 v[188:191], v15 offset:15360
  v_pk_mul_f32 v[16:17], v[16:17], v[196:197] op_sel_hi:[1,0]
  v_pk_mul_f32 v[18:19], v[18:19], v[196:197] op_sel_hi:[1,0]
  v_pk_mul_f32 v[20:21], v[20:21], v[196:197] op_sel_hi:[1,0]
  v_pk_mul_f32 v[22:23], v[22:23], v[196:197] op_sel_hi:[1,0]
  v_pk_mul_f32 v[24:25], v[24:25], v[196:197] op_sel_hi:[1,0]
  v_pk_mul_f32 v[26:27], v[26:27], v[196:197] op_sel_hi:[1,0]
  v_pk_mul_f32 v[28:29], v[28:29], v[196:197] op_sel_hi:[1,0]
  v_pk_mul_f32 v[30:31], v[30:31], v[196:197] op_sel_hi:[1,0]
  v_pk_fma_f32 v[16:17], v[128:129], v[198:199], v[16:17] op_sel_hi:[1,0,1]
  v_pk_fma_f32 v[18:19], v[130:131], v[198:199], v[18:19] op_sel_hi:[1,0,1]
  v_pk_fma_f32 v[20:21], v[132:133], v[198:199], v[20:21] op_sel_hi:[1,0,1]
  v_pk_fma_f32 v[22:23], v[134:135], v[198:199], v[22:23] op_sel_hi:[1,0,1]
  v_pk_fma_f32 v[24:25], v[136:137], v[198:199], v[24:25] op_sel_hi:[1,0,1]
  v_pk_fma_f32 v[26:27], v[138:139], v[198:199], v[26:27] op_sel_hi:[1,0,1]
  v_pk_fma_f32 v[28:29], v[140:141], v[198:199], v[28:29] op_sel_hi:[1,0,1]
  v_pk_fma_f32 v[30:31], v[142:143], v[198:199], v[30:31] op_sel_hi:[1,0,1]
  v_cvt_pk_bf16_f32 v16, v16, v17
  v_cvt_pk_bf16_f32 v17, v18, v19
  v_cvt_pk_bf16_f32 v18, v20, v21
  v_cvt_pk_bf16_f32 v19, v22, v23
  v_cvt_pk_bf16_f32 v20, v24, v25
  v_cvt_pk_bf16_f32 v21, v26, v27
  v_cvt_pk_bf16_f32 v22, v28, v29
  v_cvt_pk_bf16_f32 v23, v30, v31
  s_add_u32 s40, s51, 0
  s_add_u32 s41, s51, 7168
  buffer_store_dwordx4 v[16:19], v1, s[24:27], s40 offen sc1
  buffer_store_dwordx4 v[20:23], v1, s[24:27], s41 offen sc1
  ds_read_b128 v[128:131], v15 offset:16384
  ds_read_b128 v[132:135], v15 offset:17408
  ds_read_b128 v[136:139], v15 offset:18432
  ds_read_b128 v[140:143], v15 offset:19456
  v_pk_mul_f32 v[32:33], v[32:33], v[200:201] op_sel_hi:[1,0]
  v_pk_mul_f32 v[34:35], v[34:35], v[200:201] op_sel_hi:[1,0]
  v_pk_mul_f32 v[36:37], v[36:37], v[200:201] op_sel_hi:[1,0]
  v_pk_mul_f32 v[38:39], v[38:39], v[200:201] op_sel_hi:[1,0]
  v_pk_mul_f32 v[40:41], v[40:41], v[200:201] op_sel_hi:[1,0]
  v_pk_mul_f32 v[42:43], v[42:43], v[200:201] op_sel_hi:[1,0]
  v_pk_mul_f32 v[44:45], v[44:45], v[200:201] op_sel_hi:[1,0]
  v_pk_mul_f32 v[46:47], v[46:47], v[200:201] op_sel_hi:[1,0]
  v_pk_fma_f32 v[32:33], v[144:145], v[202:203], v[32:33] op_sel_hi:[1,0,1]
  v_pk_fma_f32 v[34:35], v[146:147], v[202:203], v[34:35] op_sel_hi:[1,0,1]
  v_pk_fma_f32 v[36:37], v[148:149], v[202:203], v[36:37] op_sel_hi:[1,0,1]
  v_pk_fma_f32 v[38:39], v[150:151], v[202:203], v[38:39] op_sel_hi:[1,0,1]
  v_pk_fma_f32 v[40:41], v[152:153], v[202:203], v[40:41] op_sel_hi:[1,0,1]
  v_pk_fma_f32 v[42:43], v[154:155], v[202:203], v[42:43] op_sel_hi:[1,0,1]
  v_pk_fma_f32 v[44:45], v[156:157], v[202:203], v[44:45] op_sel_hi:[1,0,1]
  v_pk_fma_f32 v[46:47], v[158:159], v[202:203], v[46:47] op_sel_hi:[1,0,1]
  v_cvt_pk_bf16_f32 v32, v32, v33
  v_cvt_pk_bf16_f32 v33, v34, v35
  v_cvt_pk_bf16_f32 v34, v36, v37
  v_cvt_pk_bf16_f32 v35, v38, v39
  v_cvt_pk_bf16_f32 v36, v40, v41
  v_cvt_pk_bf16_f32 v37, v42, v43
  v_cvt_pk_bf16_f32 v38, v44, v45
  v_cvt_pk_bf16_f32 v39, v46, v47
  s_add_u32 s40, s51, 1024
  s_add_u32 s41, s51, 8192
  buffer_store_dwordx4 v[32:35], v1, s[24:27], s40 offen sc1
  buffer_store_dwordx4 v[36:39], v1, s[24:27], s41 offen sc1
  ds_read_b128 v[144:147], v15 offset:20480
  ds_read_b128 v[148:151], v15 offset:21504
  ds_read_b128 v[152:155], v15 offset:22528
  ds_read_b128 v[156:159], v15 offset:23552
  s_waitcnt lgkmcnt(12)
  v_pk_mul_f32 v[48:49], v[48:49], v[204:205] op_sel_hi:[1,0]
  v_pk_mul_f32 v[50:51], v[50:51], v[204:205] op_sel_hi:[1,0]
  v_pk_mul_f32 v[52:53], v[52:53], v[204:205] op_sel_hi:[1,0]
  v_pk_mul_f32 v[54:55], v[54:55], v[204:205] op_sel_hi:[1,0]
  v_pk_mul_f32 v[56:57], v[56:57], v[204:205] op_sel_hi:[1,0]
  v_pk_mul_f32 v[58:59], v[58:59], v[204:205] op_sel_hi:[1,0]
  v_pk_mul_f32 v[60:61], v[60:61], v[204:205] op_sel_hi:[1,0]
  v_pk_mul_f32 v[62:63], v[62:63], v[204:205] op_sel_hi:[1,0]
  v_pk_fma_f32 v[48:49], v[160:161], v[206:207], v[48:49] op_sel_hi:[1,0,1]
  v_pk_fma_f32 v[50:51], v[162:163], v[206:207], v[50:51] op_sel_hi:[1,0,1]
  v_pk_fma_f32 v[52:53], v[164:165], v[206:207], v[52:53] op_sel_hi:[1,0,1]
  v_pk_fma_f32 v[54:55], v[166:167], v[206:207], v[54:55] op_sel_hi:[1,0,1]
  v_pk_fma_f32 v[56:57], v[168:169], v[206:207], v[56:57] op_sel_hi:[1,0,1]
  v_pk_fma_f32 v[58:59], v[170:171], v[206:207], v[58:59] op_sel_hi:[1,0,1]
  v_pk_fma_f32 v[60:61], v[172:173], v[206:207], v[60:61] op_sel_hi:[1,0,1]
  v_pk_fma_f32 v[62:63], v[174:175], v[206:207], v[62:63] op_sel_hi:[1,0,1]
  v_cvt_pk_bf16_f32 v48, v48, v49
  v_cvt_pk_bf16_f32 v49, v50, v51
  v_cvt_pk_bf16_f32 v50, v52, v53
  v_cvt_pk_bf16_f32 v51, v54, v55
  v_cvt_pk_bf16_f32 v52, v56, v57
  v_cvt_pk_bf16_f32 v53, v58, v59
  v_cvt_pk_bf16_f32 v54, v60, v61
  v_cvt_pk_bf16_f32 v55, v62, v63
  s_add_u32 s40, s51, 2048
  s_add_u32 s41, s51, 9216
  buffer_store_dwordx4 v[48:51], v1, s[24:27], s40 offen sc1
  buffer_store_dwordx4 v[52:55], v1, s[24:27], s41 offen sc1
  ds_read_b128 v[160:163], v15 offset:24576
  ds_read_b128 v[164:167], v15 offset:25600
  ds_read_b128 v[168:171], v15 offset:26624
  ds_read_b128 v[172:175], v15 offset:27648
  s_waitcnt lgkmcnt(12)
  v_pk_mul_f32 v[64:65], v[64:65], v[208:209] op_sel_hi:[1,0]
  v_pk_mul_f32 v[66:67], v[66:67], v[208:209] op_sel_hi:[1,0]
  v_pk_mul_f32 v[68:69], v[68:69], v[208:209] op_sel_hi:[1,0]
  v_pk_mul_f32 v[70:71], v[70:71], v[208:209] op_sel_hi:[1,0]
  v_pk_mul_f32 v[72:73], v[72:73], v[208:209] op_sel_hi:[1,0]
  v_pk_mul_f32 v[74:75], v[74:75], v[208:209] op_sel_hi:[1,0]
  v_pk_mul_f32 v[76:77], v[76:77], v[208:209] op_sel_hi:[1,0]
  v_pk_mul_f32 v[78:79], v[78:79], v[208:209] op_sel_hi:[1,0]
  v_pk_fma_f32 v[64:65], v[176:177], v[210:211], v[64:65] op_sel_hi:[1,0,1]
  v_pk_fma_f32 v[66:67], v[178:179], v[210:211], v[66:67] op_sel_hi:[1,0,1]
  v_pk_fma_f32 v[68:69], v[180:181], v[210:211], v[68:69] op_sel_hi:[1,0,1]
  v_pk_fma_f32 v[70:71], v[182:183], v[210:211], v[70:71] op_sel_hi:[1,0,1]
  v_pk_fma_f32 v[72:73], v[184:185], v[210:211], v[72:73] op_sel_hi:[1,0,1]
  v_pk_fma_f32 v[74:75], v[186:187], v[210:211], v[74:75] op_sel_hi:[1,0,1]
  v_pk_fma_f32 v[76:77], v[188:189], v[210:211], v[76:77] op_sel_hi:[1,0,1]
  v_pk_fma_f32 v[78:79], v[190:191], v[210:211], v[78:79] op_sel_hi:[1,0,1]
  v_cvt_pk_bf16_f32 v64, v64, v65
  v_cvt_pk_bf16_f32 v65, v66, v67
  v_cvt_pk_bf16_f32 v66, v68, v69
  v_cvt_pk_bf16_f32 v67, v70, v71
  v_cvt_pk_bf16_f32 v68, v72, v73
  v_cvt_pk_bf16_f32 v69, v74, v75
  v_cvt_pk_bf16_f32 v70, v76, v77
  v_cvt_pk_bf16_f32 v71, v78, v79
  s_add_u32 s40, s51, 3072
  s_add_u32 s41, s51, 10240
  buffer_store_dwordx4 v[64:67], v1, s[24:27], s40 offen sc1
  buffer_store_dwordx4 v[68:71], v1, s[24:27], s41 offen sc1
  s_waitcnt lgkmcnt(8)
  v_pk_mul_f32 v[80:81], v[80:81], v[212:213] op_sel_hi:[1,0]
  v_pk_mul_f32 v[82:83], v[82:83], v[212:213] op_sel_hi:[1,0]
  v_pk_mul_f32 v[84:85], v[84:85], v[212:213] op_sel_hi:[1,0]
  v_pk_mul_f32 v[86:87], v[86:87], v[212:213] op_sel_hi:[1,0]
  v_pk_mul_f32 v[88:89], v[88:89], v[212:213] op_sel_hi:[1,0]
  v_pk_mul_f32 v[90:91], v[90:91], v[212:213] op_sel_hi:[1,0]
  v_pk_mul_f32 v[92:93], v[92:93], v[212:213] op_sel_hi:[1,0]
  v_pk_mul_f32 v[94:95], v[94:95], v[212:213] op_sel_hi:[1,0]
  v_pk_fma_f32 v[80:81], v[128:129], v[214:215], v[80:81] op_sel_hi:[1,0,1]
  v_pk_fma_f32 v[82:83], v[130:131], v[214:215], v[82:83] op_sel_hi:[1,0,1]
  v_pk_fma_f32 v[84:85], v[132:133], v[214:215], v[84:85] op_sel_hi:[1,0,1]
  v_pk_fma_f32 v[86:87], v[134:135], v[214:215], v[86:87] op_sel_hi:[1,0,1]
  v_pk_fma_f32 v[88:89], v[136:137], v[214:215], v[88:89] op_sel_hi:[1,0,1]
  v_pk_fma_f32 v[90:91], v[138:139], v[214:215], v[90:91] op_sel_hi:[1,0,1]
  v_pk_fma_f32 v[92:93], v[140:141], v[214:215], v[92:93] op_sel_hi:[1,0,1]
  v_pk_fma_f32 v[94:95], v[142:143], v[214:215], v[94:95] op_sel_hi:[1,0,1]
  v_cvt_pk_bf16_f32 v80, v80, v81
  v_cvt_pk_bf16_f32 v81, v82, v83
  v_cvt_pk_bf16_f32 v82, v84, v85
  v_cvt_pk_bf16_f32 v83, v86, v87
  v_cvt_pk_bf16_f32 v84, v88, v89
  v_cvt_pk_bf16_f32 v85, v90, v91
  v_cvt_pk_bf16_f32 v86, v92, v93
  v_cvt_pk_bf16_f32 v87, v94, v95
  s_add_u32 s40, s51, 4096
  s_add_u32 s41, s51, 11264
  buffer_store_dwordx4 v[80:83], v1, s[24:27], s40 offen sc1
  buffer_store_dwordx4 v[84:87], v1, s[24:27], s41 offen sc1
  s_waitcnt lgkmcnt(4)
  v_pk_mul_f32 v[96:97], v[96:97], v[216:217] op_sel_hi:[1,0]
  v_pk_mul_f32 v[98:99], v[98:99], v[216:217] op_sel_hi:[1,0]
  v_pk_mul_f32 v[100:101], v[100:101], v[216:217] op_sel_hi:[1,0]
  v_pk_mul_f32 v[102:103], v[102:103], v[216:217] op_sel_hi:[1,0]
  v_pk_mul_f32 v[104:105], v[104:105], v[216:217] op_sel_hi:[1,0]
  v_pk_mul_f32 v[106:107], v[106:107], v[216:217] op_sel_hi:[1,0]
  v_pk_mul_f32 v[108:109], v[108:109], v[216:217] op_sel_hi:[1,0]
  v_pk_mul_f32 v[110:111], v[110:111], v[216:217] op_sel_hi:[1,0]
  v_pk_fma_f32 v[96:97], v[144:145], v[218:219], v[96:97] op_sel_hi:[1,0,1]
  v_pk_fma_f32 v[98:99], v[146:147], v[218:219], v[98:99] op_sel_hi:[1,0,1]
  v_pk_fma_f32 v[100:101], v[148:149], v[218:219], v[100:101] op_sel_hi:[1,0,1]
  v_pk_fma_f32 v[102:103], v[150:151], v[218:219], v[102:103] op_sel_hi:[1,0,1]
  v_pk_fma_f32 v[104:105], v[152:153], v[218:219], v[104:105] op_sel_hi:[1,0,1]
  v_pk_fma_f32 v[106:107], v[154:155], v[218:219], v[106:107] op_sel_hi:[1,0,1]
  v_pk_fma_f32 v[108:109], v[156:157], v[218:219], v[108:109] op_sel_hi:[1,0,1]
  v_pk_fma_f32 v[110:111], v[158:159], v[218:219], v[110:111] op_sel_hi:[1,0,1]
  v_cvt_pk_bf16_f32 v96, v96, v97
  v_cvt_pk_bf16_f32 v97, v98, v99
  v_cvt_pk_bf16_f32 v98, v100, v101
  v_cvt_pk_bf16_f32 v99, v102, v103
  v_cvt_pk_bf16_f32 v100, v104, v105
  v_cvt_pk_bf16_f32 v101, v106, v107
  v_cvt_pk_bf16_f32 v102, v108, v109
  v_cvt_pk_bf16_f32 v103, v110, v111
  s_add_u32 s40, s51, 5120
  s_add_u32 s41, s51, 12288
  buffer_store_dwordx4 v[96:99], v1, s[24:27], s40 offen sc1
  buffer_store_dwordx4 v[100:103], v1, s[24:27], s41 offen sc1
  s_waitcnt lgkmcnt(0)
  v_pk_mul_f32 v[112:113], v[112:113], v[220:221] op_sel_hi:[1,0]
  v_pk_mul_f32 v[114:115], v[114:115], v[220:221] op_sel_hi:[1,0]
  v_pk_mul_f32 v[116:117], v[116:117], v[220:221] op_sel_hi:[1,0]
  v_pk_mul_f32 v[118:119], v[118:119], v[220:221] op_sel_hi:[1,0]
  v_pk_mul_f32 v[120:121], v[120:121], v[220:221] op_sel_hi:[1,0]
  v_pk_mul_f32 v[122:123], v[122:123], v[220:221] op_sel_hi:[1,0]
  v_pk_mul_f32 v[124:125], v[124:125], v[220:221] op_sel_hi:[1,0]
  v_pk_mul_f32 v[126:127], v[126:127], v[220:221] op_sel_hi:[1,0]
  v_pk_fma_f32 v[112:113], v[160:161], v[222:223], v[112:113] op_sel_hi:[1,0,1]
  v_pk_fma_f32 v[114:115], v[162:163], v[222:223], v[114:115] op_sel_hi:[1,0,1]
  v_pk_fma_f32 v[116:117], v[164:165], v[222:223], v[116:117] op_sel_hi:[1,0,1]
  v_pk_fma_f32 v[118:119], v[166:167], v[222:223], v[118:119] op_sel_hi:[1,0,1]
  v_pk_fma_f32 v[120:121], v[168:169], v[222:223], v[120:121] op_sel_hi:[1,0,1]
  v_pk_fma_f32 v[122:123], v[170:171], v[222:223], v[122:123] op_sel_hi:[1,0,1]
  v_pk_fma_f32 v[124:125], v[172:173], v[222:223], v[124:125] op_sel_hi:[1,0,1]
  v_pk_fma_f32 v[126:127], v[174:175], v[222:223], v[126:127] op_sel_hi:[1,0,1]
  v_cvt_pk_bf16_f32 v112, v112, v113
  v_cvt_pk_bf16_f32 v113, v114, v115
  v_cvt_pk_bf16_f32 v114, v116, v117
  v_cvt_pk_bf16_f32 v115, v118, v119
  v_cvt_pk_bf16_f32 v116, v120, v121
  v_cvt_pk_bf16_f32 v117, v122, v123
  v_cvt_pk_bf16_f32 v118, v124, v125
  v_cvt_pk_bf16_f32 v119, v126, v127
  s_add_u32 s40, s51, 6144
  s_add_u32 s41, s51, 13312
  buffer_store_dwordx4 v[112:115], v1, s[24:27], s40 offen sc1
  buffer_store_dwordx4 v[116:119], v1, s[24:27], s41 offen sc1
  v_mov_b32 v244, s91
  v_mov_b32 v245, 1
  v_and_b32 v246, 3, v0
  v_lshl_add_u32 v246, v246, 2, s92
  s_bfe_u32 s39, s30, 0x10003
  s_mul_i32 s10, s39, 917504
  s_sub_u32 s8, 917504, s10
  s_add_u32 s9, s8, 57344
  s_add_u32 s11, s10, 57344
  s_lshl_b32 s39, s29, 5
  s_add_u32 s39, s39, s30
  s_lshl_b32 s39, s39, 2
  s_add_u32 s39, s39, s28
  s_xor_b32 s39, s39, 32
  s_mul_i32 s20, s39, 7168
  s_add_u32 s20, s20, 16777216
  s_waitcnt vmcnt(18)
  ds_read_b64_tr_b16 a[88:89], v232 offset:0
  ds_read_b64_tr_b16 a[90:91], v232 offset:2048
  ds_read_b64_tr_b16 a[92:93], v233 offset:0
  ds_read_b64_tr_b16 a[94:95], v233 offset:2048
  ds_read_b64_tr_b16 a[96:97], v234 offset:0
  ds_read_b64_tr_b16 a[98:99], v234 offset:2048
  ds_read_b64_tr_b16 a[100:101], v235 offset:0
  ds_read_b64_tr_b16 a[102:103], v235 offset:2048
  s_waitcnt vmcnt(14)
  ds_read_b64_tr_b16 a[104:105], v232 offset:4096
  ds_read_b64_tr_b16 a[106:107], v232 offset:6144
  ds_read_b64_tr_b16 a[108:109], v233 offset:4096
  ds_read_b64_tr_b16 a[110:111], v233 offset:6144
  ds_read_b64_tr_b16 a[112:113], v234 offset:4096
  ds_read_b64_tr_b16 a[114:115], v234 offset:6144
  ds_read_b64_tr_b16 a[116:117], v235 offset:4096
  ds_read_b64_tr_b16 a[118:119], v235 offset:6144
  s_waitcnt vmcnt(0)
  s_barrier
  s_cmp_lg_u32 s28, 0
  s_cbranch_scc1 L_nosig
  s_mov_b64 exec, 1
  global_store_dword v244, v245, s[66:67] sc1
  s_mov_b64 exec, -1
L_nosig:
  s_mov_b32 s38, 0
  L_poll0:
  v_readfirstlane_b32 s39, v254
  s_nop 0
  s_cmp_ge_u32 s39, 256
  s_cbranch_scc1 L_ready0
  s_add_u32 s38, s38, 1
  s_cmp_ge_u32 s38, 0x40000
  s_cbranch_scc1 L_ready0
  global_load_dword v254, v253, s[64:65] sc1
  s_waitcnt vmcnt(0)
  s_branch L_poll0
  L_ready0:
  s_waitcnt lgkmcnt(0)
  s_add_u32 m0, s89, 0
  s_nop 0
  buffer_load_dwordx4 v8, s[68:71], s84 offen offset:0 lds
  buffer_load_dwordx4 v9, s[68:71], s84 offen offset:1024 lds
  buffer_load_dwordx4 v10, s[68:71], s84 offen offset:2048 lds
  buffer_load_dwordx4 v11, s[68:71], s84 offen offset:3072 lds
  s_add_u32 m0, s89, 4096
  s_nop 0
  buffer_load_dwordx4 v8, s[68:71], s85 offen offset:0 lds
  buffer_load_dwordx4 v9, s[68:71], s85 offen offset:1024 lds
  buffer_load_dwordx4 v10, s[68:71], s85 offen offset:2048 lds
  buffer_load_dwordx4 v11, s[68:71], s85 offen offset:3072 lds
  s_add_u32 m0, s89, 8192
  s_nop 0
  buffer_load_dwordx4 v8, s[68:71], s86 offen offset:0 lds
  buffer_load_dwordx4 v9, s[68:71], s86 offen offset:1024 lds
  buffer_load_dwordx4 v10, s[68:71], s86 offen offset:2048 lds
  buffer_load_dwordx4 v11, s[68:71], s86 offen offset:3072 lds
  s_add_u32 m0, s89, 12288
  s_nop 0
  buffer_load_dwordx4 v8, s[68:71], s87 offen offset:0 lds
  buffer_load_dwordx4 v9, s[68:71], s87 offen offset:1024 lds
  buffer_load_dwordx4 v10, s[68:71], s87 offen offset:2048 lds
  buffer_load_dwordx4 v11, s[68:71], s87 offen offset:3072 lds
  s_add_u32 s68, s68, 524288
  s_addc_u32 s69, s69, 0
  s_sub_u32 s70, s70, 524288
  s_add_u32 m0, s89, 16384
  s_nop 0
  buffer_load_dwordx4 v8, s[68:71], s80 offen offset:0 lds
  buffer_load_dwordx4 v9, s[68:71], s80 offen offset:1024 lds
  buffer_load_dwordx4 v10, s[68:71], s80 offen offset:2048 lds
  buffer_load_dwordx4 v11, s[68:71], s80 offen offset:3072 lds
  s_add_u32 m0, s89, 20480
  s_nop 0
  buffer_load_dwordx4 v8, s[68:71], s81 offen offset:0 lds
  buffer_load_dwordx4 v9, s[68:71], s81 offen offset:1024 lds
  buffer_load_dwordx4 v10, s[68:71], s81 offen offset:2048 lds
  buffer_load_dwordx4 v11, s[68:71], s81 offen offset:3072 lds
  s_add_u32 m0, s89, 24576
  s_nop 0
  buffer_load_dwordx4 v8, s[68:71], s82 offen offset:0 lds
  buffer_load_dwordx4 v9, s[68:71], s82 offen offset:1024 lds
  buffer_load_dwordx4 v10, s[68:71], s82 offen offset:2048 lds
  buffer_load_dwordx4 v11, s[68:71], s82 offen offset:3072 lds
  s_add_u32 m0, s88, 0
  s_nop 0
  buffer_load_dwordx4 v8, s[68:71], s83 offen offset:0 lds
  buffer_load_dwordx4 v9, s[68:71], s83 offen offset:1024 lds
  buffer_load_dwordx4 v10, s[68:71], s83 offen offset:2048 lds
  buffer_load_dwordx4 v11, s[68:71], s83 offen offset:3072 lds
  s_add_u32 m0, s88, 4096
  s_nop 0
  buffer_load_dwordx4 v8, s[68:71], s84 offen offset:0 lds
  buffer_load_dwordx4 v9, s[68:71], s84 offen offset:1024 lds
  buffer_load_dwordx4 v10, s[68:71], s84 offen offset:2048 lds
  buffer_load_dwordx4 v11, s[68:71], s84 offen offset:3072 lds
  s_waitcnt vmcnt(32)
  ds_read_b64_tr_b16 a[120:121], v236 offset:0
  ds_read_b64_tr_b16 a[122:123], v236 offset:2048
  ds_read_b64_tr_b16 a[124:125], v237 offset:0
  ds_read_b64_tr_b16 a[126:127], v237 offset:2048
  ds_read_b64_tr_b16 a[128:129], v238 offset:0
  ds_read_b64_tr_b16 a[130:131], v238 offset:2048
  ds_read_b64_tr_b16 a[132:133], v239 offset:0
  ds_read_b64_tr_b16 a[134:135], v239 offset:2048
  s_waitcnt vmcnt(28)
  ds_read_b64_tr_b16 a[136:137], v236 offset:4096
  ds_read_b64_tr_b16 a[138:139], v236 offset:6144
  ds_read_b64_tr_b16 a[140:141], v237 offset:4096
  ds_read_b64_tr_b16 a[142:143], v237 offset:6144
  ds_read_b64_tr_b16 a[144:145], v238 offset:4096
  ds_read_b64_tr_b16 a[146:147], v238 offset:6144
  ds_read_b64_tr_b16 a[148:149], v239 offset:4096
  ds_read_b64_tr_b16 a[150:151], v239 offset:6144
  s_waitcnt lgkmcnt(8)
  s_add_u32 m0, s89, 0
  s_nop 0
  buffer_load_dwordx4 v8, s[68:71], s85 offen offset:0 lds
  buffer_load_dwordx4 v9, s[68:71], s85 offen offset:1024 lds
  buffer_load_dwordx4 v10, s[68:71], s85 offen offset:2048 lds
  buffer_load_dwordx4 v11, s[68:71], s85 offen offset:3072 lds
  s_waitcnt vmcnt(28)
  ds_read_b64_tr_b16 a[152:153], v236 offset:8192
  ds_read_b64_tr_b16 a[154:155], v236 offset:10240
  ds_read_b64_tr_b16 a[156:157], v237 offset:8192
  ds_read_b64_tr_b16 a[158:159], v237 offset:10240
  ds_read_b64_tr_b16 a[160:161], v238 offset:8192
  ds_read_b64_tr_b16 a[162:163], v238 offset:10240
  ds_read_b64_tr_b16 a[164:165], v239 offset:8192
  ds_read_b64_tr_b16 a[166:167], v239 offset:10240
  s_waitcnt lgkmcnt(8)
  global_load_dword v247, v246, s[66:67] sc1
  s_add_u32 m0, s89, 4096
  s_nop 0
  buffer_load_dwordx4 v8, s[68:71], s86 offen offset:0 lds
  buffer_load_dwordx4 v9, s[68:71], s86 offen offset:1024 lds
  buffer_load_dwordx4 v10, s[68:71], s86 offen offset:2048 lds
  buffer_load_dwordx4 v11, s[68:71], s86 offen offset:3072 lds
  s_waitcnt vmcnt(29)
  ds_read_b64_tr_b16 a[168:169], v236 offset:12288
  ds_read_b64_tr_b16 a[170:171], v236 offset:14336
  ds_read_b64_tr_b16 a[172:173], v237 offset:12288
  ds_read_b64_tr_b16 a[174:175], v237 offset:14336
  ds_read_b64_tr_b16 a[176:177], v238 offset:12288
  ds_read_b64_tr_b16 a[178:179], v238 offset:14336
  ds_read_b64_tr_b16 a[180:181], v239 offset:12288
  ds_read_b64_tr_b16 a[182:183], v239 offset:14336
  s_waitcnt lgkmcnt(8)
  s_add_u32 m0, s89, 8192
  s_nop 0
  buffer_load_dwordx4 v8, s[68:71], s87 offen offset:0 lds
  buffer_load_dwordx4 v9, s[68:71], s87 offen offset:1024 lds
  buffer_load_dwordx4 v10, s[68:71], s87 offen offset:2048 lds
  buffer_load_dwordx4 v11, s[68:71], s87 offen offset:3072 lds
  s_xor_b32 s39, s28, 0
  s_mul_i32 s39, s39, 28672
  v_add_u32 v248, s39, v1
  s_xor_b32 s39, s28, 1
  s_mul_i32 s39, s39, 28672
  v_add_u32 v249, s39, v1
  s_xor_b32 s39, s28, 2
  s_mul_i32 s39, s39, 28672
  v_add_u32 v250, s39, v1
  s_xor_b32 s39, s28, 3
  s_mul_i32 s39, s39, 28672
  v_add_u32 v251, s39, v1
  v_and_b32 v252, 15, v0
  v_lshlrev_b32 v252, 11, v252
  v_lshrrev_b32 v253, 4, v0
  v_lshl_add_u32 v252, v253, 3, v252
  v_mov_b32 v253, s101
  v_xor_b32 v244, 4096, v253
  s_waitcnt vmcnt(29)
  ds_read_b64_tr_b16 a[184:185], v236 offset:16384
  ds_read_b64_tr_b16 a[186:187], v236 offset:18432
  ds_read_b64_tr_b16 a[188:189], v237 offset:16384
  ds_read_b64_tr_b16 a[190:191], v237 offset:18432
  ds_read_b64_tr_b16 a[192:193], v238 offset:16384
  ds_read_b64_tr_b16 a[194:195], v238 offset:18432
  ds_read_b64_tr_b16 a[196:197], v239 offset:16384
  ds_read_b64_tr_b16 a[198:199], v239 offset:18432
  s_waitcnt vmcnt(25)
  ds_read_b64_tr_b16 a[200:201], v236 offset:20480
  ds_read_b64_tr_b16 a[202:203], v236 offset:22528
  ds_read_b64_tr_b16 a[204:205], v237 offset:20480
  ds_read_b64_tr_b16 a[206:207], v237 offset:22528
  ds_read_b64_tr_b16 a[208:209], v238 offset:20480
  ds_read_b64_tr_b16 a[210:211], v238 offset:22528
  ds_read_b64_tr_b16 a[212:213], v239 offset:20480
  ds_read_b64_tr_b16 a[214:215], v239 offset:22528
  s_waitcnt vmcnt(21)
  ds_read_b64_tr_b16 a[216:217], v236 offset:24576
  ds_read_b64_tr_b16 a[218:219], v236 offset:26624
  ds_read_b64_tr_b16 a[220:221], v237 offset:24576
  ds_read_b64_tr_b16 a[222:223], v237 offset:26624
  ds_read_b64_tr_b16 a[224:225], v238 offset:24576
  ds_read_b64_tr_b16 a[226:227], v238 offset:26624
  ds_read_b64_tr_b16 a[228:229], v239 offset:24576
  ds_read_b64_tr_b16 a[230:231], v239 offset:26624
  s_waitcnt vmcnt(17)
  ds_read_b64_tr_b16 a[232:233], v232 offset:0
  ds_read_b64_tr_b16 a[234:235], v232 offset:2048
  ds_read_b64_tr_b16 a[236:237], v233 offset:0
  ds_read_b64_tr_b16 a[238:239], v233 offset:2048
  ds_read_b64_tr_b16 a[240:241], v234 offset:0
  ds_read_b64_tr_b16 a[242:243], v234 offset:2048
  ds_read_b64_tr_b16 a[244:245], v235 offset:0
  ds_read_b64_tr_b16 a[246:247], v235 offset:2048
  s_waitcnt vmcnt(13)
  ds_read_b64_tr_b16 v[128:129], v232 offset:4096
  ds_read_b64_tr_b16 v[130:131], v232 offset:6144
  ds_read_b64_tr_b16 v[132:133], v233 offset:4096
  ds_read_b64_tr_b16 v[134:135], v233 offset:6144
  ds_read_b64_tr_b16 v[136:137], v234 offset:4096
  ds_read_b64_tr_b16 v[138:139], v234 offset:6144
  ds_read_b64_tr_b16 v[140:141], v235 offset:4096
  ds_read_b64_tr_b16 v[142:143], v235 offset:6144
  s_waitcnt vmcnt(9)
  ds_read_b64_tr_b16 v[144:145], v236 offset:0
  ds_read_b64_tr_b16 v[146:147], v236 offset:2048
  ds_read_b64_tr_b16 v[148:149], v237 offset:0
  ds_read_b64_tr_b16 v[150:151], v237 offset:2048
  ds_read_b64_tr_b16 v[152:153], v238 offset:0
  ds_read_b64_tr_b16 v[154:155], v238 offset:2048
  ds_read_b64_tr_b16 v[156:157], v239 offset:0
  ds_read_b64_tr_b16 v[158:159], v239 offset:2048
  s_waitcnt vmcnt(8)
  s_mov_b32 s38, 0
  L_poll1:
  v_cmp_ne_u32 vcc, 1, v247
  s_nop 1
  s_cmp_eq_u64 vcc, 0
  s_cbranch_scc1 L_ready1
  s_add_u32 s38, s38, 1
  s_cmp_ge_u32 s38, 0x40000
  s_cbranch_scc1 L_ready1
  global_load_dword v247, v246, s[66:67] sc1
  s_waitcnt vmcnt(0)
  s_branch L_poll1
  L_ready1:
  s_add_u32 s33, s8, s52
  s_nop 0
  buffer_load_dwordx4 a[0:3], v1, s[72:75], s33 offen offset:0 sc1
  s_add_u32 s34, s8, s53
  s_nop 0
  buffer_load_dwordx4 a[28:31], v1, s[72:75], s34 offen offset:0 sc1
  buffer_load_dwordx4 a[4:7], v1, s[72:75], s33 offen offset:1024 sc1
  buffer_load_dwordx4 a[32:35], v1, s[72:75], s34 offen offset:1024 sc1
  buffer_load_dwordx4 a[8:11], v1, s[72:75], s33 offen offset:2048 sc1
  buffer_load_dwordx4 a[36:39], v1, s[72:75], s34 offen offset:2048 sc1
  buffer_load_dwordx4 a[12:15], v1, s[72:75], s33 offen offset:3072 sc1
  buffer_load_dwordx4 a[40:43], v1, s[72:75], s34 offen offset:3072 sc1
  buffer_load_dwordx4 a[16:19], v240, s[72:75], s33 offen offset:0 sc1
  buffer_load_dwordx4 a[44:47], v240, s[72:75], s34 offen offset:0 sc1
  buffer_load_dwordx4 a[20:23], v240, s[72:75], s33 offen offset:1024 sc1
  buffer_load_dwordx4 a[48:51], v240, s[72:75], s34 offen offset:1024 sc1
  buffer_load_dwordx4 a[24:27], v240, s[72:75], s33 offen offset:2048 sc1
  buffer_load_dwordx4 a[52:55], v240, s[72:75], s34 offen offset:2048 sc1
  s_waitcnt vmcnt(18)
  ds_read_b64_tr_b16 v[160:161], v236 offset:4096
  ds_read_b64_tr_b16 v[162:163], v236 offset:6144
  ds_read_b64_tr_b16 v[164:165], v237 offset:4096
  ds_read_b64_tr_b16 v[166:167], v237 offset:6144
  ds_read_b64_tr_b16 v[168:169], v238 offset:4096
  ds_read_b64_tr_b16 v[170:171], v238 offset:6144
  ds_read_b64_tr_b16 v[172:173], v239 offset:4096
  ds_read_b64_tr_b16 v[174:175], v239 offset:6144
  s_waitcnt vmcnt(14)
  ds_read_b64_tr_b16 v[176:177], v236 offset:8192
  ds_read_b64_tr_b16 v[178:179], v236 offset:10240
  ds_read_b64_tr_b16 v[180:181], v237 offset:8192
  ds_read_b64_tr_b16 v[182:183], v237 offset:10240
  ds_read_b64_tr_b16 v[184:185], v238 offset:8192
  ds_read_b64_tr_b16 v[186:187], v238 offset:10240
  ds_read_b64_tr_b16 v[188:189], v239 offset:8192
  ds_read_b64_tr_b16 v[190:191], v239 offset:10240
  s_waitcnt vmcnt(12) lgkmcnt(0)
  v_mfma_f32_16x16x32_bf16 v[16:19], a[56:59], a[0:3], 0
  v_mfma_f32_16x16x32_bf16 v[16:19], a[72:75], a[28:31], v[16:19]
  v_mfma_f32_16x16x32_bf16 v[20:23], a[60:63], a[0:3], 0
  v_mfma_f32_16x16x32_bf16 v[20:23], a[76:79], a[28:31], v[20:23]
  v_mfma_f32_16x16x32_bf16 v[24:27], a[64:67], a[0:3], 0
  v_mfma_f32_16x16x32_bf16 v[24:27], a[80:83], a[28:31], v[24:27]
  v_mfma_f32_16x16x32_bf16 v[28:31], a[68:71], a[0:3], 0
  v_mfma_f32_16x16x32_bf16 v[28:31], a[84:87], a[28:31], v[28:31]
  s_waitcnt vmcnt(10)
  v_mfma_f32_16x16x32_bf16 v[32:35], a[56:59], a[4:7], 0
  s_add_u32 s33, s8, s54
  v_mfma_f32_16x16x32_bf16 v[32:35], a[72:75], a[32:35], v[32:35]
  buffer_load_dwordx4 a[0:3], v1, s[72:75], s33 offen offset:0 sc1
  v_mfma_f32_16x16x32_bf16 v[36:39], a[60:63], a[4:7], 0
  s_add_u32 s34, s8, s55
  v_mfma_f32_16x16x32_bf16 v[36:39], a[76:79], a[32:35], v[36:39]
  buffer_load_dwordx4 a[28:31], v1, s[72:75], s34 offen offset:0 sc1
  v_mfma_f32_16x16x32_bf16 v[40:43], a[64:67], a[4:7], 0
  v_mfma_f32_16x16x32_bf16 v[40:43], a[80:83], a[32:35], v[40:43]
  v_mfma_f32_16x16x32_bf16 v[44:47], a[68:71], a[4:7], 0
  v_mfma_f32_16x16x32_bf16 v[44:47], a[84:87], a[32:35], v[44:47]
  s_waitcnt vmcnt(10)
  v_mfma_f32_16x16x32_bf16 v[48:51], a[56:59], a[8:11], 0
  v_mfma_f32_16x16x32_bf16 v[48:51], a[72:75], a[36:39], v[48:51]
  buffer_load_dwordx4 a[4:7], v1, s[72:75], s33 offen offset:1024 sc1
  v_mfma_f32_16x16x32_bf16 v[52:55], a[60:63], a[8:11], 0
  v_mfma_f32_16x16x32_bf16 v[52:55], a[76:79], a[36:39], v[52:55]
  buffer_load_dwordx4 a[32:35], v1, s[72:75], s34 offen offset:1024 sc1
  v_mfma_f32_16x16x32_bf16 v[56:59], a[64:67], a[8:11], 0
  v_mfma_f32_16x16x32_bf16 v[56:59], a[80:83], a[36:39], v[56:59]
  v_mfma_f32_16x16x32_bf16 v[60:63], a[68:71], a[8:11], 0
  v_mfma_f32_16x16x32_bf16 v[60:63], a[84:87], a[36:39], v[60:63]
  s_waitcnt vmcnt(10)
  v_mfma_f32_16x16x32_bf16 v[64:67], a[56:59], a[12:15], 0
  v_mfma_f32_16x16x32_bf16 v[64:67], a[72:75], a[40:43], v[64:67]
  buffer_load_dwordx4 a[8:11], v1, s[72:75], s33 offen offset:2048 sc1
  v_mfma_f32_16x16x32_bf16 v[68:71], a[60:63], a[12:15], 0
  v_mfma_f32_16x16x32_bf16 v[68:71], a[76:79], a[40:43], v[68:71]
  buffer_load_dwordx4 a[36:39], v1, s[72:75], s34 offen offset:2048 sc1
  v_mfma_f32_16x16x32_bf16 v[72:75], a[64:67], a[12:15], 0
  v_mfma_f32_16x16x32_bf16 v[72:75], a[80:83], a[40:43], v[72:75]
  v_mfma_f32_16x16x32_bf16 v[76:79], a[68:71], a[12:15], 0
  v_mfma_f32_16x16x32_bf16 v[76:79], a[84:87], a[40:43], v[76:79]
  s_waitcnt vmcnt(10)
  v_mfma_f32_16x16x32_bf16 v[80:83], a[56:59], a[16:19], 0
  v_mfma_f32_16x16x32_bf16 v[80:83], a[72:75], a[44:47], v[80:83]
  buffer_load_dwordx4 a[12:15], v1, s[72:75], s33 offen offset:3072 sc1
  v_mfma_f32_16x16x32_bf16 v[84:87], a[60:63], a[16:19], 0
  v_mfma_f32_16x16x32_bf16 v[84:87], a[76:79], a[44:47], v[84:87]
  buffer_load_dwordx4 a[40:43], v1, s[72:75], s34 offen offset:3072 sc1
  v_mfma_f32_16x16x32_bf16 v[88:91], a[64:67], a[16:19], 0
  v_mfma_f32_16x16x32_bf16 v[88:91], a[80:83], a[44:47], v[88:91]
  v_mfma_f32_16x16x32_bf16 v[92:95], a[68:71], a[16:19], 0
  v_mfma_f32_16x16x32_bf16 v[92:95], a[84:87], a[44:47], v[92:95]
  s_waitcnt vmcnt(10)
  v_mfma_f32_16x16x32_bf16 v[96:99], a[56:59], a[20:23], 0
  v_mfma_f32_16x16x32_bf16 v[96:99], a[72:75], a[48:51], v[96:99]
  buffer_load_dwordx4 a[16:19], v240, s[72:75], s33 offen offset:0 sc1
  v_mfma_f32_16x16x32_bf16 v[100:103], a[60:63], a[20:23], 0
  v_mfma_f32_16x16x32_bf16 v[100:103], a[76:79], a[48:51], v[100:103]
  buffer_load_dwordx4 a[44:47], v240, s[72:75], s34 offen offset:0 sc1
  v_mfma_f32_16x16x32_bf16 v[104:107], a[64:67], a[20:23], 0
  v_mfma_f32_16x16x32_bf16 v[104:107], a[80:83], a[48:51], v[104:107]
  v_mfma_f32_16x16x32_bf16 v[108:111], a[68:71], a[20:23], 0
  v_mfma_f32_16x16x32_bf16 v[108:111], a[84:87], a[48:51], v[108:111]
  s_waitcnt vmcnt(10)
  v_mfma_f32_16x16x32_bf16 v[112:115], a[56:59], a[24:27], 0
  v_mfma_f32_16x16x32_bf16 v[112:115], a[72:75], a[52:55], v[112:115]
  buffer_load_dwordx4 a[20:23], v240, s[72:75], s33 offen offset:1024 sc1
  v_mfma_f32_16x16x32_bf16 v[116:119], a[60:63], a[24:27], 0
  v_mfma_f32_16x16x32_bf16 v[116:119], a[76:79], a[52:55], v[116:119]
  buffer_load_dwordx4 a[48:51], v240, s[72:75], s34 offen offset:1024 sc1
  v_mfma_f32_16x16x32_bf16 v[120:123], a[64:67], a[24:27], 0
  v_mfma_f32_16x16x32_bf16 v[120:123], a[80:83], a[52:55], v[120:123]
  v_mfma_f32_16x16x32_bf16 v[124:127], a[68:71], a[24:27], 0
  v_mfma_f32_16x16x32_bf16 v[124:127], a[84:87], a[52:55], v[124:127]
  s_waitcnt vmcnt(10)
  v_mfma_f32_16x16x32_bf16 v[16:19], a[88:91], a[0:3], v[16:19]
  v_mfma_f32_16x16x32_bf16 v[16:19], a[104:107], a[28:31], v[16:19]
  buffer_load_dwordx4 a[24:27], v240, s[72:75], s33 offen offset:2048 sc1
  v_mfma_f32_16x16x32_bf16 v[20:23], a[92:95], a[0:3], v[20:23]
  v_mfma_f32_16x16x32_bf16 v[20:23], a[108:111], a[28:31], v[20:23]
  buffer_load_dwordx4 a[52:55], v240, s[72:75], s34 offen offset:2048 sc1
  v_mfma_f32_16x16x32_bf16 v[24:27], a[96:99], a[0:3], v[24:27]
  v_mfma_f32_16x16x32_bf16 v[24:27], a[112:115], a[28:31], v[24:27]
  v_mfma_f32_16x16x32_bf16 v[28:31], a[100:103], a[0:3], v[28:31]
  v_mfma_f32_16x16x32_bf16 v[28:31], a[116:119], a[28:31], v[28:31]
  s_waitcnt vmcnt(10)
  v_mfma_f32_16x16x32_bf16 v[32:35], a[88:91], a[4:7], v[32:35]
  s_add_u32 s33, s8, s56
  v_mfma_f32_16x16x32_bf16 v[32:35], a[104:107], a[32:35], v[32:35]
  buffer_load_dwordx4 a[0:3], v1, s[72:75], s33 offen offset:0 sc1
  v_mfma_f32_16x16x32_bf16 v[36:39], a[92:95], a[4:7], v[36:39]
  s_add_u32 s34, s8, s57
  v_mfma_f32_16x16x32_bf16 v[36:39], a[108:111], a[32:35], v[36:39]
  buffer_load_dwordx4 a[28:31], v1, s[72:75], s34 offen offset:0 sc1
  v_mfma_f32_16x16x32_bf16 v[40:43], a[96:99], a[4:7], v[40:43]
  v_mfma_f32_16x16x32_bf16 v[40:43], a[112:115], a[32:35], v[40:43]
  v_mfma_f32_16x16x32_bf16 v[44:47], a[100:103], a[4:7], v[44:47]
  v_mfma_f32_16x16x32_bf16 v[44:47], a[116:119], a[32:35], v[44:47]
  s_waitcnt vmcnt(10)
  v_mfma_f32_16x16x32_bf16 v[48:51], a[88:91], a[8:11], v[48:51]
  v_mfma_f32_16x16x32_bf16 v[48:51], a[104:107], a[36:39], v[48:51]
  buffer_load_dwordx4 a[4:7], v1, s[72:75], s33 offen offset:1024 sc1
  v_mfma_f32_16x16x32_bf16 v[52:55], a[92:95], a[8:11], v[52:55]
  v_mfma_f32_16x16x32_bf16 v[52:55], a[108:111], a[36:39], v[52:55]
  buffer_load_dwordx4 a[32:35], v1, s[72:75], s34 offen offset:1024 sc1
  v_mfma_f32_16x16x32_bf16 v[56:59], a[96:99], a[8:11], v[56:59]
  v_mfma_f32_16x16x32_bf16 v[56:59], a[112:115], a[36:39], v[56:59]
  v_mfma_f32_16x16x32_bf16 v[60:63], a[100:103], a[8:11], v[60:63]
  v_mfma_f32_16x16x32_bf16 v[60:63], a[116:119], a[36:39], v[60:63]
  s_waitcnt vmcnt(10)
  v_mfma_f32_16x16x32_bf16 v[64:67], a[88:91], a[12:15], v[64:67]
  v_mfma_f32_16x16x32_bf16 v[64:67], a[104:107], a[40:43], v[64:67]
  buffer_load_dwordx4 a[8:11], v1, s[72:75], s33 offen offset:2048 sc1
  v_mfma_f32_16x16x32_bf16 v[68:71], a[92:95], a[12:15], v[68:71]
  v_mfma_f32_16x16x32_bf16 v[68:71], a[108:111], a[40:43], v[68:71]
  buffer_load_dwordx4 a[36:39], v1, s[72:75], s34 offen offset:2048 sc1
  v_mfma_f32_16x16x32_bf16 v[72:75], a[96:99], a[12:15], v[72:75]
  v_mfma_f32_16x16x32_bf16 v[72:75], a[112:115], a[40:43], v[72:75]
  v_mfma_f32_16x16x32_bf16 v[76:79], a[100:103], a[12:15], v[76:79]
  v_mfma_f32_16x16x32_bf16 v[76:79], a[116:119], a[40:43], v[76:79]
  s_waitcnt vmcnt(10)
  v_mfma_f32_16x16x32_bf16 v[80:83], a[88:91], a[16:19], v[80:83]
  v_mfma_f32_16x16x32_bf16 v[80:83], a[104:107], a[44:47], v[80:83]
  buffer_load_dwordx4 a[12:15], v1, s[72:75], s33 offen offset:3072 sc1
  v_mfma_f32_16x16x32_bf16 v[84:87], a[92:95], a[16:19], v[84:87]
  v_mfma_f32_16x16x32_bf16 v[84:87], a[108:111], a[44:47], v[84:87]
  buffer_load_dwordx4 a[40:43], v1, s[72:75], s34 offen offset:3072 sc1
  v_mfma_f32_16x16x32_bf16 v[88:91], a[96:99], a[16:19], v[88:91]
  v_mfma_f32_16x16x32_bf16 v[88:91], a[112:115], a[44:47], v[88:91]
  v_mfma_f32_16x16x32_bf16 v[92:95], a[100:103], a[16:19], v[92:95]
  v_mfma_f32_16x16x32_bf16 v[92:95], a[116:119], a[44:47], v[92:95]
  s_waitcnt vmcnt(10)
  v_mfma_f32_16x16x32_bf16 v[96:99], a[88:91], a[20:23], v[96:99]
  v_mfma_f32_16x16x32_bf16 v[96:99], a[104:107], a[48:51], v[96:99]
  buffer_load_dwordx4 a[16:19], v240, s[72:75], s33 offen offset:0 sc1
  v_mfma_f32_16x16x32_bf16 v[100:103], a[92:95], a[20:23], v[100:103]
  v_mfma_f32_16x16x32_bf16 v[100:103], a[108:111], a[48:51], v[100:103]
  buffer_load_dwordx4 a[44:47], v240, s[72:75], s34 offen offset:0 sc1
  v_mfma_f32_16x16x32_bf16 v[104:107], a[96:99], a[20:23], v[104:107]
  v_mfma_f32_16x16x32_bf16 v[104:107], a[112:115], a[48:51], v[104:107]
  v_mfma_f32_16x16x32_bf16 v[108:111], a[100:103], a[20:23], v[108:111]
  v_mfma_f32_16x16x32_bf16 v[108:111], a[116:119], a[48:51], v[108:111]
  s_waitcnt vmcnt(10)
  v_mfma_f32_16x16x32_bf16 v[112:115], a[88:91], a[24:27], v[112:115]
  v_mfma_f32_16x16x32_bf16 v[112:115], a[104:107], a[52:55], v[112:115]
  buffer_load_dwordx4 a[20:23], v240, s[72:75], s33 offen offset:1024 sc1
  v_mfma_f32_16x16x32_bf16 v[116:119], a[92:95], a[24:27], v[116:119]
  v_mfma_f32_16x16x32_bf16 v[116:119], a[108:111], a[52:55], v[116:119]
  buffer_load_dwordx4 a[48:51], v240, s[72:75], s34 offen offset:1024 sc1
  v_mfma_f32_16x16x32_bf16 v[120:123], a[96:99], a[24:27], v[120:123]
  v_mfma_f32_16x16x32_bf16 v[120:123], a[112:115], a[52:55], v[120:123]
  v_mfma_f32_16x16x32_bf16 v[124:127], a[100:103], a[24:27], v[124:127]
  v_mfma_f32_16x16x32_bf16 v[124:127], a[116:119], a[52:55], v[124:127]
  s_waitcnt vmcnt(10)
  v_mfma_f32_16x16x32_bf16 v[16:19], a[120:123], a[0:3], v[16:19]
  v_mfma_f32_16x16x32_bf16 v[16:19], a[136:139], a[28:31], v[16:19]
  buffer_load_dwordx4 a[24:27], v240, s[72:75], s33 offen offset:2048 sc1
  v_mfma_f32_16x16x32_bf16 v[20:23], a[124:127], a[0:3], v[20:23]
  v_mfma_f32_16x16x32_bf16 v[20:23], a[140:143], a[28:31], v[20:23]
  buffer_load_dwordx4 a[52:55], v240, s[72:75], s34 offen offset:2048 sc1
  v_mfma_f32_16x16x32_bf16 v[24:27], a[128:131], a[0:3], v[24:27]
  v_mfma_f32_16x16x32_bf16 v[24:27], a[144:147], a[28:31], v[24:27]
  v_mfma_f32_16x16x32_bf16 v[28:31], a[132:135], a[0:3], v[28:31]
  v_mfma_f32_16x16x32_bf16 v[28:31], a[148:151], a[28:31], v[28:31]
  s_waitcnt vmcnt(10)
  v_mfma_f32_16x16x32_bf16 v[32:35], a[120:123], a[4:7], v[32:35]
  s_add_u32 s33, s8, s58
  v_mfma_f32_16x16x32_bf16 v[32:35], a[136:139], a[32:35], v[32:35]
  buffer_load_dwordx4 a[0:3], v1, s[72:75], s33 offen offset:0 sc1
  v_mfma_f32_16x16x32_bf16 v[36:39], a[124:127], a[4:7], v[36:39]
  s_add_u32 s34, s8, s59
  v_mfma_f32_16x16x32_bf16 v[36:39], a[140:143], a[32:35], v[36:39]
  buffer_load_dwordx4 a[28:31], v1, s[72:75], s34 offen offset:0 sc1
  v_mfma_f32_16x16x32_bf16 v[40:43], a[128:131], a[4:7], v[40:43]
  v_mfma_f32_16x16x32_bf16 v[40:43], a[144:147], a[32:35], v[40:43]
  v_mfma_f32_16x16x32_bf16 v[44:47], a[132:135], a[4:7], v[44:47]
  v_mfma_f32_16x16x32_bf16 v[44:47], a[148:151], a[32:35], v[44:47]
  s_waitcnt vmcnt(10)
  v_mfma_f32_16x16x32_bf16 v[48:51], a[120:123], a[8:11], v[48:51]
  v_mfma_f32_16x16x32_bf16 v[48:51], a[136:139], a[36:39], v[48:51]
  buffer_load_dwordx4 a[4:7], v1, s[72:75], s33 offen offset:1024 sc1
  v_mfma_f32_16x16x32_bf16 v[52:55], a[124:127], a[8:11], v[52:55]
  v_mfma_f32_16x16x32_bf16 v[52:55], a[140:143], a[36:39], v[52:55]
  buffer_load_dwordx4 a[32:35], v1, s[72:75], s34 offen offset:1024 sc1
  v_mfma_f32_16x16x32_bf16 v[56:59], a[128:131], a[8:11], v[56:59]
  v_mfma_f32_16x16x32_bf16 v[56:59], a[144:147], a[36:39], v[56:59]
  v_mfma_f32_16x16x32_bf16 v[60:63], a[132:135], a[8:11], v[60:63]
  v_mfma_f32_16x16x32_bf16 v[60:63], a[148:151], a[36:39], v[60:63]
  s_waitcnt vmcnt(10)
  v_mfma_f32_16x16x32_bf16 v[64:67], a[120:123], a[12:15], v[64:67]
  v_mfma_f32_16x16x32_bf16 v[64:67], a[136:139], a[40:43], v[64:67]
  buffer_load_dwordx4 a[8:11], v1, s[72:75], s33 offen offset:2048 sc1
  v_mfma_f32_16x16x32_bf16 v[68:71], a[124:127], a[12:15], v[68:71]
  v_mfma_f32_16x16x32_bf16 v[68:71], a[140:143], a[40:43], v[68:71]
  buffer_load_dwordx4 a[36:39], v1, s[72:75], s34 offen offset:2048 sc1
  v_mfma_f32_16x16x32_bf16 v[72:75], a[128:131], a[12:15], v[72:75]
  v_mfma_f32_16x16x32_bf16 v[72:75], a[144:147], a[40:43], v[72:75]
  v_mfma_f32_16x16x32_bf16 v[76:79], a[132:135], a[12:15], v[76:79]
  v_mfma_f32_16x16x32_bf16 v[76:79], a[148:151], a[40:43], v[76:79]
  s_waitcnt vmcnt(10)
  v_mfma_f32_16x16x32_bf16 v[80:83], a[120:123], a[16:19], v[80:83]
  v_mfma_f32_16x16x32_bf16 v[80:83], a[136:139], a[44:47], v[80:83]
  buffer_load_dwordx4 a[12:15], v1, s[72:75], s33 offen offset:3072 sc1
  v_mfma_f32_16x16x32_bf16 v[84:87], a[124:127], a[16:19], v[84:87]
  v_mfma_f32_16x16x32_bf16 v[84:87], a[140:143], a[44:47], v[84:87]
  buffer_load_dwordx4 a[40:43], v1, s[72:75], s34 offen offset:3072 sc1
  v_mfma_f32_16x16x32_bf16 v[88:91], a[128:131], a[16:19], v[88:91]
  v_mfma_f32_16x16x32_bf16 v[88:91], a[144:147], a[44:47], v[88:91]
  v_mfma_f32_16x16x32_bf16 v[92:95], a[132:135], a[16:19], v[92:95]
  v_mfma_f32_16x16x32_bf16 v[92:95], a[148:151], a[44:47], v[92:95]
  s_waitcnt vmcnt(10)
  v_mfma_f32_16x16x32_bf16 v[96:99], a[120:123], a[20:23], v[96:99]
  v_mfma_f32_16x16x32_bf16 v[96:99], a[136:139], a[48:51], v[96:99]
  buffer_load_dwordx4 a[16:19], v240, s[72:75], s33 offen offset:0 sc1
  v_mfma_f32_16x16x32_bf16 v[100:103], a[124:127], a[20:23], v[100:103]
  v_mfma_f32_16x16x32_bf16 v[100:103], a[140:143], a[48:51], v[100:103]
  buffer_load_dwordx4 a[44:47], v240, s[72:75], s34 offen offset:0 sc1
  v_mfma_f32_16x16x32_bf16 v[104:107], a[128:131], a[20:23], v[104:107]
  v_mfma_f32_16x16x32_bf16 v[104:107], a[144:147], a[48:51], v[104:107]
  v_mfma_f32_16x16x32_bf16 v[108:111], a[132:135], a[20:23], v[108:111]
  v_mfma_f32_16x16x32_bf16 v[108:111], a[148:151], a[48:51], v[108:111]
  s_waitcnt vmcnt(10)
  v_mfma_f32_16x16x32_bf16 v[112:115], a[120:123], a[24:27], v[112:115]
  v_mfma_f32_16x16x32_bf16 v[112:115], a[136:139], a[52:55], v[112:115]
  buffer_load_dwordx4 a[20:23], v240, s[72:75], s33 offen offset:1024 sc1
  v_mfma_f32_16x16x32_bf16 v[116:119], a[124:127], a[24:27], v[116:119]
  v_mfma_f32_16x16x32_bf16 v[116:119], a[140:143], a[52:55], v[116:119]
  buffer_load_dwordx4 a[48:51], v240, s[72:75], s34 offen offset:1024 sc1
  v_mfma_f32_16x16x32_bf16 v[120:123], a[128:131], a[24:27], v[120:123]
  v_mfma_f32_16x16x32_bf16 v[120:123], a[144:147], a[52:55], v[120:123]
  v_mfma_f32_16x16x32_bf16 v[124:127], a[132:135], a[24:27], v[124:127]
  v_mfma_f32_16x16x32_bf16 v[124:127], a[148:151], a[52:55], v[124:127]
  s_waitcnt vmcnt(10)
  v_mfma_f32_16x16x32_bf16 v[16:19], a[152:155], a[0:3], v[16:19]
  v_mfma_f32_16x16x32_bf16 v[16:19], a[168:171], a[28:31], v[16:19]
  buffer_load_dwordx4 a[24:27], v240, s[72:75], s33 offen offset:2048 sc1
  v_mfma_f32_16x16x32_bf16 v[20:23], a[156:159], a[0:3], v[20:23]
  v_mfma_f32_16x16x32_bf16 v[20:23], a[172:175], a[28:31], v[20:23]
  buffer_load_dwordx4 a[52:55], v240, s[72:75], s34 offen offset:2048 sc1
  v_mfma_f32_16x16x32_bf16 v[24:27], a[160:163], a[0:3], v[24:27]
  v_mfma_f32_16x16x32_bf16 v[24:27], a[176:179], a[28:31], v[24:27]
  v_mfma_f32_16x16x32_bf16 v[28:31], a[164:167], a[0:3], v[28:31]
  v_mfma_f32_16x16x32_bf16 v[28:31], a[180:183], a[28:31], v[28:31]
  s_waitcnt vmcnt(10)
  v_mfma_f32_16x16x32_bf16 v[32:35], a[152:155], a[4:7], v[32:35]
  s_add_u32 s33, s9, s52
  v_mfma_f32_16x16x32_bf16 v[32:35], a[168:171], a[32:35], v[32:35]
  buffer_load_dwordx4 a[0:3], v1, s[72:75], s33 offen offset:0 sc1
  v_mfma_f32_16x16x32_bf16 v[36:39], a[156:159], a[4:7], v[36:39]
  s_add_u32 s34, s9, s53
  v_mfma_f32_16x16x32_bf16 v[36:39], a[172:175], a[32:35], v[36:39]
  buffer_load_dwordx4 a[28:31], v1, s[72:75], s34 offen offset:0 sc1
  v_mfma_f32_16x16x32_bf16 v[40:43], a[160:163], a[4:7], v[40:43]
  v_mfma_f32_16x16x32_bf16 v[40:43], a[176:179], a[32:35], v[40:43]
  v_mfma_f32_16x16x32_bf16 v[44:47], a[164:167], a[4:7], v[44:47]
  v_mfma_f32_16x16x32_bf16 v[44:47], a[180:183], a[32:35], v[44:47]
  s_waitcnt vmcnt(10)
  v_mfma_f32_16x16x32_bf16 v[48:51], a[152:155], a[8:11], v[48:51]
  v_mfma_f32_16x16x32_bf16 v[48:51], a[168:171], a[36:39], v[48:51]
  buffer_load_dwordx4 a[4:7], v1, s[72:75], s33 offen offset:1024 sc1
  v_mfma_f32_16x16x32_bf16 v[52:55], a[156:159], a[8:11], v[52:55]
  v_mfma_f32_16x16x32_bf16 v[52:55], a[172:175], a[36:39], v[52:55]
  buffer_load_dwordx4 a[32:35], v1, s[72:75], s34 offen offset:1024 sc1
  v_mfma_f32_16x16x32_bf16 v[56:59], a[160:163], a[8:11], v[56:59]
  v_mfma_f32_16x16x32_bf16 v[56:59], a[176:179], a[36:39], v[56:59]
  v_mfma_f32_16x16x32_bf16 v[60:63], a[164:167], a[8:11], v[60:63]
  v_mfma_f32_16x16x32_bf16 v[60:63], a[180:183], a[36:39], v[60:63]
  s_waitcnt vmcnt(10)
  v_mfma_f32_16x16x32_bf16 v[64:67], a[152:155], a[12:15], v[64:67]
  v_mfma_f32_16x16x32_bf16 v[64:67], a[168:171], a[40:43], v[64:67]
  buffer_load_dwordx4 a[8:11], v1, s[72:75], s33 offen offset:2048 sc1
  v_mfma_f32_16x16x32_bf16 v[68:71], a[156:159], a[12:15], v[68:71]
  v_mfma_f32_16x16x32_bf16 v[68:71], a[172:175], a[40:43], v[68:71]
  buffer_load_dwordx4 a[36:39], v1, s[72:75], s34 offen offset:2048 sc1
  v_mfma_f32_16x16x32_bf16 v[72:75], a[160:163], a[12:15], v[72:75]
  v_mfma_f32_16x16x32_bf16 v[72:75], a[176:179], a[40:43], v[72:75]
  v_mfma_f32_16x16x32_bf16 v[76:79], a[164:167], a[12:15], v[76:79]
  v_mfma_f32_16x16x32_bf16 v[76:79], a[180:183], a[40:43], v[76:79]
  s_waitcnt vmcnt(10)
  v_mfma_f32_16x16x32_bf16 v[80:83], a[152:155], a[16:19], v[80:83]
  v_mfma_f32_16x16x32_bf16 v[80:83], a[168:171], a[44:47], v[80:83]
  buffer_load_dwordx4 a[12:15], v1, s[72:75], s33 offen offset:3072 sc1
  v_mfma_f32_16x16x32_bf16 v[84:87], a[156:159], a[16:19], v[84:87]
  v_mfma_f32_16x16x32_bf16 v[84:87], a[172:175], a[44:47], v[84:87]
  buffer_load_dwordx4 a[40:43], v1, s[72:75], s34 offen offset:3072 sc1
  v_mfma_f32_16x16x32_bf16 v[88:91], a[160:163], a[16:19], v[88:91]
  v_mfma_f32_16x16x32_bf16 v[88:91], a[176:179], a[44:47], v[88:91]
  v_mfma_f32_16x16x32_bf16 v[92:95], a[164:167], a[16:19], v[92:95]
  v_mfma_f32_16x16x32_bf16 v[92:95], a[180:183], a[44:47], v[92:95]
  s_waitcnt vmcnt(10)
  v_mfma_f32_16x16x32_bf16 v[96:99], a[152:155], a[20:23], v[96:99]
  v_mfma_f32_16x16x32_bf16 v[96:99], a[168:171], a[48:51], v[96:99]
  buffer_load_dwordx4 a[16:19], v240, s[72:75], s33 offen offset:0 sc1
  v_mfma_f32_16x16x32_bf16 v[100:103], a[156:159], a[20:23], v[100:103]
  v_mfma_f32_16x16x32_bf16 v[100:103], a[172:175], a[48:51], v[100:103]
  buffer_load_dwordx4 a[44:47], v240, s[72:75], s34 offen offset:0 sc1
  v_mfma_f32_16x16x32_bf16 v[104:107], a[160:163], a[20:23], v[104:107]
  v_mfma_f32_16x16x32_bf16 v[104:107], a[176:179], a[48:51], v[104:107]
  v_mfma_f32_16x16x32_bf16 v[108:111], a[164:167], a[20:23], v[108:111]
  v_mfma_f32_16x16x32_bf16 v[108:111], a[180:183], a[48:51], v[108:111]
  s_waitcnt vmcnt(10)
  v_mfma_f32_16x16x32_bf16 v[112:115], a[152:155], a[24:27], v[112:115]
  v_mfma_f32_16x16x32_bf16 v[112:115], a[168:171], a[52:55], v[112:115]
  buffer_load_dwordx4 a[20:23], v240, s[72:75], s33 offen offset:1024 sc1
  v_mfma_f32_16x16x32_bf16 v[116:119], a[156:159], a[24:27], v[116:119]
  v_mfma_f32_16x16x32_bf16 v[116:119], a[172:175], a[52:55], v[116:119]
  buffer_load_dwordx4 a[48:51], v240, s[72:75], s34 offen offset:1024 sc1
  v_mfma_f32_16x16x32_bf16 v[120:123], a[160:163], a[24:27], v[120:123]
  v_mfma_f32_16x16x32_bf16 v[120:123], a[176:179], a[52:55], v[120:123]
  v_mfma_f32_16x16x32_bf16 v[124:127], a[164:167], a[24:27], v[124:127]
  v_mfma_f32_16x16x32_bf16 v[124:127], a[180:183], a[52:55], v[124:127]
  s_waitcnt vmcnt(10)
  v_mfma_f32_16x16x32_bf16 v[16:19], a[184:187], a[0:3], v[16:19]
  v_mfma_f32_16x16x32_bf16 v[16:19], a[200:203], a[28:31], v[16:19]
  buffer_load_dwordx4 a[24:27], v240, s[72:75], s33 offen offset:2048 sc1
  v_mfma_f32_16x16x32_bf16 v[20:23], a[188:191], a[0:3], v[20:23]
  v_mfma_f32_16x16x32_bf16 v[20:23], a[204:207], a[28:31], v[20:23]
  buffer_load_dwordx4 a[52:55], v240, s[72:75], s34 offen offset:2048 sc1
  v_mfma_f32_16x16x32_bf16 v[24:27], a[192:195], a[0:3], v[24:27]
  v_mfma_f32_16x16x32_bf16 v[24:27], a[208:211], a[28:31], v[24:27]
  v_mfma_f32_16x16x32_bf16 v[28:31], a[196:199], a[0:3], v[28:31]
  v_mfma_f32_16x16x32_bf16 v[28:31], a[212:215], a[28:31], v[28:31]
  s_waitcnt vmcnt(10)
  v_mfma_f32_16x16x32_bf16 v[32:35], a[184:187], a[4:7], v[32:35]
  s_add_u32 s33, s9, s54
  v_mfma_f32_16x16x32_bf16 v[32:35], a[200:203], a[32:35], v[32:35]
  buffer_load_dwordx4 a[0:3], v1, s[72:75], s33 offen offset:0 sc1
  v_mfma_f32_16x16x32_bf16 v[36:39], a[188:191], a[4:7], v[36:39]
  s_add_u32 s34, s9, s55
  v_mfma_f32_16x16x32_bf16 v[36:39], a[204:207], a[32:35], v[36:39]
  buffer_load_dwordx4 a[28:31], v1, s[72:75], s34 offen offset:0 sc1
  v_mfma_f32_16x16x32_bf16 v[40:43], a[192:195], a[4:7], v[40:43]
  v_mfma_f32_16x16x32_bf16 v[40:43], a[208:211], a[32:35], v[40:43]
  v_mfma_f32_16x16x32_bf16 v[44:47], a[196:199], a[4:7], v[44:47]
  v_mfma_f32_16x16x32_bf16 v[44:47], a[212:215], a[32:35], v[44:47]
  s_waitcnt vmcnt(10)
  v_mfma_f32_16x16x32_bf16 v[48:51], a[184:187], a[8:11], v[48:51]
  v_mfma_f32_16x16x32_bf16 v[48:51], a[200:203], a[36:39], v[48:51]
  buffer_load_dwordx4 a[4:7], v1, s[72:75], s33 offen offset:1024 sc1
  v_mfma_f32_16x16x32_bf16 v[52:55], a[188:191], a[8:11], v[52:55]
  v_mfma_f32_16x16x32_bf16 v[52:55], a[204:207], a[36:39], v[52:55]
  buffer_load_dwordx4 a[32:35], v1, s[72:75], s34 offen offset:1024 sc1
  v_mfma_f32_16x16x32_bf16 v[56:59], a[192:195], a[8:11], v[56:59]
  v_mfma_f32_16x16x32_bf16 v[56:59], a[208:211], a[36:39], v[56:59]
  v_mfma_f32_16x16x32_bf16 v[60:63], a[196:199], a[8:11], v[60:63]
  v_mfma_f32_16x16x32_bf16 v[60:63], a[212:215], a[36:39], v[60:63]
  s_waitcnt vmcnt(10)
  v_mfma_f32_16x16x32_bf16 v[64:67], a[184:187], a[12:15], v[64:67]
  v_mfma_f32_16x16x32_bf16 v[64:67], a[200:203], a[40:43], v[64:67]
  buffer_load_dwordx4 a[8:11], v1, s[72:75], s33 offen offset:2048 sc1
  v_mfma_f32_16x16x32_bf16 v[68:71], a[188:191], a[12:15], v[68:71]
  v_mfma_f32_16x16x32_bf16 v[68:71], a[204:207], a[40:43], v[68:71]
  buffer_load_dwordx4 a[36:39], v1, s[72:75], s34 offen offset:2048 sc1
  v_mfma_f32_16x16x32_bf16 v[72:75], a[192:195], a[12:15], v[72:75]
  v_mfma_f32_16x16x32_bf16 v[72:75], a[208:211], a[40:43], v[72:75]
  v_mfma_f32_16x16x32_bf16 v[76:79], a[196:199], a[12:15], v[76:79]
  v_mfma_f32_16x16x32_bf16 v[76:79], a[212:215], a[40:43], v[76:79]
  s_waitcnt vmcnt(10)
  v_mfma_f32_16x16x32_bf16 v[80:83], a[184:187], a[16:19], v[80:83]
  v_mfma_f32_16x16x32_bf16 v[80:83], a[200:203], a[44:47], v[80:83]
  buffer_load_dwordx4 a[12:15], v1, s[72:75], s33 offen offset:3072 sc1
  v_mfma_f32_16x16x32_bf16 v[84:87], a[188:191], a[16:19], v[84:87]
  v_mfma_f32_16x16x32_bf16 v[84:87], a[204:207], a[44:47], v[84:87]
  buffer_load_dwordx4 a[40:43], v1, s[72:75], s34 offen offset:3072 sc1
  v_mfma_f32_16x16x32_bf16 v[88:91], a[192:195], a[16:19], v[88:91]
  v_mfma_f32_16x16x32_bf16 v[88:91], a[208:211], a[44:47], v[88:91]
  v_mfma_f32_16x16x32_bf16 v[92:95], a[196:199], a[16:19], v[92:95]
  v_mfma_f32_16x16x32_bf16 v[92:95], a[212:215], a[44:47], v[92:95]
  s_waitcnt vmcnt(10)
  v_mfma_f32_16x16x32_bf16 v[96:99], a[184:187], a[20:23], v[96:99]
  v_mfma_f32_16x16x32_bf16 v[96:99], a[200:203], a[48:51], v[96:99]
  buffer_load_dwordx4 a[16:19], v240, s[72:75], s33 offen offset:0 sc1
  v_mfma_f32_16x16x32_bf16 v[100:103], a[188:191], a[20:23], v[100:103]
  v_mfma_f32_16x16x32_bf16 v[100:103], a[204:207], a[48:51], v[100:103]
  buffer_load_dwordx4 a[44:47], v240, s[72:75], s34 offen offset:0 sc1
  v_mfma_f32_16x16x32_bf16 v[104:107], a[192:195], a[20:23], v[104:107]
  v_mfma_f32_16x16x32_bf16 v[104:107], a[208:211], a[48:51], v[104:107]
  v_mfma_f32_16x16x32_bf16 v[108:111], a[196:199], a[20:23], v[108:111]
  v_mfma_f32_16x16x32_bf16 v[108:111], a[212:215], a[48:51], v[108:111]
  s_waitcnt vmcnt(10)
  v_mfma_f32_16x16x32_bf16 v[112:115], a[184:187], a[24:27], v[112:115]
  v_mfma_f32_16x16x32_bf16 v[112:115], a[200:203], a[52:55], v[112:115]
  buffer_load_dwordx4 a[20:23], v240, s[72:75], s33 offen offset:1024 sc1
  v_mfma_f32_16x16x32_bf16 v[116:119], a[188:191], a[24:27], v[116:119]
  v_mfma_f32_16x16x32_bf16 v[116:119], a[204:207], a[52:55], v[116:119]
  buffer_load_dwordx4 a[48:51], v240, s[72:75], s34 offen offset:1024 sc1
  v_mfma_f32_16x16x32_bf16 v[120:123], a[192:195], a[24:27], v[120:123]
  v_mfma_f32_16x16x32_bf16 v[120:123], a[208:211], a[52:55], v[120:123]
  v_mfma_f32_16x16x32_bf16 v[124:127], a[196:199], a[24:27], v[124:127]
  v_mfma_f32_16x16x32_bf16 v[124:127], a[212:215], a[52:55], v[124:127]
  s_waitcnt vmcnt(10)
  v_mfma_f32_16x16x32_bf16 v[16:19], a[216:219], a[0:3], v[16:19]
  s_barrier
  v_mfma_f32_16x16x32_bf16 v[16:19], a[232:235], a[28:31], v[16:19]
  buffer_load_dwordx4 a[24:27], v240, s[72:75], s33 offen offset:2048 sc1
  v_mfma_f32_16x16x32_bf16 v[20:23], a[220:223], a[0:3], v[20:23]
  v_mfma_f32_16x16x32_bf16 v[20:23], a[236:239], a[28:31], v[20:23]
  buffer_load_dwordx4 a[52:55], v240, s[72:75], s34 offen offset:2048 sc1
  v_mfma_f32_16x16x32_bf16 v[24:27], a[224:227], a[0:3], v[24:27]
  v_mfma_f32_16x16x32_bf16 v[24:27], a[240:243], a[28:31], v[24:27]
  v_mfma_f32_16x16x32_bf16 v[28:31], a[228:231], a[0:3], v[28:31]
  v_mfma_f32_16x16x32_bf16 v[28:31], a[244:247], a[28:31], v[28:31]
  s_waitcnt vmcnt(10)
  v_mfma_f32_16x16x32_bf16 v[32:35], a[216:219], a[4:7], v[32:35]
  s_add_u32 s33, s9, s56
  v_mfma_f32_16x16x32_bf16 v[32:35], a[232:235], a[32:35], v[32:35]
  buffer_load_dwordx4 a[0:3], v1, s[72:75], s33 offen offset:0 sc1
  v_mfma_f32_16x16x32_bf16 v[36:39], a[220:223], a[4:7], v[36:39]
  s_add_u32 s34, s9, s57
  v_mfma_f32_16x16x32_bf16 v[36:39], a[236:239], a[32:35], v[36:39]
  buffer_load_dwordx4 a[28:31], v1, s[72:75], s34 offen offset:0 sc1
  v_mfma_f32_16x16x32_bf16 v[40:43], a[224:227], a[4:7], v[40:43]
  v_mfma_f32_16x16x32_bf16 v[40:43], a[240:243], a[32:35], v[40:43]
  v_mfma_f32_16x16x32_bf16 v[44:47], a[228:231], a[4:7], v[44:47]
  v_mfma_f32_16x16x32_bf16 v[44:47], a[244:247], a[32:35], v[44:47]
  s_waitcnt vmcnt(10)
  v_mfma_f32_16x16x32_bf16 v[48:51], a[216:219], a[8:11], v[48:51]
  v_mfma_f32_16x16x32_bf16 v[48:51], a[232:235], a[36:39], v[48:51]
  buffer_load_dwordx4 a[4:7], v1, s[72:75], s33 offen offset:1024 sc1
  v_mfma_f32_16x16x32_bf16 v[52:55], a[220:223], a[8:11], v[52:55]
  v_mfma_f32_16x16x32_bf16 v[52:55], a[236:239], a[36:39], v[52:55]
  buffer_load_dwordx4 a[32:35], v1, s[72:75], s34 offen offset:1024 sc1
  v_mfma_f32_16x16x32_bf16 v[56:59], a[224:227], a[8:11], v[56:59]
  v_mfma_f32_16x16x32_bf16 v[56:59], a[240:243], a[36:39], v[56:59]
  v_mfma_f32_16x16x32_bf16 v[60:63], a[228:231], a[8:11], v[60:63]
  v_mfma_f32_16x16x32_bf16 v[60:63], a[244:247], a[36:39], v[60:63]
  s_waitcnt vmcnt(10)
  v_mfma_f32_16x16x32_bf16 v[64:67], a[216:219], a[12:15], v[64:67]
  v_mfma_f32_16x16x32_bf16 v[64:67], a[232:235], a[40:43], v[64:67]
  buffer_load_dwordx4 a[8:11], v1, s[72:75], s33 offen offset:2048 sc1
  v_mfma_f32_16x16x32_bf16 v[68:71], a[220:223], a[12:15], v[68:71]
  v_mfma_f32_16x16x32_bf16 v[68:71], a[236:239], a[40:43], v[68:71]
  buffer_load_dwordx4 a[36:39], v1, s[72:75], s34 offen offset:2048 sc1
  v_mfma_f32_16x16x32_bf16 v[72:75], a[224:227], a[12:15], v[72:75]
  v_mfma_f32_16x16x32_bf16 v[72:75], a[240:243], a[40:43], v[72:75]
  v_mfma_f32_16x16x32_bf16 v[76:79], a[228:231], a[12:15], v[76:79]
  v_mfma_f32_16x16x32_bf16 v[76:79], a[244:247], a[40:43], v[76:79]
  s_waitcnt vmcnt(10)
  v_mfma_f32_16x16x32_bf16 v[80:83], a[216:219], a[16:19], v[80:83]
  v_mfma_f32_16x16x32_bf16 v[80:83], a[232:235], a[44:47], v[80:83]
  buffer_load_dwordx4 a[12:15], v1, s[72:75], s33 offen offset:3072 sc1
  v_mfma_f32_16x16x32_bf16 v[84:87], a[220:223], a[16:19], v[84:87]
  v_mfma_f32_16x16x32_bf16 v[84:87], a[236:239], a[44:47], v[84:87]
  buffer_load_dwordx4 a[40:43], v1, s[72:75], s34 offen offset:3072 sc1
  v_mfma_f32_16x16x32_bf16 v[88:91], a[224:227], a[16:19], v[88:91]
  v_mfma_f32_16x16x32_bf16 v[88:91], a[240:243], a[44:47], v[88:91]
  v_mfma_f32_16x16x32_bf16 v[92:95], a[228:231], a[16:19], v[92:95]
  v_mfma_f32_16x16x32_bf16 v[92:95], a[244:247], a[44:47], v[92:95]
  s_waitcnt vmcnt(10)
  v_mfma_f32_16x16x32_bf16 v[96:99], a[216:219], a[20:23], v[96:99]
  v_mfma_f32_16x16x32_bf16 v[96:99], a[232:235], a[48:51], v[96:99]
  buffer_load_dwordx4 a[16:19], v240, s[72:75], s33 offen offset:0 sc1
  v_mfma_f32_16x16x32_bf16 v[100:103], a[220:223], a[20:23], v[100:103]
  v_mfma_f32_16x16x32_bf16 v[100:103], a[236:239], a[48:51], v[100:103]
  buffer_load_dwordx4 a[44:47], v240, s[72:75], s34 offen offset:0 sc1
  v_mfma_f32_16x16x32_bf16 v[104:107], a[224:227], a[20:23], v[104:107]
  v_mfma_f32_16x16x32_bf16 v[104:107], a[240:243], a[48:51], v[104:107]
  v_mfma_f32_16x16x32_bf16 v[108:111], a[228:231], a[20:23], v[108:111]
  v_mfma_f32_16x16x32_bf16 v[108:111], a[244:247], a[48:51], v[108:111]
  s_waitcnt vmcnt(10)
  v_mfma_f32_16x16x32_bf16 v[112:115], a[216:219], a[24:27], v[112:115]
  v_mfma_f32_16x16x32_bf16 v[112:115], a[232:235], a[52:55], v[112:115]
  buffer_load_dwordx4 a[20:23], v240, s[72:75], s33 offen offset:1024 sc1
  v_mfma_f32_16x16x32_bf16 v[116:119], a[220:223], a[24:27], v[116:119]
  v_mfma_f32_16x16x32_bf16 v[116:119], a[236:239], a[52:55], v[116:119]
  buffer_load_dwordx4 a[48:51], v240, s[72:75], s34 offen offset:1024 sc1
  v_mfma_f32_16x16x32_bf16 v[120:123], a[224:227], a[24:27], v[120:123]
  v_mfma_f32_16x16x32_bf16 v[120:123], a[240:243], a[52:55], v[120:123]
  v_mfma_f32_16x16x32_bf16 v[124:127], a[228:231], a[24:27], v[124:127]
  v_mfma_f32_16x16x32_bf16 v[124:127], a[244:247], a[52:55], v[124:127]
  s_waitcnt vmcnt(10)
  v_mfma_f32_16x16x32_bf16 v[16:19], v[128:131], a[0:3], v[16:19]
  v_mfma_f32_16x16x32_bf16 v[16:19], v[144:147], a[28:31], v[16:19]
  buffer_load_dwordx4 a[24:27], v240, s[72:75], s33 offen offset:2048 sc1
  v_mfma_f32_16x16x32_bf16 v[20:23], v[132:135], a[0:3], v[20:23]
  v_mfma_f32_16x16x32_bf16 v[20:23], v[148:151], a[28:31], v[20:23]
  buffer_load_dwordx4 a[52:55], v240, s[72:75], s34 offen offset:2048 sc1
  v_mfma_f32_16x16x32_bf16 v[24:27], v[136:139], a[0:3], v[24:27]
  v_mfma_f32_16x16x32_bf16 v[24:27], v[152:155], a[28:31], v[24:27]
  v_mfma_f32_16x16x32_bf16 v[28:31], v[140:143], a[0:3], v[28:31]
  v_mfma_f32_16x16x32_bf16 v[28:31], v[156:159], a[28:31], v[28:31]
  s_waitcnt vmcnt(10)
  v_mfma_f32_16x16x32_bf16 v[32:35], v[128:131], a[4:7], v[32:35]
  s_add_u32 s33, s9, s58
  v_mfma_f32_16x16x32_bf16 v[32:35], v[144:147], a[32:35], v[32:35]
  buffer_load_dwordx4 a[0:3], v1, s[72:75], s33 offen offset:0 sc1
  v_mfma_f32_16x16x32_bf16 v[36:39], v[132:135], a[4:7], v[36:39]
  s_add_u32 s34, s9, s59
  v_mfma_f32_16x16x32_bf16 v[36:39], v[148:151], a[32:35], v[36:39]
  buffer_load_dwordx4 a[28:31], v1, s[72:75], s34 offen offset:0 sc1
  v_mfma_f32_16x16x32_bf16 v[40:43], v[136:139], a[4:7], v[40:43]
  v_mfma_f32_16x16x32_bf16 v[40:43], v[152:155], a[32:35], v[40:43]
  v_mfma_f32_16x16x32_bf16 v[44:47], v[140:143], a[4:7], v[44:47]
  v_mfma_f32_16x16x32_bf16 v[44:47], v[156:159], a[32:35], v[44:47]
  s_waitcnt vmcnt(10)
  v_mfma_f32_16x16x32_bf16 v[48:51], v[128:131], a[8:11], v[48:51]
  v_mfma_f32_16x16x32_bf16 v[48:51], v[144:147], a[36:39], v[48:51]
  buffer_load_dwordx4 a[4:7], v1, s[72:75], s33 offen offset:1024 sc1
  v_mfma_f32_16x16x32_bf16 v[52:55], v[132:135], a[8:11], v[52:55]
  v_mfma_f32_16x16x32_bf16 v[52:55], v[148:151], a[36:39], v[52:55]
  buffer_load_dwordx4 a[32:35], v1, s[72:75], s34 offen offset:1024 sc1
  v_mfma_f32_16x16x32_bf16 v[56:59], v[136:139], a[8:11], v[56:59]
  v_mfma_f32_16x16x32_bf16 v[56:59], v[152:155], a[36:39], v[56:59]
  v_mfma_f32_16x16x32_bf16 v[60:63], v[140:143], a[8:11], v[60:63]
  v_mfma_f32_16x16x32_bf16 v[60:63], v[156:159], a[36:39], v[60:63]
  s_waitcnt vmcnt(10)
  v_mfma_f32_16x16x32_bf16 v[64:67], v[128:131], a[12:15], v[64:67]
  v_mfma_f32_16x16x32_bf16 v[64:67], v[144:147], a[40:43], v[64:67]
  buffer_load_dwordx4 a[8:11], v1, s[72:75], s33 offen offset:2048 sc1
  v_mfma_f32_16x16x32_bf16 v[68:71], v[132:135], a[12:15], v[68:71]
  v_mfma_f32_16x16x32_bf16 v[68:71], v[148:151], a[40:43], v[68:71]
  buffer_load_dwordx4 a[36:39], v1, s[72:75], s34 offen offset:2048 sc1
  v_mfma_f32_16x16x32_bf16 v[72:75], v[136:139], a[12:15], v[72:75]
  v_mfma_f32_16x16x32_bf16 v[72:75], v[152:155], a[40:43], v[72:75]
  v_mfma_f32_16x16x32_bf16 v[76:79], v[140:143], a[12:15], v[76:79]
  v_mfma_f32_16x16x32_bf16 v[76:79], v[156:159], a[40:43], v[76:79]
  s_waitcnt vmcnt(10)
  v_mfma_f32_16x16x32_bf16 v[80:83], v[128:131], a[16:19], v[80:83]
  v_mfma_f32_16x16x32_bf16 v[80:83], v[144:147], a[44:47], v[80:83]
  buffer_load_dwordx4 a[12:15], v1, s[72:75], s33 offen offset:3072 sc1
  v_mfma_f32_16x16x32_bf16 v[84:87], v[132:135], a[16:19], v[84:87]
  v_mfma_f32_16x16x32_bf16 v[84:87], v[148:151], a[44:47], v[84:87]
  buffer_load_dwordx4 a[40:43], v1, s[72:75], s34 offen offset:3072 sc1
  v_mfma_f32_16x16x32_bf16 v[88:91], v[136:139], a[16:19], v[88:91]
  v_mfma_f32_16x16x32_bf16 v[88:91], v[152:155], a[44:47], v[88:91]
  v_mfma_f32_16x16x32_bf16 v[92:95], v[140:143], a[16:19], v[92:95]
  v_mfma_f32_16x16x32_bf16 v[92:95], v[156:159], a[44:47], v[92:95]
  s_waitcnt vmcnt(10)
  v_mfma_f32_16x16x32_bf16 v[96:99], v[128:131], a[20:23], v[96:99]
  v_mfma_f32_16x16x32_bf16 v[96:99], v[144:147], a[48:51], v[96:99]
  buffer_load_dwordx4 a[16:19], v240, s[72:75], s33 offen offset:0 sc1
  v_mfma_f32_16x16x32_bf16 v[100:103], v[132:135], a[20:23], v[100:103]
  v_mfma_f32_16x16x32_bf16 v[100:103], v[148:151], a[48:51], v[100:103]
  buffer_load_dwordx4 a[44:47], v240, s[72:75], s34 offen offset:0 sc1
  v_mfma_f32_16x16x32_bf16 v[104:107], v[136:139], a[20:23], v[104:107]
  v_mfma_f32_16x16x32_bf16 v[104:107], v[152:155], a[48:51], v[104:107]
  v_mfma_f32_16x16x32_bf16 v[108:111], v[140:143], a[20:23], v[108:111]
  v_mfma_f32_16x16x32_bf16 v[108:111], v[156:159], a[48:51], v[108:111]
  s_waitcnt vmcnt(10)
  v_mfma_f32_16x16x32_bf16 v[112:115], v[128:131], a[24:27], v[112:115]
  v_mfma_f32_16x16x32_bf16 v[112:115], v[144:147], a[52:55], v[112:115]
  buffer_load_dwordx4 a[20:23], v240, s[72:75], s33 offen offset:1024 sc1
  v_mfma_f32_16x16x32_bf16 v[116:119], v[132:135], a[24:27], v[116:119]
  v_mfma_f32_16x16x32_bf16 v[116:119], v[148:151], a[52:55], v[116:119]
  buffer_load_dwordx4 a[48:51], v240, s[72:75], s34 offen offset:1024 sc1
  v_mfma_f32_16x16x32_bf16 v[120:123], v[136:139], a[24:27], v[120:123]
  v_mfma_f32_16x16x32_bf16 v[120:123], v[152:155], a[52:55], v[120:123]
  v_mfma_f32_16x16x32_bf16 v[124:127], v[140:143], a[24:27], v[124:127]
  v_mfma_f32_16x16x32_bf16 v[124:127], v[156:159], a[52:55], v[124:127]
  s_waitcnt vmcnt(10)
  v_mfma_f32_16x16x32_bf16 v[16:19], v[160:163], a[0:3], v[16:19]
  v_mfma_f32_16x16x32_bf16 v[16:19], v[176:179], a[28:31], v[16:19]
  buffer_load_dwordx4 a[24:27], v240, s[72:75], s33 offen offset:2048 sc1
  v_mfma_f32_16x16x32_bf16 v[20:23], v[164:167], a[0:3], v[20:23]
  v_mfma_f32_16x16x32_bf16 v[20:23], v[180:183], a[28:31], v[20:23]
  buffer_load_dwordx4 a[52:55], v240, s[72:75], s34 offen offset:2048 sc1
  v_mfma_f32_16x16x32_bf16 v[24:27], v[168:171], a[0:3], v[24:27]
  v_mfma_f32_16x16x32_bf16 v[24:27], v[184:187], a[28:31], v[24:27]
  v_mfma_f32_16x16x32_bf16 v[28:31], v[172:175], a[0:3], v[28:31]
  v_mfma_f32_16x16x32_bf16 v[28:31], v[188:191], a[28:31], v[28:31]
  s_waitcnt vmcnt(10)
  v_mfma_f32_16x16x32_bf16 v[32:35], v[160:163], a[4:7], v[32:35]
  s_add_u32 s33, s10, s52
  v_mfma_f32_16x16x32_bf16 v[32:35], v[176:179], a[32:35], v[32:35]
  buffer_load_dwordx4 a[0:3], v1, s[72:75], s33 offen offset:0 sc1
  v_mfma_f32_16x16x32_bf16 v[36:39], v[164:167], a[4:7], v[36:39]
  s_add_u32 s34, s10, s53
  v_mfma_f32_16x16x32_bf16 v[36:39], v[180:183], a[32:35], v[36:39]
  buffer_load_dwordx4 a[28:31], v1, s[72:75], s34 offen offset:0 sc1
  v_mfma_f32_16x16x32_bf16 v[40:43], v[168:171], a[4:7], v[40:43]
  v_mfma_f32_16x16x32_bf16 v[40:43], v[184:187], a[32:35], v[40:43]
  v_mov_b32 v192, v16
  v_mov_b32 v193, v17
  v_mfma_f32_16x16x32_bf16 v[44:47], v[172:175], a[4:7], v[44:47]
  v_mfma_f32_16x16x32_bf16 v[44:47], v[188:191], a[32:35], v[44:47]
  s_waitcnt vmcnt(10)
  v_mov_b32 v194, v18
  v_mov_b32 v195, v19
  v_mfma_f32_16x16x32_bf16 v[48:51], v[160:163], a[8:11], v[48:51]
  ds_write_b128 v249, v[20:23] offset:7168
  v_mfma_f32_16x16x32_bf16 v[48:51], v[176:179], a[36:39], v[48:51]
  buffer_load_dwordx4 a[4:7], v1, s[72:75], s33 offen offset:1024 sc1
  v_mfma_f32_16x16x32_bf16 v[52:55], v[164:167], a[8:11], v[52:55]
  v_mfma_f32_16x16x32_bf16 v[52:55], v[180:183], a[36:39], v[52:55]
  buffer_load_dwordx4 a[32:35], v1, s[72:75], s34 offen offset:1024 sc1
  v_mfma_f32_16x16x32_bf16 v[56:59], v[168:171], a[8:11], v[56:59]
  ds_write_b128 v250, v[24:27] offset:14336
  v_mfma_f32_16x16x32_bf16 v[56:59], v[184:187], a[36:39], v[56:59]
  v_mov_b32 v196, v32
  v_mov_b32 v197, v33
  v_mfma_f32_16x16x32_bf16 v[60:63], v[172:175], a[8:11], v[60:63]
  v_mfma_f32_16x16x32_bf16 v[60:63], v[188:191], a[36:39], v[60:63]
  s_waitcnt vmcnt(10)
  v_mov_b32 v198, v34
  v_mov_b32 v199, v35
  v_mfma_f32_16x16x32_bf16 v[64:67], v[160:163], a[12:15], v[64:67]
  ds_write_b128 v251, v[28:31] offset:21504
  v_mfma_f32_16x16x32_bf16 v[64:67], v[176:179], a[40:43], v[64:67]
  buffer_load_dwordx4 a[8:11], v1, s[72:75], s33 offen offset:2048 sc1
  v_mfma_f32_16x16x32_bf16 v[68:71], v[164:167], a[12:15], v[68:71]
  v_mfma_f32_16x16x32_bf16 v[68:71], v[180:183], a[40:43], v[68:71]
  buffer_load_dwordx4 a[36:39], v1, s[72:75], s34 offen offset:2048 sc1
  v_mfma_f32_16x16x32_bf16 v[72:75], v[168:171], a[12:15], v[72:75]
  ds_write_b128 v249, v[36:39] offset:8192
  v_mfma_f32_16x16x32_bf16 v[72:75], v[184:187], a[40:43], v[72:75]
  v_mov_b32 v200, v48
  v_mov_b32 v201, v49
  v_mfma_f32_16x16x32_bf16 v[76:79], v[172:175], a[12:15], v[76:79]
  v_mfma_f32_16x16x32_bf16 v[76:79], v[188:191], a[40:43], v[76:79]
  s_waitcnt vmcnt(10)
  v_mov_b32 v202, v50
  v_mov_b32 v203, v51
  v_mfma_f32_16x16x32_bf16 v[80:83], v[160:163], a[16:19], v[80:83]
  ds_write_b128 v250, v[40:43] offset:15360
  v_mfma_f32_16x16x32_bf16 v[80:83], v[176:179], a[44:47], v[80:83]
  buffer_load_dwordx4 a[12:15], v1, s[72:75], s33 offen offset:3072 sc1
  v_mfma_f32_16x16x32_bf16 v[84:87], v[164:167], a[16:19], v[84:87]
  v_mfma_f32_16x16x32_bf16 v[84:87], v[180:183], a[44:47], v[84:87]
  buffer_load_dwordx4 a[40:43], v1, s[72:75], s34 offen offset:3072 sc1
  v_mfma_f32_16x16x32_bf16 v[88:91], v[168:171], a[16:19], v[88:91]
  ds_write_b128 v251, v[44:47] offset:22528
  v_mfma_f32_16x16x32_bf16 v[88:91], v[184:187], a[44:47], v[88:91]
  v_mov_b32 v204, v64
  v_mov_b32 v205, v65
  v_mfma_f32_16x16x32_bf16 v[92:95], v[172:175], a[16:19], v[92:95]
  v_mfma_f32_16x16x32_bf16 v[92:95], v[188:191], a[44:47], v[92:95]
  s_waitcnt vmcnt(10)
  v_mov_b32 v206, v66
  v_mov_b32 v207, v67
  v_mfma_f32_16x16x32_bf16 v[96:99], v[160:163], a[20:23], v[96:99]
  ds_write_b128 v249, v[52:55] offset:9216
  v_mfma_f32_16x16x32_bf16 v[96:99], v[176:179], a[48:51], v[96:99]
  buffer_load_dwordx4 a[16:19], v240, s[72:75], s33 offen offset:0 sc1
  v_mfma_f32_16x16x32_bf16 v[100:103], v[164:167], a[20:23], v[100:103]
  v_mfma_f32_16x16x32_bf16 v[100:103], v[180:183], a[48:51], v[100:103]
  buffer_load_dwordx4 a[44:47], v240, s[72:75], s34 offen offset:0 sc1
  v_mfma_f32_16x16x32_bf16 v[104:107], v[168:171], a[20:23], v[104:107]
  ds_write_b128 v250, v[56:59] offset:16384
  v_mfma_f32_16x16x32_bf16 v[104:107], v[184:187], a[48:51], v[104:107]
  v_mov_b32 v208, v80
  v_mov_b32 v209, v81
  v_mfma_f32_16x16x32_bf16 v[108:111], v[172:175], a[20:23], v[108:111]
  v_mfma_f32_16x16x32_bf16 v[108:111], v[188:191], a[48:51], v[108:111]
  s_waitcnt vmcnt(10)
  v_mov_b32 v210, v82
  v_mov_b32 v211, v83
  v_mfma_f32_16x16x32_bf16 v[112:115], v[160:163], a[24:27], v[112:115]
  ds_write_b128 v251, v[60:63] offset:23552
  v_mfma_f32_16x16x32_bf16 v[112:115], v[176:179], a[52:55], v[112:115]
  buffer_load_dwordx4 a[20:23], v240, s[72:75], s33 offen offset:1024 sc1
  v_mfma_f32_16x16x32_bf16 v[116:119], v[164:167], a[24:27], v[116:119]
  v_mfma_f32_16x16x32_bf16 v[116:119], v[180:183], a[52:55], v[116:119]
  buffer_load_dwordx4 a[48:51], v240, s[72:75], s34 offen offset:1024 sc1
  v_mfma_f32_16x16x32_bf16 v[120:123], v[168:171], a[24:27], v[120:123]
  ds_write_b128 v249, v[68:71] offset:10240
  v_mfma_f32_16x16x32_bf16 v[120:123], v[184:187], a[52:55], v[120:123]
  v_mov_b32 v212, v96
  v_mov_b32 v213, v97
  v_mfma_f32_16x16x32_bf16 v[124:127], v[172:175], a[24:27], v[124:127]
  v_mfma_f32_16x16x32_bf16 v[124:127], v[188:191], a[52:55], v[124:127]
  s_waitcnt vmcnt(10)
  v_mov_b32 v214, v98
  v_mov_b32 v215, v99
  v_mfma_f32_16x16x32_bf16 v[16:19], a[56:59], a[0:3], 0
  ds_write_b128 v250, v[72:75] offset:17408
  v_mfma_f32_16x16x32_bf16 v[16:19], a[72:75], a[28:31], v[16:19]
  buffer_load_dwordx4 a[24:27], v240, s[72:75], s33 offen offset:2048 sc1
  v_mfma_f32_16x16x32_bf16 v[20:23], a[60:63], a[0:3], 0
  v_mfma_f32_16x16x32_bf16 v[20:23], a[76:79], a[28:31], v[20:23]
  buffer_load_dwordx4 a[52:55], v240, s[72:75], s34 offen offset:2048 sc1
  v_mfma_f32_16x16x32_bf16 v[24:27], a[64:67], a[0:3], 0
  ds_write_b128 v251, v[76:79] offset:24576
  v_mfma_f32_16x16x32_bf16 v[24:27], a[80:83], a[28:31], v[24:27]
  v_mov_b32 v216, v112
  v_mov_b32 v217, v113
  v_mfma_f32_16x16x32_bf16 v[28:31], a[68:71], a[0:3], 0
  v_mfma_f32_16x16x32_bf16 v[28:31], a[84:87], a[28:31], v[28:31]
  s_waitcnt vmcnt(10)
  v_mov_b32 v218, v114
  v_mov_b32 v219, v115
  v_mfma_f32_16x16x32_bf16 v[32:35], a[56:59], a[4:7], 0
  s_add_u32 s33, s10, s54
  ds_write_b128 v249, v[84:87] offset:11264
  v_mfma_f32_16x16x32_bf16 v[32:35], a[72:75], a[32:35], v[32:35]
  buffer_load_dwordx4 a[0:3], v1, s[72:75], s33 offen offset:0 sc1
  v_mfma_f32_16x16x32_bf16 v[36:39], a[60:63], a[4:7], 0
  s_add_u32 s34, s10, s55
  v_mfma_f32_16x16x32_bf16 v[36:39], a[76:79], a[32:35], v[36:39]
  buffer_load_dwordx4 a[28:31], v1, s[72:75], s34 offen offset:0 sc1
  v_mfma_f32_16x16x32_bf16 v[40:43], a[64:67], a[4:7], 0
  ds_write_b128 v250, v[88:91] offset:18432
  v_mfma_f32_16x16x32_bf16 v[40:43], a[80:83], a[32:35], v[40:43]
  v_mfma_f32_16x16x32_bf16 v[44:47], a[68:71], a[4:7], 0
  v_mfma_f32_16x16x32_bf16 v[44:47], a[84:87], a[32:35], v[44:47]
  s_waitcnt vmcnt(10)
  v_mfma_f32_16x16x32_bf16 v[48:51], a[56:59], a[8:11], 0
  ds_write_b128 v251, v[92:95] offset:25600
  v_mfma_f32_16x16x32_bf16 v[48:51], a[72:75], a[36:39], v[48:51]
  buffer_load_dwordx4 a[4:7], v1, s[72:75], s33 offen offset:1024 sc1
  v_mfma_f32_16x16x32_bf16 v[52:55], a[60:63], a[8:11], 0
  v_mfma_f32_16x16x32_bf16 v[52:55], a[76:79], a[36:39], v[52:55]
  buffer_load_dwordx4 a[32:35], v1, s[72:75], s34 offen offset:1024 sc1
  v_mfma_f32_16x16x32_bf16 v[56:59], a[64:67], a[8:11], 0
  ds_write_b128 v249, v[100:103] offset:12288
  v_mfma_f32_16x16x32_bf16 v[56:59], a[80:83], a[36:39], v[56:59]
  v_mfma_f32_16x16x32_bf16 v[60:63], a[68:71], a[8:11], 0
  v_mfma_f32_16x16x32_bf16 v[60:63], a[84:87], a[36:39], v[60:63]
  s_waitcnt vmcnt(10)
  v_mfma_f32_16x16x32_bf16 v[64:67], a[56:59], a[12:15], 0
  ds_write_b128 v250, v[104:107] offset:19456
  v_mfma_f32_16x16x32_bf16 v[64:67], a[72:75], a[40:43], v[64:67]
  buffer_load_dwordx4 a[8:11], v1, s[72:75], s33 offen offset:2048 sc1
  v_mfma_f32_16x16x32_bf16 v[68:71], a[60:63], a[12:15], 0
  v_mfma_f32_16x16x32_bf16 v[68:71], a[76:79], a[40:43], v[68:71]
  buffer_load_dwordx4 a[36:39], v1, s[72:75], s34 offen offset:2048 sc1
  v_mfma_f32_16x16x32_bf16 v[72:75], a[64:67], a[12:15], 0
  ds_write_b128 v251, v[108:111] offset:26624
  v_mfma_f32_16x16x32_bf16 v[72:75], a[80:83], a[40:43], v[72:75]
  v_mfma_f32_16x16x32_bf16 v[76:79], a[68:71], a[12:15], 0
  v_mfma_f32_16x16x32_bf16 v[76:79], a[84:87], a[40:43], v[76:79]
  s_waitcnt vmcnt(10)
  v_mfma_f32_16x16x32_bf16 v[80:83], a[56:59], a[16:19], 0
  ds_write_b128 v249, v[116:119] offset:13312
  v_mfma_f32_16x16x32_bf16 v[80:83], a[72:75], a[44:47], v[80:83]
  buffer_load_dwordx4 a[12:15], v1, s[72:75], s33 offen offset:3072 sc1
  v_mfma_f32_16x16x32_bf16 v[84:87], a[60:63], a[16:19], 0
  v_mfma_f32_16x16x32_bf16 v[84:87], a[76:79], a[44:47], v[84:87]
  buffer_load_dwordx4 a[40:43], v1, s[72:75], s34 offen offset:3072 sc1
  v_mfma_f32_16x16x32_bf16 v[88:91], a[64:67], a[16:19], 0
  ds_write_b128 v250, v[120:123] offset:20480
  v_mfma_f32_16x16x32_bf16 v[88:91], a[80:83], a[44:47], v[88:91]
  v_mfma_f32_16x16x32_bf16 v[92:95], a[68:71], a[16:19], 0
  v_mfma_f32_16x16x32_bf16 v[92:95], a[84:87], a[44:47], v[92:95]
  s_waitcnt vmcnt(10)
  v_mfma_f32_16x16x32_bf16 v[96:99], a[56:59], a[20:23], 0
  ds_write_b128 v251, v[124:127] offset:27648
  v_mfma_f32_16x16x32_bf16 v[96:99], a[72:75], a[48:51], v[96:99]
  buffer_load_dwordx4 a[16:19], v240, s[72:75], s33 offen offset:0 sc1
  v_mfma_f32_16x16x32_bf16 v[100:103], a[60:63], a[20:23], 0
  v_mfma_f32_16x16x32_bf16 v[100:103], a[76:79], a[48:51], v[100:103]
  buffer_load_dwordx4 a[44:47], v240, s[72:75], s34 offen offset:0 sc1
  v_mfma_f32_16x16x32_bf16 v[104:107], a[64:67], a[20:23], 0
  v_mfma_f32_16x16x32_bf16 v[104:107], a[80:83], a[48:51], v[104:107]
  s_waitcnt lgkmcnt(0)
  s_barrier
  v_mfma_f32_16x16x32_bf16 v[108:111], a[68:71], a[20:23], 0
  v_mfma_f32_16x16x32_bf16 v[108:111], a[84:87], a[48:51], v[108:111]
  s_waitcnt vmcnt(10)
  v_mfma_f32_16x16x32_bf16 v[112:115], a[56:59], a[24:27], 0
  ds_read_b128 v[220:223], v248 offset:7168
  v_mfma_f32_16x16x32_bf16 v[112:115], a[72:75], a[52:55], v[112:115]
  buffer_load_dwordx4 a[20:23], v240, s[72:75], s33 offen offset:1024 sc1
  v_mfma_f32_16x16x32_bf16 v[116:119], a[60:63], a[24:27], 0
  ds_read_b128 v[224:227], v248 offset:14336
  v_mfma_f32_16x16x32_bf16 v[116:119], a[76:79], a[52:55], v[116:119]
  buffer_load_dwordx4 a[48:51], v240, s[72:75], s34 offen offset:1024 sc1
  v_mfma_f32_16x16x32_bf16 v[120:123], a[64:67], a[24:27], 0
  ds_read_b128 v[228:231], v248 offset:21504
  v_mfma_f32_16x16x32_bf16 v[120:123], a[80:83], a[52:55], v[120:123]
  v_mfma_f32_16x16x32_bf16 v[124:127], a[68:71], a[24:27], 0
  v_mfma_f32_16x16x32_bf16 v[124:127], a[84:87], a[52:55], v[124:127]
  s_waitcnt vmcnt(10)
  v_mfma_f32_16x16x32_bf16 v[16:19], a[88:91], a[0:3], v[16:19]
  s_waitcnt lgkmcnt(0)
  v_add_f32 v192, v192, v220
  v_add_f32 v193, v193, v221
  v_mfma_f32_16x16x32_bf16 v[16:19], a[104:107], a[28:31], v[16:19]
  buffer_load_dwordx4 a[24:27], v240, s[72:75], s33 offen offset:2048 sc1
  v_mfma_f32_16x16x32_bf16 v[20:23], a[92:95], a[0:3], v[20:23]
  v_add_f32 v194, v194, v222
  v_add_f32 v195, v195, v223
  v_mfma_f32_16x16x32_bf16 v[20:23], a[108:111], a[28:31], v[20:23]
  buffer_load_dwordx4 a[52:55], v240, s[72:75], s34 offen offset:2048 sc1
  v_mfma_f32_16x16x32_bf16 v[24:27], a[96:99], a[0:3], v[24:27]
  v_add_f32 v224, v224, v228
  v_add_f32 v225, v225, v229
  v_mfma_f32_16x16x32_bf16 v[24:27], a[112:115], a[28:31], v[24:27]
  v_add_f32 v226, v226, v230
  v_add_f32 v227, v227, v231
  v_mfma_f32_16x16x32_bf16 v[28:31], a[100:103], a[0:3], v[28:31]
  v_add_f32 v192, v192, v224
  v_add_f32 v193, v193, v225
  v_mfma_f32_16x16x32_bf16 v[28:31], a[116:119], a[28:31], v[28:31]
  s_waitcnt vmcnt(10)
  v_add_f32 v194, v194, v226
  v_add_f32 v195, v195, v227
  v_mfma_f32_16x16x32_bf16 v[32:35], a[88:91], a[4:7], v[32:35]
  s_add_u32 s33, s10, s56
  ds_read_b128 v[220:223], v248 offset:8192
  v_mfma_f32_16x16x32_bf16 v[32:35], a[104:107], a[32:35], v[32:35]
  buffer_load_dwordx4 a[0:3], v1, s[72:75], s33 offen offset:0 sc1
  v_mfma_f32_16x16x32_bf16 v[36:39], a[92:95], a[4:7], v[36:39]
  s_add_u32 s34, s10, s57
  ds_read_b128 v[224:227], v248 offset:15360
  v_mfma_f32_16x16x32_bf16 v[36:39], a[108:111], a[32:35], v[36:39]
  buffer_load_dwordx4 a[28:31], v1, s[72:75], s34 offen offset:0 sc1
  v_mfma_f32_16x16x32_bf16 v[40:43], a[96:99], a[4:7], v[40:43]
  ds_read_b128 v[228:231], v248 offset:22528
  v_mfma_f32_16x16x32_bf16 v[40:43], a[112:115], a[32:35], v[40:43]
  v_mfma_f32_16x16x32_bf16 v[44:47], a[100:103], a[4:7], v[44:47]
  v_mfma_f32_16x16x32_bf16 v[44:47], a[116:119], a[32:35], v[44:47]
  s_waitcnt vmcnt(10)
  v_mfma_f32_16x16x32_bf16 v[48:51], a[88:91], a[8:11], v[48:51]
  s_waitcnt lgkmcnt(0)
  v_add_f32 v196, v196, v220
  v_add_f32 v197, v197, v221
  v_mfma_f32_16x16x32_bf16 v[48:51], a[104:107], a[36:39], v[48:51]
  buffer_load_dwordx4 a[4:7], v1, s[72:75], s33 offen offset:1024 sc1
  v_mfma_f32_16x16x32_bf16 v[52:55], a[92:95], a[8:11], v[52:55]
  v_add_f32 v198, v198, v222
  v_add_f32 v199, v199, v223
  v_mfma_f32_16x16x32_bf16 v[52:55], a[108:111], a[36:39], v[52:55]
  buffer_load_dwordx4 a[32:35], v1, s[72:75], s34 offen offset:1024 sc1
  v_mfma_f32_16x16x32_bf16 v[56:59], a[96:99], a[8:11], v[56:59]
  v_add_f32 v224, v224, v228
  v_add_f32 v225, v225, v229
  v_mfma_f32_16x16x32_bf16 v[56:59], a[112:115], a[36:39], v[56:59]
  v_add_f32 v226, v226, v230
  v_add_f32 v227, v227, v231
  v_mfma_f32_16x16x32_bf16 v[60:63], a[100:103], a[8:11], v[60:63]
  v_add_f32 v196, v196, v224
  v_add_f32 v197, v197, v225
  v_mfma_f32_16x16x32_bf16 v[60:63], a[116:119], a[36:39], v[60:63]
  s_waitcnt vmcnt(10)
  v_add_f32 v198, v198, v226
  v_add_f32 v199, v199, v227
  v_mfma_f32_16x16x32_bf16 v[64:67], a[88:91], a[12:15], v[64:67]
  ds_read_b128 v[220:223], v248 offset:9216
  v_mfma_f32_16x16x32_bf16 v[64:67], a[104:107], a[40:43], v[64:67]
  buffer_load_dwordx4 a[8:11], v1, s[72:75], s33 offen offset:2048 sc1
  v_mfma_f32_16x16x32_bf16 v[68:71], a[92:95], a[12:15], v[68:71]
  ds_read_b128 v[224:227], v248 offset:16384
  v_mfma_f32_16x16x32_bf16 v[68:71], a[108:111], a[40:43], v[68:71]
  buffer_load_dwordx4 a[36:39], v1, s[72:75], s34 offen offset:2048 sc1
  v_mfma_f32_16x16x32_bf16 v[72:75], a[96:99], a[12:15], v[72:75]
  ds_read_b128 v[228:231], v248 offset:23552
  v_mfma_f32_16x16x32_bf16 v[72:75], a[112:115], a[40:43], v[72:75]
  v_mfma_f32_16x16x32_bf16 v[76:79], a[100:103], a[12:15], v[76:79]
  v_mfma_f32_16x16x32_bf16 v[76:79], a[116:119], a[40:43], v[76:79]
  s_waitcnt vmcnt(10)
  v_mfma_f32_16x16x32_bf16 v[80:83], a[88:91], a[16:19], v[80:83]
  s_waitcnt lgkmcnt(0)
  v_add_f32 v200, v200, v220
  v_add_f32 v201, v201, v221
  v_mfma_f32_16x16x32_bf16 v[80:83], a[104:107], a[44:47], v[80:83]
  buffer_load_dwordx4 a[12:15], v1, s[72:75], s33 offen offset:3072 sc1
  v_mfma_f32_16x16x32_bf16 v[84:87], a[92:95], a[16:19], v[84:87]
  v_add_f32 v202, v202, v222
  v_add_f32 v203, v203, v223
  v_mfma_f32_16x16x32_bf16 v[84:87], a[108:111], a[44:47], v[84:87]
  buffer_load_dwordx4 a[40:43], v1, s[72:75], s34 offen offset:3072 sc1
  v_mfma_f32_16x16x32_bf16 v[88:91], a[96:99], a[16:19], v[88:91]
  v_add_f32 v224, v224, v228
  v_add_f32 v225, v225, v229
  v_mfma_f32_16x16x32_bf16 v[88:91], a[112:115], a[44:47], v[88:91]
  v_add_f32 v226, v226, v230
  v_add_f32 v227, v227, v231
  v_mfma_f32_16x16x32_bf16 v[92:95], a[100:103], a[16:19], v[92:95]
  v_add_f32 v200, v200, v224
  v_add_f32 v201, v201, v225
  v_mfma_f32_16x16x32_bf16 v[92:95], a[116:119], a[44:47], v[92:95]
  s_waitcnt vmcnt(10)
  v_add_f32 v202, v202, v226
  v_add_f32 v203, v203, v227
  v_mfma_f32_16x16x32_bf16 v[96:99], a[88:91], a[20:23], v[96:99]
  ds_read_b128 v[220:223], v248 offset:10240
  v_mfma_f32_16x16x32_bf16 v[96:99], a[104:107], a[48:51], v[96:99]
  buffer_load_dwordx4 a[16:19], v240, s[72:75], s33 offen offset:0 sc1
  v_mfma_f32_16x16x32_bf16 v[100:103], a[92:95], a[20:23], v[100:103]
  ds_read_b128 v[224:227], v248 offset:17408
  v_mfma_f32_16x16x32_bf16 v[100:103], a[108:111], a[48:51], v[100:103]
  buffer_load_dwordx4 a[44:47], v240, s[72:75], s34 offen offset:0 sc1
  v_mfma_f32_16x16x32_bf16 v[104:107], a[96:99], a[20:23], v[104:107]
  ds_read_b128 v[228:231], v248 offset:24576
  v_mfma_f32_16x16x32_bf16 v[104:107], a[112:115], a[48:51], v[104:107]
  v_mfma_f32_16x16x32_bf16 v[108:111], a[100:103], a[20:23], v[108:111]
  v_mfma_f32_16x16x32_bf16 v[108:111], a[116:119], a[48:51], v[108:111]
  s_waitcnt vmcnt(10)
  v_mfma_f32_16x16x32_bf16 v[112:115], a[88:91], a[24:27], v[112:115]
  s_waitcnt lgkmcnt(0)
  v_add_f32 v204, v204, v220
  v_add_f32 v205, v205, v221
  v_mfma_f32_16x16x32_bf16 v[112:115], a[104:107], a[52:55], v[112:115]
  buffer_load_dwordx4 a[20:23], v240, s[72:75], s33 offen offset:1024 sc1
  v_mfma_f32_16x16x32_bf16 v[116:119], a[92:95], a[24:27], v[116:119]
  v_add_f32 v206, v206, v222
  v_add_f32 v207, v207, v223
  v_mfma_f32_16x16x32_bf16 v[116:119], a[108:111], a[52:55], v[116:119]
  buffer_load_dwordx4 a[48:51], v240, s[72:75], s34 offen offset:1024 sc1
  v_mfma_f32_16x16x32_bf16 v[120:123], a[96:99], a[24:27], v[120:123]
  v_add_f32 v224, v224, v228
  v_add_f32 v225, v225, v229
  v_mfma_f32_16x16x32_bf16 v[120:123], a[112:115], a[52:55], v[120:123]
  v_add_f32 v226, v226, v230
  v_add_f32 v227, v227, v231
  v_mfma_f32_16x16x32_bf16 v[124:127], a[100:103], a[24:27], v[124:127]
  v_add_f32 v204, v204, v224
  v_add_f32 v205, v205, v225
  v_mfma_f32_16x16x32_bf16 v[124:127], a[116:119], a[52:55], v[124:127]
  s_waitcnt vmcnt(10)
  v_add_f32 v206, v206, v226
  v_add_f32 v207, v207, v227
  v_mfma_f32_16x16x32_bf16 v[16:19], a[120:123], a[0:3], v[16:19]
  ds_read_b128 v[220:223], v248 offset:11264
  v_mfma_f32_16x16x32_bf16 v[16:19], a[136:139], a[28:31], v[16:19]
  buffer_load_dwordx4 a[24:27], v240, s[72:75], s33 offen offset:2048 sc1
  v_mfma_f32_16x16x32_bf16 v[20:23], a[124:127], a[0:3], v[20:23]
  ds_read_b128 v[224:227], v248 offset:18432
  v_mfma_f32_16x16x32_bf16 v[20:23], a[140:143], a[28:31], v[20:23]
  buffer_load_dwordx4 a[52:55], v240, s[72:75], s34 offen offset:2048 sc1
  v_mfma_f32_16x16x32_bf16 v[24:27], a[128:131], a[0:3], v[24:27]
  ds_read_b128 v[228:231], v248 offset:25600
  v_mfma_f32_16x16x32_bf16 v[24:27], a[144:147], a[28:31], v[24:27]
  v_mfma_f32_16x16x32_bf16 v[28:31], a[132:135], a[0:3], v[28:31]
  v_mfma_f32_16x16x32_bf16 v[28:31], a[148:151], a[28:31], v[28:31]
  s_waitcnt vmcnt(10)
  v_mfma_f32_16x16x32_bf16 v[32:35], a[120:123], a[4:7], v[32:35]
  s_add_u32 s33, s10, s58
  s_waitcnt lgkmcnt(0)
  v_add_f32 v208, v208, v220
  v_add_f32 v209, v209, v221
  v_mfma_f32_16x16x32_bf16 v[32:35], a[136:139], a[32:35], v[32:35]
  buffer_load_dwordx4 a[0:3], v1, s[72:75], s33 offen offset:0 sc1
  v_mfma_f32_16x16x32_bf16 v[36:39], a[124:127], a[4:7], v[36:39]
  s_add_u32 s34, s10, s59
  v_add_f32 v210, v210, v222
  v_add_f32 v211, v211, v223
  v_mfma_f32_16x16x32_bf16 v[36:39], a[140:143], a[32:35], v[36:39]
  buffer_load_dwordx4 a[28:31], v1, s[72:75], s34 offen offset:0 sc1
  v_mfma_f32_16x16x32_bf16 v[40:43], a[128:131], a[4:7], v[40:43]
  v_add_f32 v224, v224, v228
  v_add_f32 v225, v225, v229
  v_mfma_f32_16x16x32_bf16 v[40:43], a[144:147], a[32:35], v[40:43]
  v_add_f32 v226, v226, v230
  v_add_f32 v227, v227, v231
  v_mfma_f32_16x16x32_bf16 v[44:47], a[132:135], a[4:7], v[44:47]
  v_add_f32 v208, v208, v224
  v_add_f32 v209, v209, v225
  v_mfma_f32_16x16x32_bf16 v[44:47], a[148:151], a[32:35], v[44:47]
  s_waitcnt vmcnt(10)
  v_add_f32 v210, v210, v226
  v_add_f32 v211, v211, v227
  v_mfma_f32_16x16x32_bf16 v[48:51], a[120:123], a[8:11], v[48:51]
  ds_read_b128 v[220:223], v248 offset:12288
  v_mfma_f32_16x16x32_bf16 v[48:51], a[136:139], a[36:39], v[48:51]
  buffer_load_dwordx4 a[4:7], v1, s[72:75], s33 offen offset:1024 sc1
  v_mfma_f32_16x16x32_bf16 v[52:55], a[124:127], a[8:11], v[52:55]
  ds_read_b128 v[224:227], v248 offset:19456
  v_mfma_f32_16x16x32_bf16 v[52:55], a[140:143], a[36:39], v[52:55]
  buffer_load_dwordx4 a[32:35], v1, s[72:75], s34 offen offset:1024 sc1
  v_mfma_f32_16x16x32_bf16 v[56:59], a[128:131], a[8:11], v[56:59]
  ds_read_b128 v[228:231], v248 offset:26624
  v_mfma_f32_16x16x32_bf16 v[56:59], a[144:147], a[36:39], v[56:59]
  v_mfma_f32_16x16x32_bf16 v[60:63], a[132:135], a[8:11], v[60:63]
  v_mfma_f32_16x16x32_bf16 v[60:63], a[148:151], a[36:39], v[60:63]
  s_waitcnt vmcnt(10)
  v_mfma_f32_16x16x32_bf16 v[64:67], a[120:123], a[12:15], v[64:67]
  s_waitcnt lgkmcnt(0)
  v_add_f32 v212, v212, v220
  v_add_f32 v213, v213, v221
  v_mfma_f32_16x16x32_bf16 v[64:67], a[136:139], a[40:43], v[64:67]
  buffer_load_dwordx4 a[8:11], v1, s[72:75], s33 offen offset:2048 sc1
  v_mfma_f32_16x16x32_bf16 v[68:71], a[124:127], a[12:15], v[68:71]
  v_add_f32 v214, v214, v222
  v_add_f32 v215, v215, v223
  v_mfma_f32_16x16x32_bf16 v[68:71], a[140:143], a[40:43], v[68:71]
  buffer_load_dwordx4 a[36:39], v1, s[72:75], s34 offen offset:2048 sc1
  v_mfma_f32_16x16x32_bf16 v[72:75], a[128:131], a[12:15], v[72:75]
  v_add_f32 v224, v224, v228
  v_add_f32 v225, v225, v229
  v_mfma_f32_16x16x32_bf16 v[72:75], a[144:147], a[40:43], v[72:75]
  v_add_f32 v226, v226, v230
  v_add_f32 v227, v227, v231
  v_mfma_f32_16x16x32_bf16 v[76:79], a[132:135], a[12:15], v[76:79]
  v_add_f32 v212, v212, v224
  v_add_f32 v213, v213, v225
  v_mfma_f32_16x16x32_bf16 v[76:79], a[148:151], a[40:43], v[76:79]
  s_waitcnt vmcnt(10)
  v_add_f32 v214, v214, v226
  v_add_f32 v215, v215, v227
  v_mfma_f32_16x16x32_bf16 v[80:83], a[120:123], a[16:19], v[80:83]
  ds_read_b128 v[220:223], v248 offset:13312
  v_mfma_f32_16x16x32_bf16 v[80:83], a[136:139], a[44:47], v[80:83]
  buffer_load_dwordx4 a[12:15], v1, s[72:75], s33 offen offset:3072 sc1
  v_mfma_f32_16x16x32_bf16 v[84:87], a[124:127], a[16:19], v[84:87]
  ds_read_b128 v[224:227], v248 offset:20480
  v_mfma_f32_16x16x32_bf16 v[84:87], a[140:143], a[44:47], v[84:87]
  buffer_load_dwordx4 a[40:43], v1, s[72:75], s34 offen offset:3072 sc1
  v_mfma_f32_16x16x32_bf16 v[88:91], a[128:131], a[16:19], v[88:91]
  ds_read_b128 v[228:231], v248 offset:27648
  v_mfma_f32_16x16x32_bf16 v[88:91], a[144:147], a[44:47], v[88:91]
  v_mfma_f32_16x16x32_bf16 v[92:95], a[132:135], a[16:19], v[92:95]
  v_mfma_f32_16x16x32_bf16 v[92:95], a[148:151], a[44:47], v[92:95]
  s_waitcnt vmcnt(10)
  v_mfma_f32_16x16x32_bf16 v[96:99], a[120:123], a[20:23], v[96:99]
  s_waitcnt lgkmcnt(0)
  v_add_f32 v216, v216, v220
  v_add_f32 v217, v217, v221
  v_mfma_f32_16x16x32_bf16 v[96:99], a[136:139], a[48:51], v[96:99]
  buffer_load_dwordx4 a[16:19], v240, s[72:75], s33 offen offset:0 sc1
  v_mfma_f32_16x16x32_bf16 v[100:103], a[124:127], a[20:23], v[100:103]
  v_add_f32 v218, v218, v222
  v_add_f32 v219, v219, v223
  v_mfma_f32_16x16x32_bf16 v[100:103], a[140:143], a[48:51], v[100:103]
  buffer_load_dwordx4 a[44:47], v240, s[72:75], s34 offen offset:0 sc1
  v_mfma_f32_16x16x32_bf16 v[104:107], a[128:131], a[20:23], v[104:107]
  v_add_f32 v224, v224, v228
  v_add_f32 v225, v225, v229
  v_mfma_f32_16x16x32_bf16 v[104:107], a[144:147], a[48:51], v[104:107]
  v_add_f32 v226, v226, v230
  v_add_f32 v227, v227, v231
  v_mfma_f32_16x16x32_bf16 v[108:111], a[132:135], a[20:23], v[108:111]
  v_add_f32 v216, v216, v224
  v_add_f32 v217, v217, v225
  v_mfma_f32_16x16x32_bf16 v[108:111], a[148:151], a[48:51], v[108:111]
  s_waitcnt vmcnt(10)
  v_add_f32 v218, v218, v226
  v_add_f32 v219, v219, v227
  v_mfma_f32_16x16x32_bf16 v[112:115], a[120:123], a[24:27], v[112:115]
  v_mfma_f32_16x16x32_bf16 v[112:115], a[136:139], a[52:55], v[112:115]
  buffer_load_dwordx4 a[20:23], v240, s[72:75], s33 offen offset:1024 sc1
  v_mfma_f32_16x16x32_bf16 v[116:119], a[124:127], a[24:27], v[116:119]
  v_mfma_f32_16x16x32_bf16 v[116:119], a[140:143], a[52:55], v[116:119]
  buffer_load_dwordx4 a[48:51], v240, s[72:75], s34 offen offset:1024 sc1
  v_mfma_f32_16x16x32_bf16 v[120:123], a[128:131], a[24:27], v[120:123]
  buffer_store_dwordx4 v[192:195], v1, s[24:27], s20 offen offset:0 sc1
  v_mfma_f32_16x16x32_bf16 v[120:123], a[144:147], a[52:55], v[120:123]
  buffer_store_dwordx4 v[196:199], v1, s[24:27], s20 offen offset:1024 sc1
  v_mfma_f32_16x16x32_bf16 v[124:127], a[132:135], a[24:27], v[124:127]
  buffer_store_dwordx4 v[200:203], v1, s[24:27], s20 offen offset:2048 sc1
  v_mfma_f32_16x16x32_bf16 v[124:127], a[148:151], a[52:55], v[124:127]
  s_waitcnt vmcnt(13)
  v_mfma_f32_16x16x32_bf16 v[16:19], a[152:155], a[0:3], v[16:19]
  buffer_store_dwordx4 v[204:207], v1, s[24:27], s20 offen offset:3072 sc1
  v_mfma_f32_16x16x32_bf16 v[16:19], a[168:171], a[28:31], v[16:19]
  buffer_load_dwordx4 a[24:27], v240, s[72:75], s33 offen offset:2048 sc1
  v_mfma_f32_16x16x32_bf16 v[20:23], a[156:159], a[0:3], v[20:23]
  buffer_store_dwordx4 v[208:211], v240, s[24:27], s20 offen offset:0 sc1
  v_mfma_f32_16x16x32_bf16 v[20:23], a[172:175], a[28:31], v[20:23]
  buffer_load_dwordx4 a[52:55], v240, s[72:75], s34 offen offset:2048 sc1
  v_mfma_f32_16x16x32_bf16 v[24:27], a[160:163], a[0:3], v[24:27]
  buffer_store_dwordx4 v[212:215], v240, s[24:27], s20 offen offset:1024 sc1
  v_mfma_f32_16x16x32_bf16 v[24:27], a[176:179], a[28:31], v[24:27]
  buffer_store_dwordx4 v[216:219], v240, s[24:27], s20 offen offset:2048 sc1
  v_mfma_f32_16x16x32_bf16 v[28:31], a[164:167], a[0:3], v[28:31]
  v_mfma_f32_16x16x32_bf16 v[28:31], a[180:183], a[28:31], v[28:31]
  s_waitcnt vmcnt(17)
  v_mfma_f32_16x16x32_bf16 v[32:35], a[152:155], a[4:7], v[32:35]
  s_add_u32 s33, s11, s52
  v_mfma_f32_16x16x32_bf16 v[32:35], a[168:171], a[32:35], v[32:35]
  buffer_load_dwordx4 a[0:3], v1, s[72:75], s33 offen offset:0 sc1
  v_mfma_f32_16x16x32_bf16 v[36:39], a[156:159], a[4:7], v[36:39]
  s_add_u32 s34, s11, s53
  v_mfma_f32_16x16x32_bf16 v[36:39], a[172:175], a[32:35], v[36:39]
  buffer_load_dwordx4 a[28:31], v1, s[72:75], s34 offen offset:0 sc1
  v_mfma_f32_16x16x32_bf16 v[40:43], a[160:163], a[4:7], v[40:43]
  v_mfma_f32_16x16x32_bf16 v[40:43], a[176:179], a[32:35], v[40:43]
  v_mfma_f32_16x16x32_bf16 v[44:47], a[164:167], a[4:7], v[44:47]
  v_mfma_f32_16x16x32_bf16 v[44:47], a[180:183], a[32:35], v[44:47]
  s_waitcnt vmcnt(17)
  v_mfma_f32_16x16x32_bf16 v[48:51], a[152:155], a[8:11], v[48:51]
  v_mfma_f32_16x16x32_bf16 v[48:51], a[168:171], a[36:39], v[48:51]
  buffer_load_dwordx4 a[4:7], v1, s[72:75], s33 offen offset:1024 sc1
  v_mfma_f32_16x16x32_bf16 v[52:55], a[156:159], a[8:11], v[52:55]
  v_mfma_f32_16x16x32_bf16 v[52:55], a[172:175], a[36:39], v[52:55]
  buffer_load_dwordx4 a[32:35], v1, s[72:75], s34 offen offset:1024 sc1
  v_mfma_f32_16x16x32_bf16 v[56:59], a[160:163], a[8:11], v[56:59]
  v_mfma_f32_16x16x32_bf16 v[56:59], a[176:179], a[36:39], v[56:59]
  v_mfma_f32_16x16x32_bf16 v[60:63], a[164:167], a[8:11], v[60:63]
  v_mfma_f32_16x16x32_bf16 v[60:63], a[180:183], a[36:39], v[60:63]
  s_waitcnt vmcnt(17)
  v_mfma_f32_16x16x32_bf16 v[64:67], a[152:155], a[12:15], v[64:67]
  v_mfma_f32_16x16x32_bf16 v[64:67], a[168:171], a[40:43], v[64:67]
  buffer_load_dwordx4 a[8:11], v1, s[72:75], s33 offen offset:2048 sc1
  v_mfma_f32_16x16x32_bf16 v[68:71], a[156:159], a[12:15], v[68:71]
  v_mfma_f32_16x16x32_bf16 v[68:71], a[172:175], a[40:43], v[68:71]
  buffer_load_dwordx4 a[36:39], v1, s[72:75], s34 offen offset:2048 sc1
  v_mfma_f32_16x16x32_bf16 v[72:75], a[160:163], a[12:15], v[72:75]
  v_mfma_f32_16x16x32_bf16 v[72:75], a[176:179], a[40:43], v[72:75]
  v_mfma_f32_16x16x32_bf16 v[76:79], a[164:167], a[12:15], v[76:79]
  v_mfma_f32_16x16x32_bf16 v[76:79], a[180:183], a[40:43], v[76:79]
  s_waitcnt vmcnt(17)
  v_mfma_f32_16x16x32_bf16 v[80:83], a[152:155], a[16:19], v[80:83]
  v_mfma_f32_16x16x32_bf16 v[80:83], a[168:171], a[44:47], v[80:83]
  buffer_load_dwordx4 a[12:15], v1, s[72:75], s33 offen offset:3072 sc1
  v_mfma_f32_16x16x32_bf16 v[84:87], a[156:159], a[16:19], v[84:87]
  v_mfma_f32_16x16x32_bf16 v[84:87], a[172:175], a[44:47], v[84:87]
  buffer_load_dwordx4 a[40:43], v1, s[72:75], s34 offen offset:3072 sc1
  v_mfma_f32_16x16x32_bf16 v[88:91], a[160:163], a[16:19], v[88:91]
  v_mfma_f32_16x16x32_bf16 v[88:91], a[176:179], a[44:47], v[88:91]
  v_mfma_f32_16x16x32_bf16 v[92:95], a[164:167], a[16:19], v[92:95]
  v_mfma_f32_16x16x32_bf16 v[92:95], a[180:183], a[44:47], v[92:95]
  s_waitcnt vmcnt(17)
  v_mfma_f32_16x16x32_bf16 v[96:99], a[152:155], a[20:23], v[96:99]
  v_mfma_f32_16x16x32_bf16 v[96:99], a[168:171], a[48:51], v[96:99]
  buffer_load_dwordx4 a[16:19], v240, s[72:75], s33 offen offset:0 sc1
  v_mfma_f32_16x16x32_bf16 v[100:103], a[156:159], a[20:23], v[100:103]
  v_mfma_f32_16x16x32_bf16 v[100:103], a[172:175], a[48:51], v[100:103]
  buffer_load_dwordx4 a[44:47], v240, s[72:75], s34 offen offset:0 sc1
  v_mfma_f32_16x16x32_bf16 v[104:107], a[160:163], a[20:23], v[104:107]
  v_mfma_f32_16x16x32_bf16 v[104:107], a[176:179], a[48:51], v[104:107]
  v_mfma_f32_16x16x32_bf16 v[108:111], a[164:167], a[20:23], v[108:111]
  v_mfma_f32_16x16x32_bf16 v[108:111], a[180:183], a[48:51], v[108:111]
  s_waitcnt vmcnt(12)
  v_mfma_f32_16x16x32_bf16 v[112:115], a[152:155], a[24:27], v[112:115]
  v_mfma_f32_16x16x32_bf16 v[112:115], a[168:171], a[52:55], v[112:115]
  buffer_load_dwordx4 a[20:23], v240, s[72:75], s33 offen offset:1024 sc1
  v_mfma_f32_16x16x32_bf16 v[116:119], a[156:159], a[24:27], v[116:119]
  v_mfma_f32_16x16x32_bf16 v[116:119], a[172:175], a[52:55], v[116:119]
  buffer_load_dwordx4 a[48:51], v240, s[72:75], s34 offen offset:1024 sc1
  v_mfma_f32_16x16x32_bf16 v[120:123], a[160:163], a[24:27], v[120:123]
  s_waitcnt vmcnt(12)
  s_mov_b64 exec, 1
  global_store_dword v244, v245, s[66:67] sc1
  s_mov_b64 exec, -1
  v_mfma_f32_16x16x32_bf16 v[120:123], a[176:179], a[52:55], v[120:123]
  v_mfma_f32_16x16x32_bf16 v[124:127], a[164:167], a[24:27], v[124:127]
  v_mfma_f32_16x16x32_bf16 v[124:127], a[180:183], a[52:55], v[124:127]
  s_waitcnt vmcnt(11)
  v_mfma_f32_16x16x32_bf16 v[16:19], a[184:187], a[0:3], v[16:19]
  v_mfma_f32_16x16x32_bf16 v[16:19], a[200:203], a[28:31], v[16:19]
  buffer_load_dwordx4 a[24:27], v240, s[72:75], s33 offen offset:2048 sc1
  v_mfma_f32_16x16x32_bf16 v[20:23], a[188:191], a[0:3], v[20:23]
  v_mfma_f32_16x16x32_bf16 v[20:23], a[204:207], a[28:31], v[20:23]
  buffer_load_dwordx4 a[52:55], v240, s[72:75], s34 offen offset:2048 sc1
  v_mfma_f32_16x16x32_bf16 v[24:27], a[192:195], a[0:3], v[24:27]
  v_mfma_f32_16x16x32_bf16 v[24:27], a[208:211], a[28:31], v[24:27]
  v_mfma_f32_16x16x32_bf16 v[28:31], a[196:199], a[0:3], v[28:31]
  v_mfma_f32_16x16x32_bf16 v[28:31], a[212:215], a[28:31], v[28:31]
  s_waitcnt vmcnt(11)
  v_mfma_f32_16x16x32_bf16 v[32:35], a[184:187], a[4:7], v[32:35]
  s_add_u32 s33, s11, s54
  v_mfma_f32_16x16x32_bf16 v[32:35], a[200:203], a[32:35], v[32:35]
  buffer_load_dwordx4 a[0:3], v1, s[72:75], s33 offen offset:0 sc1
  v_mfma_f32_16x16x32_bf16 v[36:39], a[188:191], a[4:7], v[36:39]
  s_add_u32 s34, s11, s55
  v_mfma_f32_16x16x32_bf16 v[36:39], a[204:207], a[32:35], v[36:39]
  buffer_load_dwordx4 a[28:31], v1, s[72:75], s34 offen offset:0 sc1
  v_mfma_f32_16x16x32_bf16 v[40:43], a[192:195], a[4:7], v[40:43]
  v_mfma_f32_16x16x32_bf16 v[40:43], a[208:211], a[32:35], v[40:43]
  v_mfma_f32_16x16x32_bf16 v[44:47], a[196:199], a[4:7], v[44:47]
  v_mfma_f32_16x16x32_bf16 v[44:47], a[212:215], a[32:35], v[44:47]
  s_waitcnt vmcnt(11)
  v_mfma_f32_16x16x32_bf16 v[48:51], a[184:187], a[8:11], v[48:51]
  v_mfma_f32_16x16x32_bf16 v[48:51], a[200:203], a[36:39], v[48:51]
  buffer_load_dwordx4 a[4:7], v1, s[72:75], s33 offen offset:1024 sc1
  v_mfma_f32_16x16x32_bf16 v[52:55], a[188:191], a[8:11], v[52:55]
  v_mfma_f32_16x16x32_bf16 v[52:55], a[204:207], a[36:39], v[52:55]
  buffer_load_dwordx4 a[32:35], v1, s[72:75], s34 offen offset:1024 sc1
  v_mfma_f32_16x16x32_bf16 v[56:59], a[192:195], a[8:11], v[56:59]
  v_mfma_f32_16x16x32_bf16 v[56:59], a[208:211], a[36:39], v[56:59]
  v_mfma_f32_16x16x32_bf16 v[60:63], a[196:199], a[8:11], v[60:63]
  v_mfma_f32_16x16x32_bf16 v[60:63], a[212:215], a[36:39], v[60:63]
  s_waitcnt vmcnt(11)
  v_mfma_f32_16x16x32_bf16 v[64:67], a[184:187], a[12:15], v[64:67]
  v_mfma_f32_16x16x32_bf16 v[64:67], a[200:203], a[40:43], v[64:67]
  buffer_load_dwordx4 a[8:11], v1, s[72:75], s33 offen offset:2048 sc1
  v_mfma_f32_16x16x32_bf16 v[68:71], a[188:191], a[12:15], v[68:71]
  v_mfma_f32_16x16x32_bf16 v[68:71], a[204:207], a[40:43], v[68:71]
  buffer_load_dwordx4 a[36:39], v1, s[72:75], s34 offen offset:2048 sc1
  v_mfma_f32_16x16x32_bf16 v[72:75], a[192:195], a[12:15], v[72:75]
  v_mfma_f32_16x16x32_bf16 v[72:75], a[208:211], a[40:43], v[72:75]
  v_mfma_f32_16x16x32_bf16 v[76:79], a[196:199], a[12:15], v[76:79]
  v_mfma_f32_16x16x32_bf16 v[76:79], a[212:215], a[40:43], v[76:79]
  s_waitcnt vmcnt(11)
  v_mfma_f32_16x16x32_bf16 v[80:83], a[184:187], a[16:19], v[80:83]
  v_mfma_f32_16x16x32_bf16 v[80:83], a[200:203], a[44:47], v[80:83]
  buffer_load_dwordx4 a[12:15], v1, s[72:75], s33 offen offset:3072 sc1
  v_mfma_f32_16x16x32_bf16 v[84:87], a[188:191], a[16:19], v[84:87]
  v_mfma_f32_16x16x32_bf16 v[84:87], a[204:207], a[44:47], v[84:87]
  buffer_load_dwordx4 a[40:43], v1, s[72:75], s34 offen offset:3072 sc1
  v_mfma_f32_16x16x32_bf16 v[88:91], a[192:195], a[16:19], v[88:91]
  v_mfma_f32_16x16x32_bf16 v[88:91], a[208:211], a[44:47], v[88:91]
  v_mfma_f32_16x16x32_bf16 v[92:95], a[196:199], a[16:19], v[92:95]
  v_mfma_f32_16x16x32_bf16 v[92:95], a[212:215], a[44:47], v[92:95]
  s_waitcnt vmcnt(11)
  v_mfma_f32_16x16x32_bf16 v[96:99], a[184:187], a[20:23], v[96:99]
  v_mfma_f32_16x16x32_bf16 v[96:99], a[200:203], a[48:51], v[96:99]
  buffer_load_dwordx4 a[16:19], v240, s[72:75], s33 offen offset:0 sc1
  v_mfma_f32_16x16x32_bf16 v[100:103], a[188:191], a[20:23], v[100:103]
  v_mfma_f32_16x16x32_bf16 v[100:103], a[204:207], a[48:51], v[100:103]
  buffer_load_dwordx4 a[44:47], v240, s[72:75], s34 offen offset:0 sc1
  v_mfma_f32_16x16x32_bf16 v[104:107], a[192:195], a[20:23], v[104:107]
  v_mfma_f32_16x16x32_bf16 v[104:107], a[208:211], a[48:51], v[104:107]
  v_mfma_f32_16x16x32_bf16 v[108:111], a[196:199], a[20:23], v[108:111]
  v_mfma_f32_16x16x32_bf16 v[108:111], a[212:215], a[48:51], v[108:111]
  s_waitcnt vmcnt(10)
  v_mfma_f32_16x16x32_bf16 v[112:115], a[184:187], a[24:27], v[112:115]
  v_mfma_f32_16x16x32_bf16 v[112:115], a[200:203], a[52:55], v[112:115]
  buffer_load_dwordx4 a[20:23], v240, s[72:75], s33 offen offset:1024 sc1
  v_mfma_f32_16x16x32_bf16 v[116:119], a[188:191], a[24:27], v[116:119]
  v_mfma_f32_16x16x32_bf16 v[116:119], a[204:207], a[52:55], v[116:119]
  buffer_load_dwordx4 a[48:51], v240, s[72:75], s34 offen offset:1024 sc1
  v_mfma_f32_16x16x32_bf16 v[120:123], a[192:195], a[24:27], v[120:123]
  v_mfma_f32_16x16x32_bf16 v[120:123], a[208:211], a[52:55], v[120:123]
  v_mfma_f32_16x16x32_bf16 v[124:127], a[196:199], a[24:27], v[124:127]
  v_mfma_f32_16x16x32_bf16 v[124:127], a[212:215], a[52:55], v[124:127]
  s_waitcnt vmcnt(10)
  v_mfma_f32_16x16x32_bf16 v[16:19], a[216:219], a[0:3], v[16:19]
  v_mfma_f32_16x16x32_bf16 v[16:19], a[232:235], a[28:31], v[16:19]
  buffer_load_dwordx4 a[24:27], v240, s[72:75], s33 offen offset:2048 sc1
  v_mfma_f32_16x16x32_bf16 v[20:23], a[220:223], a[0:3], v[20:23]
  v_mfma_f32_16x16x32_bf16 v[20:23], a[236:239], a[28:31], v[20:23]
  buffer_load_dwordx4 a[52:55], v240, s[72:75], s34 offen offset:2048 sc1
  v_mfma_f32_16x16x32_bf16 v[24:27], a[224:227], a[0:3], v[24:27]
  s_barrier
  v_mfma_f32_16x16x32_bf16 v[24:27], a[240:243], a[28:31], v[24:27]
  v_mfma_f32_16x16x32_bf16 v[28:31], a[228:231], a[0:3], v[28:31]
  v_mfma_f32_16x16x32_bf16 v[28:31], a[244:247], a[28:31], v[28:31]
  s_waitcnt vmcnt(10)
  v_mfma_f32_16x16x32_bf16 v[32:35], a[216:219], a[4:7], v[32:35]
  s_add_u32 s33, s11, s56
  v_mfma_f32_16x16x32_bf16 v[32:35], a[232:235], a[32:35], v[32:35]
  buffer_load_dwordx4 a[0:3], v1, s[72:75], s33 offen offset:0 sc1
  v_mfma_f32_16x16x32_bf16 v[36:39], a[220:223], a[4:7], v[36:39]
  s_add_u32 s34, s11, s57
  v_mfma_f32_16x16x32_bf16 v[36:39], a[236:239], a[32:35], v[36:39]
  buffer_load_dwordx4 a[28:31], v1, s[72:75], s34 offen offset:0 sc1
  v_mfma_f32_16x16x32_bf16 v[40:43], a[224:227], a[4:7], v[40:43]
  v_mfma_f32_16x16x32_bf16 v[40:43], a[240:243], a[32:35], v[40:43]
  v_mfma_f32_16x16x32_bf16 v[44:47], a[228:231], a[4:7], v[44:47]
  v_mfma_f32_16x16x32_bf16 v[44:47], a[244:247], a[32:35], v[44:47]
  s_waitcnt vmcnt(10)
  v_mfma_f32_16x16x32_bf16 v[48:51], a[216:219], a[8:11], v[48:51]
  v_mfma_f32_16x16x32_bf16 v[48:51], a[232:235], a[36:39], v[48:51]
  buffer_load_dwordx4 a[4:7], v1, s[72:75], s33 offen offset:1024 sc1
  v_mfma_f32_16x16x32_bf16 v[52:55], a[220:223], a[8:11], v[52:55]
  v_mfma_f32_16x16x32_bf16 v[52:55], a[236:239], a[36:39], v[52:55]
  buffer_load_dwordx4 a[32:35], v1, s[72:75], s34 offen offset:1024 sc1
  v_mfma_f32_16x16x32_bf16 v[56:59], a[224:227], a[8:11], v[56:59]
  v_mfma_f32_16x16x32_bf16 v[56:59], a[240:243], a[36:39], v[56:59]
  v_mfma_f32_16x16x32_bf16 v[60:63], a[228:231], a[8:11], v[60:63]
  v_mfma_f32_16x16x32_bf16 v[60:63], a[244:247], a[36:39], v[60:63]
  s_waitcnt vmcnt(10)
  v_mfma_f32_16x16x32_bf16 v[64:67], a[216:219], a[12:15], v[64:67]
  v_mfma_f32_16x16x32_bf16 v[64:67], a[232:235], a[40:43], v[64:67]
  buffer_load_dwordx4 a[8:11], v1, s[72:75], s33 offen offset:2048 sc1
  v_mfma_f32_16x16x32_bf16 v[68:71], a[220:223], a[12:15], v[68:71]
  v_mfma_f32_16x16x32_bf16 v[68:71], a[236:239], a[40:43], v[68:71]
  buffer_load_dwordx4 a[36:39], v1, s[72:75], s34 offen offset:2048 sc1
  v_mfma_f32_16x16x32_bf16 v[72:75], a[224:227], a[12:15], v[72:75]
  v_mfma_f32_16x16x32_bf16 v[72:75], a[240:243], a[40:43], v[72:75]
  v_mfma_f32_16x16x32_bf16 v[76:79], a[228:231], a[12:15], v[76:79]
  v_mfma_f32_16x16x32_bf16 v[76:79], a[244:247], a[40:43], v[76:79]
  s_waitcnt vmcnt(10)
  v_mfma_f32_16x16x32_bf16 v[80:83], a[216:219], a[16:19], v[80:83]
  v_mfma_f32_16x16x32_bf16 v[80:83], a[232:235], a[44:47], v[80:83]
  buffer_load_dwordx4 a[12:15], v1, s[72:75], s33 offen offset:3072 sc1
  v_mfma_f32_16x16x32_bf16 v[84:87], a[220:223], a[16:19], v[84:87]
  v_mfma_f32_16x16x32_bf16 v[84:87], a[236:239], a[44:47], v[84:87]
  buffer_load_dwordx4 a[40:43], v1, s[72:75], s34 offen offset:3072 sc1
  v_mfma_f32_16x16x32_bf16 v[88:91], a[224:227], a[16:19], v[88:91]
  v_mfma_f32_16x16x32_bf16 v[88:91], a[240:243], a[44:47], v[88:91]
  v_mfma_f32_16x16x32_bf16 v[92:95], a[228:231], a[16:19], v[92:95]
  v_mfma_f32_16x16x32_bf16 v[92:95], a[244:247], a[44:47], v[92:95]
  s_waitcnt vmcnt(10)
  v_mfma_f32_16x16x32_bf16 v[96:99], a[216:219], a[20:23], v[96:99]
  v_mfma_f32_16x16x32_bf16 v[96:99], a[232:235], a[48:51], v[96:99]
  buffer_load_dwordx4 a[16:19], v240, s[72:75], s33 offen offset:0 sc1
  v_mfma_f32_16x16x32_bf16 v[100:103], a[220:223], a[20:23], v[100:103]
  v_mfma_f32_16x16x32_bf16 v[100:103], a[236:239], a[48:51], v[100:103]
  buffer_load_dwordx4 a[44:47], v240, s[72:75], s34 offen offset:0 sc1
  v_mfma_f32_16x16x32_bf16 v[104:107], a[224:227], a[20:23], v[104:107]
  v_mfma_f32_16x16x32_bf16 v[104:107], a[240:243], a[48:51], v[104:107]
  v_mfma_f32_16x16x32_bf16 v[108:111], a[228:231], a[20:23], v[108:111]
  v_mfma_f32_16x16x32_bf16 v[108:111], a[244:247], a[48:51], v[108:111]
  s_waitcnt vmcnt(10)
  v_mfma_f32_16x16x32_bf16 v[112:115], a[216:219], a[24:27], v[112:115]
  v_mfma_f32_16x16x32_bf16 v[112:115], a[232:235], a[52:55], v[112:115]
  buffer_load_dwordx4 a[20:23], v240, s[72:75], s33 offen offset:1024 sc1
  v_mfma_f32_16x16x32_bf16 v[116:119], a[220:223], a[24:27], v[116:119]
  v_mfma_f32_16x16x32_bf16 v[116:119], a[236:239], a[52:55], v[116:119]
  buffer_load_dwordx4 a[48:51], v240, s[72:75], s34 offen offset:1024 sc1
  v_mfma_f32_16x16x32_bf16 v[120:123], a[224:227], a[24:27], v[120:123]
  v_mfma_f32_16x16x32_bf16 v[120:123], a[240:243], a[52:55], v[120:123]
  v_mfma_f32_16x16x32_bf16 v[124:127], a[228:231], a[24:27], v[124:127]
  v_mfma_f32_16x16x32_bf16 v[124:127], a[244:247], a[52:55], v[124:127]
  s_waitcnt vmcnt(10)
  v_mfma_f32_16x16x32_bf16 v[16:19], v[128:131], a[0:3], v[16:19]
  v_mfma_f32_16x16x32_bf16 v[16:19], v[144:147], a[28:31], v[16:19]
  buffer_load_dwordx4 a[24:27], v240, s[72:75], s33 offen offset:2048 sc1
  v_mfma_f32_16x16x32_bf16 v[20:23], v[132:135], a[0:3], v[20:23]
  v_mfma_f32_16x16x32_bf16 v[20:23], v[148:151], a[28:31], v[20:23]
  buffer_load_dwordx4 a[52:55], v240, s[72:75], s34 offen offset:2048 sc1
  v_mfma_f32_16x16x32_bf16 v[24:27], v[136:139], a[0:3], v[24:27]
  v_mfma_f32_16x16x32_bf16 v[24:27], v[152:155], a[28:31], v[24:27]
  v_mfma_f32_16x16x32_bf16 v[28:31], v[140:143], a[0:3], v[28:31]
  v_mfma_f32_16x16x32_bf16 v[28:31], v[156:159], a[28:31], v[28:31]
  s_waitcnt vmcnt(10)
  v_mfma_f32_16x16x32_bf16 v[32:35], v[128:131], a[4:7], v[32:35]
  s_add_u32 s33, s11, s58
  v_mfma_f32_16x16x32_bf16 v[32:35], v[144:147], a[32:35], v[32:35]
  buffer_load_dwordx4 a[0:3], v1, s[72:75], s33 offen offset:0 sc1
  v_mfma_f32_16x16x32_bf16 v[36:39], v[132:135], a[4:7], v[36:39]
  s_add_u32 s34, s11, s59
  v_mfma_f32_16x16x32_bf16 v[36:39], v[148:151], a[32:35], v[36:39]
  buffer_load_dwordx4 a[28:31], v1, s[72:75], s34 offen offset:0 sc1
  v_mfma_f32_16x16x32_bf16 v[40:43], v[136:139], a[4:7], v[40:43]
  global_load_dword v247, v253, s[66:67] sc1
  v_mfma_f32_16x16x32_bf16 v[40:43], v[152:155], a[32:35], v[40:43]
  v_mfma_f32_16x16x32_bf16 v[44:47], v[140:143], a[4:7], v[44:47]
  v_mfma_f32_16x16x32_bf16 v[44:47], v[156:159], a[32:35], v[44:47]
  s_waitcnt vmcnt(11)
  v_mfma_f32_16x16x32_bf16 v[48:51], v[128:131], a[8:11], v[48:51]
  v_mfma_f32_16x16x32_bf16 v[48:51], v[144:147], a[36:39], v[48:51]
  buffer_load_dwordx4 a[4:7], v1, s[72:75], s33 offen offset:1024 sc1
  v_mfma_f32_16x16x32_bf16 v[52:55], v[132:135], a[8:11], v[52:55]
  v_mfma_f32_16x16x32_bf16 v[52:55], v[148:151], a[36:39], v[52:55]
  buffer_load_dwordx4 a[32:35], v1, s[72:75], s34 offen offset:1024 sc1
  v_mfma_f32_16x16x32_bf16 v[56:59], v[136:139], a[8:11], v[56:59]
  v_mfma_f32_16x16x32_bf16 v[56:59], v[152:155], a[36:39], v[56:59]
  v_mfma_f32_16x16x32_bf16 v[60:63], v[140:143], a[8:11], v[60:63]
  v_mfma_f32_16x16x32_bf16 v[60:63], v[156:159], a[36:39], v[60:63]
  s_waitcnt vmcnt(11)
  v_mfma_f32_16x16x32_bf16 v[64:67], v[128:131], a[12:15], v[64:67]
  v_mfma_f32_16x16x32_bf16 v[64:67], v[144:147], a[40:43], v[64:67]
  buffer_load_dwordx4 a[8:11], v1, s[72:75], s33 offen offset:2048 sc1
  v_mfma_f32_16x16x32_bf16 v[68:71], v[132:135], a[12:15], v[68:71]
  v_mfma_f32_16x16x32_bf16 v[68:71], v[148:151], a[40:43], v[68:71]
  buffer_load_dwordx4 a[36:39], v1, s[72:75], s34 offen offset:2048 sc1
  v_mfma_f32_16x16x32_bf16 v[72:75], v[136:139], a[12:15], v[72:75]
  v_mfma_f32_16x16x32_bf16 v[72:75], v[152:155], a[40:43], v[72:75]
  v_mfma_f32_16x16x32_bf16 v[76:79], v[140:143], a[12:15], v[76:79]
  v_mfma_f32_16x16x32_bf16 v[76:79], v[156:159], a[40:43], v[76:79]
  s_waitcnt vmcnt(11)
  v_mfma_f32_16x16x32_bf16 v[80:83], v[128:131], a[16:19], v[80:83]
  v_mfma_f32_16x16x32_bf16 v[80:83], v[144:147], a[44:47], v[80:83]
  buffer_load_dwordx4 a[12:15], v1, s[72:75], s33 offen offset:3072 sc1
  v_mfma_f32_16x16x32_bf16 v[84:87], v[132:135], a[16:19], v[84:87]
  v_mfma_f32_16x16x32_bf16 v[84:87], v[148:151], a[44:47], v[84:87]
  buffer_load_dwordx4 a[40:43], v1, s[72:75], s34 offen offset:3072 sc1
  v_mfma_f32_16x16x32_bf16 v[88:91], v[136:139], a[16:19], v[88:91]
  v_mfma_f32_16x16x32_bf16 v[88:91], v[152:155], a[44:47], v[88:91]
  v_mfma_f32_16x16x32_bf16 v[92:95], v[140:143], a[16:19], v[92:95]
  v_mfma_f32_16x16x32_bf16 v[92:95], v[156:159], a[44:47], v[92:95]
  s_waitcnt vmcnt(11)
  v_mfma_f32_16x16x32_bf16 v[96:99], v[128:131], a[20:23], v[96:99]
  v_mfma_f32_16x16x32_bf16 v[96:99], v[144:147], a[48:51], v[96:99]
  buffer_load_dwordx4 a[16:19], v240, s[72:75], s33 offen offset:0 sc1
  v_mfma_f32_16x16x32_bf16 v[100:103], v[132:135], a[20:23], v[100:103]
  v_mfma_f32_16x16x32_bf16 v[100:103], v[148:151], a[48:51], v[100:103]
  buffer_load_dwordx4 a[44:47], v240, s[72:75], s34 offen offset:0 sc1
  v_mfma_f32_16x16x32_bf16 v[104:107], v[136:139], a[20:23], v[104:107]
  v_mfma_f32_16x16x32_bf16 v[104:107], v[152:155], a[48:51], v[104:107]
  v_mfma_f32_16x16x32_bf16 v[108:111], v[140:143], a[20:23], v[108:111]
  v_mfma_f32_16x16x32_bf16 v[108:111], v[156:159], a[48:51], v[108:111]
  s_waitcnt vmcnt(11)
  v_mfma_f32_16x16x32_bf16 v[112:115], v[128:131], a[24:27], v[112:115]
  v_mfma_f32_16x16x32_bf16 v[112:115], v[144:147], a[52:55], v[112:115]
  buffer_load_dwordx4 a[20:23], v240, s[72:75], s33 offen offset:1024 sc1
  v_mfma_f32_16x16x32_bf16 v[116:119], v[132:135], a[24:27], v[116:119]
  v_mfma_f32_16x16x32_bf16 v[116:119], v[148:151], a[52:55], v[116:119]
  buffer_load_dwordx4 a[48:51], v240, s[72:75], s34 offen offset:1024 sc1
  v_mfma_f32_16x16x32_bf16 v[120:123], v[136:139], a[24:27], v[120:123]
  v_mfma_f32_16x16x32_bf16 v[120:123], v[152:155], a[52:55], v[120:123]
  v_mfma_f32_16x16x32_bf16 v[124:127], v[140:143], a[24:27], v[124:127]
  v_mfma_f32_16x16x32_bf16 v[124:127], v[156:159], a[52:55], v[124:127]
  s_waitcnt vmcnt(11)
  v_mfma_f32_16x16x32_bf16 v[20:23], v[164:167], a[0:3], v[20:23]
  v_mfma_f32_16x16x32_bf16 v[20:23], v[180:183], a[28:31], v[20:23]
  buffer_load_dwordx4 a[24:27], v240, s[72:75], s33 offen offset:2048 sc1
  v_mfma_f32_16x16x32_bf16 v[24:27], v[168:171], a[0:3], v[24:27]
  v_mfma_f32_16x16x32_bf16 v[24:27], v[184:187], a[28:31], v[24:27]
  buffer_load_dwordx4 a[52:55], v240, s[72:75], s34 offen offset:2048 sc1
  s_waitcnt vmcnt(12)
  s_mov_b32 s38, 0
  L_poll2:
  v_cmp_ne_u32 vcc, 1, v247
  s_nop 1
  s_cmp_eq_u64 vcc, 0
  s_cbranch_scc1 L_ready2
  s_add_u32 s38, s38, 1
  s_cmp_ge_u32 s38, 0x40000
  s_cbranch_scc1 L_ready2
  global_load_dword v247, v253, s[66:67] sc1
  s_waitcnt vmcnt(0)
  s_branch L_poll2
  L_ready2:
  v_mfma_f32_16x16x32_bf16 v[28:31], v[172:175], a[0:3], v[28:31]
  buffer_load_dwordx4 v[192:195], v1, s[24:27], s100 offen offset:0 sc1
  v_mfma_f32_16x16x32_bf16 v[28:31], v[188:191], a[28:31], v[28:31]
  buffer_load_dwordx4 v[196:199], v1, s[24:27], s100 offen offset:1024 sc1
  v_mfma_f32_16x16x32_bf16 v[16:19], v[160:163], a[0:3], v[16:19]
  buffer_load_dwordx4 v[200:203], v1, s[24:27], s100 offen offset:2048 sc1
  v_mfma_f32_16x16x32_bf16 v[16:19], v[176:179], a[28:31], v[16:19]
  s_waitcnt vmcnt(13)
  v_mfma_f32_16x16x32_bf16 v[36:39], v[164:167], a[4:7], v[36:39]
  buffer_load_dwordx4 v[204:207], v1, s[24:27], s100 offen offset:3072 sc1
  v_mfma_f32_16x16x32_bf16 v[36:39], v[180:183], a[32:35], v[36:39]
  buffer_load_dwordx4 v[208:211], v240, s[24:27], s100 offen offset:0 sc1
  v_mfma_f32_16x16x32_bf16 v[40:43], v[168:171], a[4:7], v[40:43]
  ds_write_b128 v249, v[20:23] offset:7168
  v_mfma_f32_16x16x32_bf16 v[40:43], v[184:187], a[32:35], v[40:43]
  buffer_load_dwordx4 v[212:215], v240, s[24:27], s100 offen offset:1024 sc1
  v_mfma_f32_16x16x32_bf16 v[44:47], v[172:175], a[4:7], v[44:47]
  ds_write_b128 v250, v[24:27] offset:14336
  v_mfma_f32_16x16x32_bf16 v[44:47], v[188:191], a[32:35], v[44:47]
  buffer_load_dwordx4 v[216:219], v240, s[24:27], s100 offen offset:2048 sc1
  v_mfma_f32_16x16x32_bf16 v[32:35], v[160:163], a[4:7], v[32:35]
  ds_write_b128 v251, v[28:31] offset:21504
  v_mfma_f32_16x16x32_bf16 v[32:35], v[176:179], a[32:35], v[32:35]
  s_waitcnt vmcnt(15)
  v_mfma_f32_16x16x32_bf16 v[52:55], v[164:167], a[8:11], v[52:55]
  v_mfma_f32_16x16x32_bf16 v[52:55], v[180:183], a[36:39], v[52:55]
  v_mfma_f32_16x16x32_bf16 v[56:59], v[168:171], a[8:11], v[56:59]
  ds_write_b128 v249, v[36:39] offset:8192
  v_mfma_f32_16x16x32_bf16 v[56:59], v[184:187], a[36:39], v[56:59]
  v_mfma_f32_16x16x32_bf16 v[60:63], v[172:175], a[8:11], v[60:63]
  ds_write_b128 v250, v[40:43] offset:15360
  v_mfma_f32_16x16x32_bf16 v[60:63], v[188:191], a[36:39], v[60:63]
  v_mfma_f32_16x16x32_bf16 v[48:51], v[160:163], a[8:11], v[48:51]
  ds_write_b128 v251, v[44:47] offset:22528
  v_mfma_f32_16x16x32_bf16 v[48:51], v[176:179], a[36:39], v[48:51]
  s_waitcnt vmcnt(13)
  v_mfma_f32_16x16x32_bf16 v[68:71], v[164:167], a[12:15], v[68:71]
  v_mfma_f32_16x16x32_bf16 v[68:71], v[180:183], a[40:43], v[68:71]
  v_mfma_f32_16x16x32_bf16 v[72:75], v[168:171], a[12:15], v[72:75]
  ds_write_b128 v249, v[52:55] offset:9216
  v_mfma_f32_16x16x32_bf16 v[72:75], v[184:187], a[40:43], v[72:75]
  v_mfma_f32_16x16x32_bf16 v[76:79], v[172:175], a[12:15], v[76:79]
  ds_write_b128 v250, v[56:59] offset:16384
  v_mfma_f32_16x16x32_bf16 v[76:79], v[188:191], a[40:43], v[76:79]
  v_mfma_f32_16x16x32_bf16 v[64:67], v[160:163], a[12:15], v[64:67]
  ds_write_b128 v251, v[60:63] offset:23552
  v_mfma_f32_16x16x32_bf16 v[64:67], v[176:179], a[40:43], v[64:67]
  s_waitcnt vmcnt(11)
  v_mfma_f32_16x16x32_bf16 v[84:87], v[164:167], a[16:19], v[84:87]
  v_mfma_f32_16x16x32_bf16 v[84:87], v[180:183], a[44:47], v[84:87]
  v_mfma_f32_16x16x32_bf16 v[88:91], v[168:171], a[16:19], v[88:91]
  ds_write_b128 v249, v[68:71] offset:10240
  v_mfma_f32_16x16x32_bf16 v[88:91], v[184:187], a[44:47], v[88:91]
  v_mfma_f32_16x16x32_bf16 v[92:95], v[172:175], a[16:19], v[92:95]
  ds_write_b128 v250, v[72:75] offset:17408
  v_mfma_f32_16x16x32_bf16 v[92:95], v[188:191], a[44:47], v[92:95]
  v_mfma_f32_16x16x32_bf16 v[80:83], v[160:163], a[16:19], v[80:83]
  ds_write_b128 v251, v[76:79] offset:24576
  v_mfma_f32_16x16x32_bf16 v[80:83], v[176:179], a[44:47], v[80:83]
  s_waitcnt vmcnt(9)
  v_mfma_f32_16x16x32_bf16 v[100:103], v[164:167], a[20:23], v[100:103]
  v_mfma_f32_16x16x32_bf16 v[100:103], v[180:183], a[48:51], v[100:103]
  v_mfma_f32_16x16x32_bf16 v[104:107], v[168:171], a[20:23], v[104:107]
  ds_write_b128 v249, v[84:87] offset:11264
  v_mfma_f32_16x16x32_bf16 v[104:107], v[184:187], a[48:51], v[104:107]
  s_waitcnt lgkmcnt(1)
  s_barrier
  v_mfma_f32_16x16x32_bf16 v[108:111], v[172:175], a[20:23], v[108:111]
  ds_write_b128 v250, v[88:91] offset:18432
  v_mfma_f32_16x16x32_bf16 v[108:111], v[188:191], a[48:51], v[108:111]
  ds_read_b128 v[20:23], v248 offset:7168
  v_mfma_f32_16x16x32_bf16 v[96:99], v[160:163], a[20:23], v[96:99]
  ds_write_b128 v251, v[92:95] offset:25600
  v_mfma_f32_16x16x32_bf16 v[96:99], v[176:179], a[48:51], v[96:99]
  s_waitcnt vmcnt(7)
  ds_read_b128 v[24:27], v248 offset:14336
  v_mfma_f32_16x16x32_bf16 v[116:119], v[164:167], a[24:27], v[116:119]
  ds_read_b128 v[28:31], v248 offset:21504
  v_mfma_f32_16x16x32_bf16 v[116:119], v[180:183], a[52:55], v[116:119]
  ds_read_b128 v[36:39], v248 offset:8192
  v_mfma_f32_16x16x32_bf16 v[120:123], v[168:171], a[24:27], v[120:123]
  ds_write_b128 v249, v[100:103] offset:12288
  v_mfma_f32_16x16x32_bf16 v[120:123], v[184:187], a[52:55], v[120:123]
  ds_read_b128 v[40:43], v248 offset:15360
  v_mfma_f32_16x16x32_bf16 v[124:127], v[172:175], a[24:27], v[124:127]
  ds_write_b128 v250, v[104:107] offset:19456
  v_mfma_f32_16x16x32_bf16 v[124:127], v[188:191], a[52:55], v[124:127]
  ds_read_b128 v[44:47], v248 offset:22528
  v_mfma_f32_16x16x32_bf16 v[112:115], v[160:163], a[24:27], v[112:115]
  ds_write_b128 v251, v[108:111] offset:26624
  v_mfma_f32_16x16x32_bf16 v[112:115], v[176:179], a[52:55], v[112:115]
  ds_read_b128 v[52:55], v248 offset:9216
  ds_read_b128 v[56:59], v248 offset:16384
  ds_read_b128 v[60:63], v248 offset:23552
  s_nop 4
  ds_write_b128 v249, v[116:119] offset:13312
  ds_write_b128 v250, v[120:123] offset:20480
  ds_write_b128 v251, v[124:127] offset:27648
  s_waitcnt vmcnt(0)
  ds_read_b128 v[68:71], v248 offset:10240
  ds_read_b128 v[72:75], v248 offset:17408
  ds_read_b128 v[76:79], v248 offset:24576
  s_waitcnt lgkmcnt(14)
  v_pk_add_f32 v[16:17], v[16:17], v[20:21]
  v_pk_add_f32 v[24:25], v[24:25], v[28:29]
  v_pk_add_f32 v[18:19], v[18:19], v[22:23]
  v_pk_add_f32 v[26:27], v[26:27], v[30:31]
  v_pk_add_f32 v[16:17], v[16:17], v[192:193]
  v_pk_add_f32 v[18:19], v[18:19], v[194:195]
  v_pk_add_f32 v[16:17], v[16:17], v[24:25]
  v_pk_add_f32 v[18:19], v[18:19], v[26:27]
  v_cvt_pk_bf16_f32 v16, v16, v17
  v_cvt_pk_bf16_f32 v17, v18, v19
  buffer_store_dwordx2 v[16:17], v252, s[76:79], s90 offen
  s_add_u32 s90, s90, 32768
  s_waitcnt lgkmcnt(10)
  v_pk_add_f32 v[32:33], v[32:33], v[36:37]
  v_pk_add_f32 v[40:41], v[40:41], v[44:45]
  v_pk_add_f32 v[34:35], v[34:35], v[38:39]
  v_pk_add_f32 v[42:43], v[42:43], v[46:47]
  v_pk_add_f32 v[32:33], v[32:33], v[196:197]
  v_pk_add_f32 v[34:35], v[34:35], v[198:199]
  v_pk_add_f32 v[32:33], v[32:33], v[40:41]
  v_pk_add_f32 v[34:35], v[34:35], v[42:43]
  v_cvt_pk_bf16_f32 v32, v32, v33
  v_cvt_pk_bf16_f32 v33, v34, v35
  buffer_store_dwordx2 v[32:33], v252, s[76:79], s90 offen
  s_add_u32 s90, s90, 32768
  s_waitcnt lgkmcnt(3)
  s_barrier
  ds_read_b128 v[84:87], v248 offset:11264
  ds_read_b128 v[88:91], v248 offset:18432
  ds_read_b128 v[92:95], v248 offset:25600
  ds_read_b128 v[100:103], v248 offset:12288
  ds_read_b128 v[104:107], v248 offset:19456
  ds_read_b128 v[108:111], v248 offset:26624
  ds_read_b128 v[116:119], v248 offset:13312
  ds_read_b128 v[120:123], v248 offset:20480
  ds_read_b128 v[124:127], v248 offset:27648
  s_waitcnt lgkmcnt(14)
  v_pk_add_f32 v[48:49], v[48:49], v[52:53]
  v_pk_add_f32 v[56:57], v[56:57], v[60:61]
  v_pk_add_f32 v[50:51], v[50:51], v[54:55]
  v_pk_add_f32 v[58:59], v[58:59], v[62:63]
  v_pk_add_f32 v[48:49], v[48:49], v[200:201]
  v_pk_add_f32 v[50:51], v[50:51], v[202:203]
  v_pk_add_f32 v[48:49], v[48:49], v[56:57]
  v_pk_add_f32 v[50:51], v[50:51], v[58:59]
  v_cvt_pk_bf16_f32 v48, v48, v49
  v_cvt_pk_bf16_f32 v49, v50, v51
  buffer_store_dwordx2 v[48:49], v252, s[76:79], s90 offen
  s_add_u32 s90, s90, 32768
  s_waitcnt lgkmcnt(9)
  v_pk_add_f32 v[64:65], v[64:65], v[68:69]
  v_pk_add_f32 v[72:73], v[72:73], v[76:77]
  v_pk_add_f32 v[66:67], v[66:67], v[70:71]
  v_pk_add_f32 v[74:75], v[74:75], v[78:79]
  v_pk_add_f32 v[64:65], v[64:65], v[204:205]
  v_pk_add_f32 v[66:67], v[66:67], v[206:207]
  v_pk_add_f32 v[64:65], v[64:65], v[72:73]
  v_pk_add_f32 v[66:67], v[66:67], v[74:75]
  v_cvt_pk_bf16_f32 v64, v64, v65
  v_cvt_pk_bf16_f32 v65, v66, v67
  buffer_store_dwordx2 v[64:65], v252, s[76:79], s90 offen
  s_add_u32 s90, s90, 32768
  s_waitcnt lgkmcnt(6)
  v_pk_add_f32 v[80:81], v[80:81], v[84:85]
  v_pk_add_f32 v[88:89], v[88:89], v[92:93]
  v_pk_add_f32 v[82:83], v[82:83], v[86:87]
  v_pk_add_f32 v[90:91], v[90:91], v[94:95]
  v_pk_add_f32 v[80:81], v[80:81], v[208:209]
  v_pk_add_f32 v[82:83], v[82:83], v[210:211]
  v_pk_add_f32 v[80:81], v[80:81], v[88:89]
  v_pk_add_f32 v[82:83], v[82:83], v[90:91]
  v_cvt_pk_bf16_f32 v80, v80, v81
  v_cvt_pk_bf16_f32 v81, v82, v83
  buffer_store_dwordx2 v[80:81], v252, s[76:79], s90 offen
  s_add_u32 s90, s90, 32768
  s_waitcnt lgkmcnt(3)
  v_pk_add_f32 v[96:97], v[96:97], v[100:101]
  v_pk_add_f32 v[104:105], v[104:105], v[108:109]
  v_pk_add_f32 v[98:99], v[98:99], v[102:103]
  v_pk_add_f32 v[106:107], v[106:107], v[110:111]
  v_pk_add_f32 v[96:97], v[96:97], v[212:213]
  v_pk_add_f32 v[98:99], v[98:99], v[214:215]
  v_pk_add_f32 v[96:97], v[96:97], v[104:105]
  v_pk_add_f32 v[98:99], v[98:99], v[106:107]
  v_cvt_pk_bf16_f32 v96, v96, v97
  v_cvt_pk_bf16_f32 v97, v98, v99
  buffer_store_dwordx2 v[96:97], v252, s[76:79], s90 offen
  s_add_u32 s90, s90, 32768
  s_waitcnt lgkmcnt(0)
  v_pk_add_f32 v[112:113], v[112:113], v[116:117]
  v_pk_add_f32 v[120:121], v[120:121], v[124:125]
  v_pk_add_f32 v[114:115], v[114:115], v[118:119]
  v_pk_add_f32 v[122:123], v[122:123], v[126:127]
  v_pk_add_f32 v[112:113], v[112:113], v[216:217]
  v_pk_add_f32 v[114:115], v[114:115], v[218:219]
  v_pk_add_f32 v[112:113], v[112:113], v[120:121]
  v_pk_add_f32 v[114:115], v[114:115], v[122:123]
  v_cvt_pk_bf16_f32 v112, v112, v113
  v_cvt_pk_bf16_f32 v113, v114, v115
  buffer_store_dwordx2 v[112:113], v252, s[76:79], s90 offen
  s_add_u32 s90, s90, 32768
L_done:
  s_endpgm
L_fallback:
  s_mov_b32 s47, 1
  s_waitcnt vmcnt(0) lgkmcnt(0)
  s_barrier
  v_mov_b32 v196, 0xff800000
  v_mov_b32 v200, 0xff800000
  v_mov_b32 v204, 0xff800000
  v_mov_b32 v208, 0xff800000
  v_mov_b32 v212, 0xff800000
  v_mov_b32 v216, 0xff800000
  v_mov_b32 v220, 0xff800000
  s_mov_b32 s43, s94
  v_add_u32 v232, 0, v12
  v_xor_b32 v233, 64, v232
  v_xor_b32 v234, 128, v232
  v_xor_b32 v235, 192, v232
  s_mov_b32 s38, 0
L_fb_loop:
  s_add_u32 m0, 0, s49
  s_nop 0
  buffer_load_dwordx4 v4, s[12:15], s43 offen offset:0 nt lds
  buffer_load_dwordx4 v5, s[12:15], s43 offen offset:1024 nt lds
  buffer_load_dwordx4 v6, s[12:15], s43 offen offset:2048 nt lds
  buffer_load_dwordx4 v7, s[12:15], s43 offen offset:3072 nt lds
  s_add_u32 s43, s43, 16384
  s_and_b32 s43, s43, 0x3ffff
  s_waitcnt vmcnt(0)
  s_barrier
  ds_read_b128 a[224:227], v232 offset:0
  ds_read_b128 a[228:231], v233 offset:0
  ds_read_b128 a[232:235], v234 offset:0
  ds_read_b128 a[236:239], v235 offset:0
  ds_read_b128 a[240:243], v232 offset:4096
  ds_read_b128 a[244:247], v233 offset:4096
  ds_read_b128 a[248:251], v234 offset:4096
  ds_read_b128 a[252:255], v235 offset:4096
  s_waitcnt lgkmcnt(0)
  s_barrier
  v_mfma_f32_16x16x32_bf16 v[160:163], a[224:227], a[112:115], 0
  v_mfma_f32_16x16x32_bf16 v[160:163], a[228:231], a[116:119], v[160:163]
  v_mfma_f32_16x16x32_bf16 v[160:163], a[232:235], a[120:123], v[160:163]
  v_mfma_f32_16x16x32_bf16 v[160:163], a[236:239], a[124:127], v[160:163]
  v_mfma_f32_16x16x32_bf16 v[164:167], a[240:243], a[112:115], 0
  v_mfma_f32_16x16x32_bf16 v[164:167], a[244:247], a[116:119], v[164:167]
  v_mfma_f32_16x16x32_bf16 v[164:167], a[248:251], a[120:123], v[164:167]
  v_mfma_f32_16x16x32_bf16 v[164:167], a[252:255], a[124:127], v[164:167]
  s_nop 7
  v_max3_f32 v196, v196, v160, v161
  v_max3_f32 v196, v196, v162, v163
  v_max3_f32 v196, v196, v164, v165
  v_max3_f32 v196, v196, v166, v167
  v_mfma_f32_16x16x32_bf16 v[160:163], a[224:227], a[128:131], 0
  v_mfma_f32_16x16x32_bf16 v[160:163], a[228:231], a[132:135], v[160:163]
  v_mfma_f32_16x16x32_bf16 v[160:163], a[232:235], a[136:139], v[160:163]
  v_mfma_f32_16x16x32_bf16 v[160:163], a[236:239], a[140:143], v[160:163]
  v_mfma_f32_16x16x32_bf16 v[164:167], a[240:243], a[128:131], 0
  v_mfma_f32_16x16x32_bf16 v[164:167], a[244:247], a[132:135], v[164:167]
  v_mfma_f32_16x16x32_bf16 v[164:167], a[248:251], a[136:139], v[164:167]
  v_mfma_f32_16x16x32_bf16 v[164:167], a[252:255], a[140:143], v[164:167]
  s_nop 7
  v_max3_f32 v200, v200, v160, v161
  v_max3_f32 v200, v200, v162, v163
  v_max3_f32 v200, v200, v164, v165
  v_max3_f32 v200, v200, v166, v167
  v_mfma_f32_16x16x32_bf16 v[160:163], a[224:227], a[144:147], 0
  v_mfma_f32_16x16x32_bf16 v[160:163], a[228:231], a[148:151], v[160:163]
  v_mfma_f32_16x16x32_bf16 v[160:163], a[232:235], a[152:155], v[160:163]
  v_mfma_f32_16x16x32_bf16 v[160:163], a[236:239], a[156:159], v[160:163]
  v_mfma_f32_16x16x32_bf16 v[164:167], a[240:243], a[144:147], 0
  v_mfma_f32_16x16x32_bf16 v[164:167], a[244:247], a[148:151], v[164:167]
  v_mfma_f32_16x16x32_bf16 v[164:167], a[248:251], a[152:155], v[164:167]
  v_mfma_f32_16x16x32_bf16 v[164:167], a[252:255], a[156:159], v[164:167]
  s_nop 7
  v_max3_f32 v204, v204, v160, v161
  v_max3_f32 v204, v204, v162, v163
  v_max3_f32 v204, v204, v164, v165
  v_max3_f32 v204, v204, v166, v167
  v_mfma_f32_16x16x32_bf16 v[160:163], a[224:227], a[160:163], 0
  v_mfma_f32_16x16x32_bf16 v[160:163], a[228:231], a[164:167], v[160:163]
  v_mfma_f32_16x16x32_bf16 v[160:163], a[232:235], a[168:171], v[160:163]
  v_mfma_f32_16x16x32_bf16 v[160:163], a[236:239], a[172:175], v[160:163]
  v_mfma_f32_16x16x32_bf16 v[164:167], a[240:243], a[160:163], 0
  v_mfma_f32_16x16x32_bf16 v[164:167], a[244:247], a[164:167], v[164:167]
  v_mfma_f32_16x16x32_bf16 v[164:167], a[248:251], a[168:171], v[164:167]
  v_mfma_f32_16x16x32_bf16 v[164:167], a[252:255], a[172:175], v[164:167]
  s_nop 7
  v_max3_f32 v208, v208, v160, v161
  v_max3_f32 v208, v208, v162, v163
  v_max3_f32 v208, v208, v164, v165
  v_max3_f32 v208, v208, v166, v167
  v_mfma_f32_16x16x32_bf16 v[160:163], a[224:227], a[176:179], 0
  v_mfma_f32_16x16x32_bf16 v[160:163], a[228:231], a[180:183], v[160:163]
  v_mfma_f32_16x16x32_bf16 v[160:163], a[232:235], a[184:187], v[160:163]
  v_mfma_f32_16x16x32_bf16 v[160:163], a[236:239], a[188:191], v[160:163]
  v_mfma_f32_16x16x32_bf16 v[164:167], a[240:243], a[176:179], 0
  v_mfma_f32_16x16x32_bf16 v[164:167], a[244:247], a[180:183], v[164:167]
  v_mfma_f32_16x16x32_bf16 v[164:167], a[248:251], a[184:187], v[164:167]
  v_mfma_f32_16x16x32_bf16 v[164:167], a[252:255], a[188:191], v[164:167]
  s_nop 7
  v_max3_f32 v212, v212, v160, v161
  v_max3_f32 v212, v212, v162, v163
  v_max3_f32 v212, v212, v164, v165
  v_max3_f32 v212, v212, v166, v167
  v_mfma_f32_16x16x32_bf16 v[160:163], a[224:227], a[192:195], 0
  v_mfma_f32_16x16x32_bf16 v[160:163], a[228:231], a[196:199], v[160:163]
  v_mfma_f32_16x16x32_bf16 v[160:163], a[232:235], a[200:203], v[160:163]
  v_mfma_f32_16x16x32_bf16 v[160:163], a[236:239], a[204:207], v[160:163]
  v_mfma_f32_16x16x32_bf16 v[164:167], a[240:243], a[192:195], 0
  v_mfma_f32_16x16x32_bf16 v[164:167], a[244:247], a[196:199], v[164:167]
  v_mfma_f32_16x16x32_bf16 v[164:167], a[248:251], a[200:203], v[164:167]
  v_mfma_f32_16x16x32_bf16 v[164:167], a[252:255], a[204:207], v[164:167]
  s_nop 7
  v_max3_f32 v216, v216, v160, v161
  v_max3_f32 v216, v216, v162, v163
  v_max3_f32 v216, v216, v164, v165
  v_max3_f32 v216, v216, v166, v167
  v_mfma_f32_16x16x32_bf16 v[160:163], a[224:227], a[208:211], 0
  v_mfma_f32_16x16x32_bf16 v[160:163], a[228:231], a[212:215], v[160:163]
  v_mfma_f32_16x16x32_bf16 v[160:163], a[232:235], a[216:219], v[160:163]
  v_mfma_f32_16x16x32_bf16 v[160:163], a[236:239], a[220:223], v[160:163]
  v_mfma_f32_16x16x32_bf16 v[164:167], a[240:243], a[208:211], 0
  v_mfma_f32_16x16x32_bf16 v[164:167], a[244:247], a[212:215], v[164:167]
  v_mfma_f32_16x16x32_bf16 v[164:167], a[248:251], a[216:219], v[164:167]
  v_mfma_f32_16x16x32_bf16 v[164:167], a[252:255], a[220:223], v[164:167]
  s_nop 7
  v_max3_f32 v220, v220, v160, v161
  v_max3_f32 v220, v220, v162, v163
  v_max3_f32 v220, v220, v164, v165
  v_max3_f32 v220, v220, v166, v167
  s_add_u32 s38, s38, 1
  s_cmp_lt_u32 s38, 16
  s_cbranch_scc1 L_fb_loop
  v_mov_b32 v197, v196
  v_mov_b32 v201, v200
  v_mov_b32 v205, v204
  v_mov_b32 v209, v208
  v_mov_b32 v213, v212
  v_mov_b32 v217, v216
  v_mov_b32 v221, v220
  s_nop 1
  v_permlane32_swap_b32 v196, v197
  v_permlane32_swap_b32 v200, v201
  v_permlane32_swap_b32 v204, v205
  v_permlane32_swap_b32 v208, v209
  v_permlane32_swap_b32 v212, v213
  v_permlane32_swap_b32 v216, v217
  v_permlane32_swap_b32 v220, v221
  s_nop 1
  v_max_f32 v196, v196, v197
  v_max_f32 v200, v200, v201
  v_max_f32 v204, v204, v205
  v_max_f32 v208, v208, v209
  v_max_f32 v212, v212, v213
  v_max_f32 v216, v216, v217
  v_max_f32 v220, v220, v221
  v_mov_b32 v197, v196
  v_mov_b32 v201, v200
  v_mov_b32 v205, v204
  v_mov_b32 v209, v208
  v_mov_b32 v213, v212
  v_mov_b32 v217, v216
  v_mov_b32 v221, v220
  s_nop 1
  v_permlane16_swap_b32 v196, v197
  v_permlane16_swap_b32 v200, v201
  v_permlane16_swap_b32 v204, v205
  v_permlane16_swap_b32 v208, v209
  v_permlane16_swap_b32 v212, v213
  v_permlane16_swap_b32 v216, v217
  v_permlane16_swap_b32 v220, v221
  s_nop 1
  v_max_f32 v196, v196, v197
  v_max_f32 v200, v200, v201
  v_max_f32 v204, v204, v205
  v_max_f32 v208, v208, v209
  v_max_f32 v212, v212, v213
  v_max_f32 v216, v216, v217
  v_max_f32 v220, v220, v221
  v_sub_f32 v196, 0, v196
  v_mov_b32 v197, v196
  v_mov_b32 v198, v196
  v_mov_b32 v199, v196
  v_sub_f32 v200, 0, v200
  v_mov_b32 v201, v200
  v_mov_b32 v202, v200
  v_mov_b32 v203, v200
  v_sub_f32 v204, 0, v204
  v_mov_b32 v205, v204
  v_mov_b32 v206, v204
  v_mov_b32 v207, v204
  v_sub_f32 v208, 0, v208
  v_mov_b32 v209, v208
  v_mov_b32 v210, v208
  v_mov_b32 v211, v208
  v_sub_f32 v212, 0, v212
  v_mov_b32 v213, v212
  v_mov_b32 v214, v212
  v_mov_b32 v215, v212
  v_sub_f32 v216, 0, v216
  v_mov_b32 v217, v216
  v_mov_b32 v218, v216
  v_mov_b32 v219, v216
  v_sub_f32 v220, 0, v220
  v_mov_b32 v221, v220
  v_mov_b32 v222, v220
  v_mov_b32 v223, v220
  s_mov_b32 s43, s94
  s_add_u32 m0, 131072, s49
  s_nop 0
  buffer_load_dwordx4 v4, s[12:15], s43 offen offset:0 nt lds
  buffer_load_dwordx4 v5, s[12:15], s43 offen offset:1024 nt lds
  buffer_load_dwordx4 v6, s[12:15], s43 offen offset:2048 nt lds
  buffer_load_dwordx4 v7, s[12:15], s43 offen offset:3072 nt lds
  s_add_u32 m0, 131072, s48
  s_nop 0
  buffer_load_dwordx4 v4, s[16:19], s43 offen offset:0 nt lds
  buffer_load_dwordx4 v5, s[16:19], s43 offen offset:1024 nt lds
  buffer_load_dwordx4 v6, s[16:19], s43 offen offset:2048 nt lds
  buffer_load_dwordx4 v7, s[16:19], s43 offen offset:3072 nt lds
  s_add_u32 s43, s43, 16384
  s_and_b32 s43, s43, 0x3ffff
  s_add_u32 m0, 98304, s49
  s_nop 0
  buffer_load_dwordx4 v4, s[12:15], s43 offen offset:0 nt lds
  buffer_load_dwordx4 v5, s[12:15], s43 offen offset:1024 nt lds
  buffer_load_dwordx4 v6, s[12:15], s43 offen offset:2048 nt lds
  buffer_load_dwordx4 v7, s[12:15], s43 offen offset:3072 nt lds
  s_add_u32 m0, 98304, s48
  s_nop 0
  buffer_load_dwordx4 v4, s[16:19], s43 offen offset:0 nt lds
  buffer_load_dwordx4 v5, s[16:19], s43 offen offset:1024 nt lds
  buffer_load_dwordx4 v6, s[16:19], s43 offen offset:2048 nt lds
  buffer_load_dwordx4 v7, s[16:19], s43 offen offset:3072 nt lds
  s_add_u32 s43, s43, 16384
  s_and_b32 s43, s43, 0x3ffff
  s_add_u32 m0, 65536, s49
  s_nop 0
  buffer_load_dwordx4 v4, s[12:15], s43 offen offset:0 nt lds
  buffer_load_dwordx4 v5, s[12:15], s43 offen offset:1024 nt lds
  buffer_load_dwordx4 v6, s[12:15], s43 offen offset:2048 nt lds
  buffer_load_dwordx4 v7, s[12:15], s43 offen offset:3072 nt lds
  s_add_u32 m0, 65536, s48
  s_nop 0
  buffer_load_dwordx4 v4, s[16:19], s43 offen offset:0 nt lds
  buffer_load_dwordx4 v5, s[16:19], s43 offen offset:1024 nt lds
  buffer_load_dwordx4 v6, s[16:19], s43 offen offset:2048 nt lds
  buffer_load_dwordx4 v7, s[16:19], s43 offen offset:3072 nt lds
  s_add_u32 s43, s43, 16384
  s_and_b32 s43, s43, 0x3ffff
  s_add_u32 m0, 32768, s49
  s_nop 0
  buffer_load_dwordx4 v4, s[12:15], s43 offen offset:0 nt lds
  buffer_load_dwordx4 v5, s[12:15], s43 offen offset:1024 nt lds
  buffer_load_dwordx4 v6, s[12:15], s43 offen offset:2048 nt lds
  buffer_load_dwordx4 v7, s[12:15], s43 offen offset:3072 nt lds
  s_add_u32 m0, 32768, s48
  s_nop 0
  buffer_load_dwordx4 v4, s[16:19], s43 offen offset:0 nt lds
  buffer_load_dwordx4 v5, s[16:19], s43 offen offset:1024 nt lds
  buffer_load_dwordx4 v6, s[16:19], s43 offen offset:2048 nt lds
  buffer_load_dwordx4 v7, s[16:19], s43 offen offset:3072 nt lds
  s_add_u32 s43, s43, 16384
  s_and_b32 s43, s43, 0x3ffff
  v_mov_b32 v16, 0
  v_mov_b32 v17, 0
  v_mov_b32 v18, 0
  v_mov_b32 v19, 0
  v_mov_b32 v20, 0
  v_mov_b32 v21, 0
  v_mov_b32 v22, 0
  v_mov_b32 v23, 0
  v_mov_b32 v24, 0
  v_mov_b32 v25, 0
  v_mov_b32 v26, 0
  v_mov_b32 v27, 0
  v_mov_b32 v28, 0
  v_mov_b32 v29, 0
  v_mov_b32 v30, 0
  v_mov_b32 v31, 0
  v_mov_b32 v32, 0
  v_mov_b32 v33, 0
  v_mov_b32 v34, 0
  v_mov_b32 v35, 0
  v_mov_b32 v36, 0
  v_mov_b32 v37, 0
  v_mov_b32 v38, 0
  v_mov_b32 v39, 0
  v_mov_b32 v40, 0
  v_mov_b32 v41, 0
  v_mov_b32 v42, 0
  v_mov_b32 v43, 0
  v_mov_b32 v44, 0
  v_mov_b32 v45, 0
  v_mov_b32 v46, 0
  v_mov_b32 v47, 0
  v_mov_b32 v48, 0
  v_mov_b32 v49, 0
  v_mov_b32 v50, 0
  v_mov_b32 v51, 0
  v_mov_b32 v52, 0
  v_mov_b32 v53, 0
  v_mov_b32 v54, 0
  v_mov_b32 v55, 0
  v_mov_b32 v56, 0
  v_mov_b32 v57, 0
  v_mov_b32 v58, 0
  v_mov_b32 v59, 0
  v_mov_b32 v60, 0
  v_mov_b32 v61, 0
  v_mov_b32 v62, 0
  v_mov_b32 v63, 0
  v_mov_b32 v64, 0
  v_mov_b32 v65, 0
  v_mov_b32 v66, 0
  v_mov_b32 v67, 0
  v_mov_b32 v68, 0
  v_mov_b32 v69, 0
  v_mov_b32 v70, 0
  v_mov_b32 v71, 0
  v_mov_b32 v72, 0
  v_mov_b32 v73, 0
  v_mov_b32 v74, 0
  v_mov_b32 v75, 0
  v_mov_b32 v76, 0
  v_mov_b32 v77, 0
  v_mov_b32 v78, 0
  v_mov_b32 v79, 0
  v_mov_b32 v80, 0
  v_mov_b32 v81, 0
  v_mov_b32 v82, 0
  v_mov_b32 v83, 0
  v_mov_b32 v84, 0
  v_mov_b32 v85, 0
  v_mov_b32 v86, 0
  v_mov_b32 v87, 0
  v_mov_b32 v88, 0
  v_mov_b32 v89, 0
  v_mov_b32 v90, 0
  v_mov_b32 v91, 0
  v_mov_b32 v92, 0
  v_mov_b32 v93, 0
  v_mov_b32 v94, 0
  v_mov_b32 v95, 0
  v_mov_b32 v96, 0
  v_mov_b32 v97, 0
  v_mov_b32 v98, 0
  v_mov_b32 v99, 0
  v_mov_b32 v100, 0
  v_mov_b32 v101, 0
  v_mov_b32 v102, 0
  v_mov_b32 v103, 0
  v_mov_b32 v104, 0
  v_mov_b32 v105, 0
  v_mov_b32 v106, 0
  v_mov_b32 v107, 0
  v_mov_b32 v108, 0
  v_mov_b32 v109, 0
  v_mov_b32 v110, 0
  v_mov_b32 v111, 0
  v_mov_b32 v112, 0
  v_mov_b32 v113, 0
  v_mov_b32 v114, 0
  v_mov_b32 v115, 0
  v_mov_b32 v116, 0
  v_mov_b32 v117, 0
  v_mov_b32 v118, 0
  v_mov_b32 v119, 0
  v_mov_b32 v120, 0
  v_mov_b32 v121, 0
  v_mov_b32 v122, 0
  v_mov_b32 v123, 0
  v_mov_b32 v124, 0
  v_mov_b32 v125, 0
  v_mov_b32 v126, 0
  v_mov_b32 v127, 0
  v_accvgpr_write_b32 a0, 0
  v_accvgpr_write_b32 a1, 0
  v_accvgpr_write_b32 a2, 0
  v_accvgpr_write_b32 a3, 0
  v_accvgpr_write_b32 a4, 0
  v_accvgpr_write_b32 a5, 0
  v_accvgpr_write_b32 a6, 0
  v_accvgpr_write_b32 a7, 0
  v_accvgpr_write_b32 a8, 0
  v_accvgpr_write_b32 a9, 0
  v_accvgpr_write_b32 a10, 0
  v_accvgpr_write_b32 a11, 0
  v_accvgpr_write_b32 a12, 0
  v_accvgpr_write_b32 a13, 0
  v_accvgpr_write_b32 a14, 0
  v_accvgpr_write_b32 a15, 0
  v_accvgpr_write_b32 a16, 0
  v_accvgpr_write_b32 a17, 0
  v_accvgpr_write_b32 a18, 0
  v_accvgpr_write_b32 a19, 0
  v_accvgpr_write_b32 a20, 0
  v_accvgpr_write_b32 a21, 0
  v_accvgpr_write_b32 a22, 0
  v_accvgpr_write_b32 a23, 0
  v_accvgpr_write_b32 a24, 0
  v_accvgpr_write_b32 a25, 0
  v_accvgpr_write_b32 a26, 0
  v_accvgpr_write_b32 a27, 0
  v_accvgpr_write_b32 a28, 0
  v_accvgpr_write_b32 a29, 0
  v_accvgpr_write_b32 a30, 0
  v_accvgpr_write_b32 a31, 0
  v_accvgpr_write_b32 a32, 0
  v_accvgpr_write_b32 a33, 0
  v_accvgpr_write_b32 a34, 0
  v_accvgpr_write_b32 a35, 0
  v_accvgpr_write_b32 a36, 0
  v_accvgpr_write_b32 a37, 0
  v_accvgpr_write_b32 a38, 0
  v_accvgpr_write_b32 a39, 0
  v_accvgpr_write_b32 a40, 0
  v_accvgpr_write_b32 a41, 0
  v_accvgpr_write_b32 a42, 0
  v_accvgpr_write_b32 a43, 0
  v_accvgpr_write_b32 a44, 0
  v_accvgpr_write_b32 a45, 0
  v_accvgpr_write_b32 a46, 0
  v_accvgpr_write_b32 a47, 0
  v_accvgpr_write_b32 a48, 0
  v_accvgpr_write_b32 a49, 0
  v_accvgpr_write_b32 a50, 0
  v_accvgpr_write_b32 a51, 0
  v_accvgpr_write_b32 a52, 0
  v_accvgpr_write_b32 a53, 0
  v_accvgpr_write_b32 a54, 0
  v_accvgpr_write_b32 a55, 0
  v_accvgpr_write_b32 a56, 0
  v_accvgpr_write_b32 a57, 0
  v_accvgpr_write_b32 a58, 0
  v_accvgpr_write_b32 a59, 0
  v_accvgpr_write_b32 a60, 0
  v_accvgpr_write_b32 a61, 0
  v_accvgpr_write_b32 a62, 0
  v_accvgpr_write_b32 a63, 0
  v_accvgpr_write_b32 a64, 0
  v_accvgpr_write_b32 a65, 0
  v_accvgpr_write_b32 a66, 0
  v_accvgpr_write_b32 a67, 0
  v_accvgpr_write_b32 a68, 0
  v_accvgpr_write_b32 a69, 0
  v_accvgpr_write_b32 a70, 0
  v_accvgpr_write_b32 a71, 0
  v_accvgpr_write_b32 a72, 0
  v_accvgpr_write_b32 a73, 0
  v_accvgpr_write_b32 a74, 0
  v_accvgpr_write_b32 a75, 0
  v_accvgpr_write_b32 a76, 0
  v_accvgpr_write_b32 a77, 0
  v_accvgpr_write_b32 a78, 0
  v_accvgpr_write_b32 a79, 0
  v_accvgpr_write_b32 a80, 0
  v_accvgpr_write_b32 a81, 0
  v_accvgpr_write_b32 a82, 0
  v_accvgpr_write_b32 a83, 0
  v_accvgpr_write_b32 a84, 0
  v_accvgpr_write_b32 a85, 0
  v_accvgpr_write_b32 a86, 0
  v_accvgpr_write_b32 a87, 0
  v_accvgpr_write_b32 a88, 0
  v_accvgpr_write_b32 a89, 0
  v_accvgpr_write_b32 a90, 0
  v_accvgpr_write_b32 a91, 0
  v_accvgpr_write_b32 a92, 0
  v_accvgpr_write_b32 a93, 0
  v_accvgpr_write_b32 a94, 0
  v_accvgpr_write_b32 a95, 0
  v_accvgpr_write_b32 a96, 0
  v_accvgpr_write_b32 a97, 0
  v_accvgpr_write_b32 a98, 0
  v_accvgpr_write_b32 a99, 0
  v_accvgpr_write_b32 a100, 0
  v_accvgpr_write_b32 a101, 0
  v_accvgpr_write_b32 a102, 0
  v_accvgpr_write_b32 a103, 0
  v_accvgpr_write_b32 a104, 0
  v_accvgpr_write_b32 a105, 0
  v_accvgpr_write_b32 a106, 0
  v_accvgpr_write_b32 a107, 0
  v_accvgpr_write_b32 a108, 0
  v_accvgpr_write_b32 a109, 0
  v_accvgpr_write_b32 a110, 0
  v_accvgpr_write_b32 a111, 0
  v_mov_b32 v128, 0
  v_mov_b32 v129, 0
  v_mov_b32 v130, 0
  v_mov_b32 v131, 0
  v_mov_b32 v132, 0
  v_mov_b32 v133, 0
  v_mov_b32 v134, 0
  v_mov_b32 v135, 0
  v_mov_b32 v136, 0
  v_mov_b32 v137, 0
  v_mov_b32 v138, 0
  v_mov_b32 v139, 0
  v_mov_b32 v140, 0
  v_mov_b32 v141, 0
  v_mov_b32 v142, 0
  v_mov_b32 v143, 0
  v_mov_b32 v144, 0
  v_mov_b32 v145, 0
  v_mov_b32 v146, 0
  v_mov_b32 v147, 0
  v_mov_b32 v148, 0
  v_mov_b32 v149, 0
  v_mov_b32 v150, 0
  v_mov_b32 v151, 0
  v_mov_b32 v152, 0
  v_mov_b32 v153, 0
  v_mov_b32 v154, 0
  v_mov_b32 v155, 0
  v_mov_b32 v156, 0
  v_mov_b32 v157, 0
  v_mov_b32 v158, 0
  v_mov_b32 v159, 0
  v_mov_b32 v184, 0
  v_mov_b32 v185, 0
  v_mov_b32 v186, 0
  v_mov_b32 v187, 0
  v_mov_b32 v188, 0
  v_mov_b32 v189, 0
  v_mov_b32 v190, 0
  v_mov_b32 v191, 0
  v_mov_b32 v192, 0
  v_mov_b32 v193, 0
  v_mov_b32 v194, 0
  v_mov_b32 v195, 0
  v_mov_b32 v224, 0
  v_mov_b32 v225, 0
  v_mov_b32 v226, 0
  v_mov_b32 v227, 0
  v_mov_b32 v228, 0
  v_mov_b32 v229, 0
  v_mov_b32 v230, 0
  v_mov_b32 v176, 0xf149f2ca
  v_mov_b32 v177, 0xf149f2ca
  v_mov_b32 v178, 0xf149f2ca
  v_mov_b32 v179, 0xf149f2ca
  v_mov_b32 v180, 0xf149f2ca
  v_mov_b32 v181, 0xf149f2ca
  v_mov_b32 v182, 0xf149f2ca
  v_mov_b32 v183, 0xf149f2ca
  s_mov_b32 s35, 0xfff
  s_mov_b32 s45, 0
  s_mov_b32 s46, 98304
  s_mov_b32 s38, -1
  s_add_u32 s38, s38, 1
  s_bitcmp1_b32 s35, s38
  s_cselect_b32 s44, s45, 0x30000
  s_cselect_b32 s95, s43, 0x40000000
  s_cselect_b32 s42, 32768, 0
  s_sub_u32 s45, s45, s42
  s_cselect_b32 s45, 131072, s45
  s_lshr_b32 s42, s42, 1
  s_add_u32 s43, s43, s42
  s_and_b32 s43, s43, 0x3ffff
  v_add_u32 v232, 131072, v12
  v_xor_b32 v233, 64, v232
  v_xor_b32 v234, 128, v232
  v_xor_b32 v235, 192, v232
  v_add_u32 v236, 131072, v13
  v_xor_b32 v237, 32, v236
  v_xor_b32 v238, 64, v236
  v_xor_b32 v239, 96, v236
  v_xor_b32 v240, 128, v236
  v_xor_b32 v241, 160, v236
  v_xor_b32 v242, 192, v236
  v_xor_b32 v243, 224, v236
  s_waitcnt vmcnt(0)
  s_barrier
  ds_read_b128 a[224:227], v232 offset:0
  ds_read_b128 a[228:231], v233 offset:0
  ds_read_b128 a[232:235], v234 offset:0
  ds_read_b128 a[236:239], v235 offset:0
  ds_read_b128 a[240:243], v232 offset:4096
  ds_read_b128 a[244:247], v233 offset:4096
  ds_read_b128 a[248:251], v234 offset:4096
  ds_read_b128 a[252:255], v235 offset:4096
  s_waitcnt lgkmcnt(0)
  s_branch L_att
  .fill 6144, 4, 0xBF800000
.section .rodata,"a"
.p2align 6
.amdhsa_kernel standalone__mha_block_cached__near_ridge_kernel
  .amdhsa_next_free_vgpr 512
  .amdhsa_next_free_sgpr 102
  .amdhsa_accum_offset 256
  .amdhsa_group_segment_fixed_size 0
  .amdhsa_kernarg_size 64
  .amdhsa_user_sgpr_count 2
  .amdhsa_user_sgpr_kernarg_segment_ptr 1
  .amdhsa_system_sgpr_workgroup_id_x 1
.end_amdhsa_kernel
```
